```python
import torch

def _softmax(x, axis=-1):
    return torch.softmax(x, dim=axis)

def _gelu(x):
    return torch.nn.functional.gelu(x, approximate='tanh')

def _silu(x):
    return torch.nn.functional.silu(x)

def _sigmoid(x):
    return torch.sigmoid(x)

def _layernorm(x, axis=-1, eps=1e-05):
    m = x.mean(dim=axis, keepdim=True)
    v = x.var(dim=axis, keepdim=True, unbiased=False)
    return (x - m) / torch.sqrt(v + eps)

def _scatter_add(tgt, idx, src, axis=0):
    return tgt.clone().index_add_(axis, idx, src)

def _segment_sum(src, seg, n):
    out = torch.zeros((n,) + src.shape[1:], dtype=src.dtype)
    return out.index_add_(0, seg, src)

def _pad(x, pw):
    flat = tuple((v for pair in reversed(pw) for v in pair))
    return torch.nn.functional.pad(x, flat)
kernel_name = 'gated_mix__memory_aug_recurrent_mem_tr__ssm_conv_s4__prompt'

def setup_inputs():

    _w = lambda a: (lambda t: t.to(torch.bfloat16) if t.is_floating_point() else t)(torch.as_tensor(a))

    def _A_setup():
        B, S, Dm = (1, 2048, 512)
        H, Dh = (32, 128)
        M, seg = (8, 32)
        seg = min(seg, S)
        S = S // seg * seg
        return {'x': _w((lambda *s: torch.randn(*s, dtype=torch.bfloat16) * 0.05)(B, S, Dm)), 'mem0': _w((lambda *s: torch.randn(*s, dtype=torch.bfloat16) * 0.4)(B, M, Dm)), 'Wq': _w((lambda *s: torch.randn(*s, dtype=torch.bfloat16) * 6.4)(Dm, H, Dh) * Dm ** (-0.5)), 'Wk': _w((lambda *s: torch.randn(*s, dtype=torch.bfloat16) * 6.4)(Dm, H, Dh) * Dm ** (-0.5)), 'Wv': _w((lambda *s: torch.randn(*s, dtype=torch.bfloat16) * 0.4)(Dm, H, Dh) * Dm ** (-0.5)), 'Wo': _w((lambda *s: torch.randn(*s, dtype=torch.bfloat16) * 0.4)(H, Dh, Dm) * (H * Dh) ** (-0.5)), 'seg_len': seg}
    _A_in = _A_setup()

    def _B_setup():
        B, L, D, N = (1, 2048, 512, 128)
        A_re = -(lambda _x: torch.exp(torch.as_tensor(_x)))((lambda *s: torch.randn(*s, dtype=torch.bfloat16) * 6.4)(D, N))
        A_im = torch.pi * (lambda *s: torch.randn(*s, dtype=torch.bfloat16) * 0.05)(D, N)
        B_re = (lambda *s: torch.randn(*s, dtype=torch.bfloat16) * 0.1)(D, N)
        B_im = (lambda *s: torch.randn(*s, dtype=torch.bfloat16) * 0.1)(D, N)
        C_re = (lambda *s: torch.randn(*s, dtype=torch.bfloat16) * 0.1)(D, N)
        C_im = (lambda *s: torch.randn(*s, dtype=torch.bfloat16) * 0.1)(D, N)
        log_dt = (lambda *s: torch.randn(*s, dtype=torch.bfloat16) * 0.05)(D) * 0.5 - 4.0
        Dskip = (lambda *s: torch.randn(*s, dtype=torch.bfloat16) * 0.05)(D)
        return {'u': _w((lambda *s: torch.randn(*s, dtype=torch.bfloat16) * 0.05)(B, L, D)), 'A_re': _w(A_re), 'A_im': _w(A_im), 'B_re': _w(B_re), 'B_im': _w(B_im), 'C_re': _w(C_re), 'C_im': _w(C_im), 'log_dt': _w(log_dt), 'Dskip': _w(Dskip)}
    _B_in = _B_setup()
    return {'A_x': _A_in['x'], 'A_mem0': _A_in['mem0'], 'A_Wq': _A_in['Wq'], 'A_Wk': _A_in['Wk'], 'A_Wv': _A_in['Wv'], 'A_Wo': _A_in['Wo'], 'A_seg_len': _A_in['seg_len'], 'B_u': _B_in['u'], 'B_A_re': _B_in['A_re'], 'B_A_im': _B_in['A_im'], 'B_B_re': _B_in['B_re'], 'B_B_im': _B_in['B_im'], 'B_C_re': _B_in['C_re'], 'B_C_im': _B_in['C_im'], 'B_log_dt': _B_in['log_dt'], 'B_Dskip': _B_in['Dskip'], 'gate_w': _w((lambda *s: torch.randn(*s, dtype=torch.bfloat16) * 0.05)(512) * 16.0)}

def reference(A_x, A_mem0, A_Wq, A_Wk, A_Wv, A_Wo, A_seg_len, B_u, B_A_re, B_A_im, B_B_re, B_B_im, B_C_re, B_C_im, B_log_dt, B_Dskip, gate_w):

    def _A_ref(x, mem0, Wq, Wk, Wv, Wo, seg_len):
        B, S, Dm = x.shape
        H, Dh = (Wq.shape[1], Wq.shape[2])
        M = mem0.shape[1]
        scale = Dh ** (-0.5)
        n_seg = S // seg_len
        L = M + seg_len
        idx = torch.arange(L)
        mask = (idx[:, None] < M) | (idx[:, None] >= idx[None, :])
        mem = mem0
        outs = []
        for s in range(n_seg):
            xs = x[:, s * seg_len:(s + 1) * seg_len, :].clone()
            h = torch.concatenate([mem, xs], axis=1)
            q = torch.einsum('btd,dhe->bhte', h, Wq)
            k = torch.einsum('btd,dhe->bhte', h, Wk)
            v = torch.einsum('btd,dhe->bhte', h, Wv)
            scores = torch.einsum('bhqe,bhke->bhqk', q, k) * scale
            scores = torch.where(mask[None, None], scores, -1000000000.0)
            p = _softmax(scores, axis=-1)
            o = torch.einsum('bhqk,bhke->bhqe', p, v)
            o = torch.einsum('bhte,hed->btd', o, Wo)
            mem = o[:, :M, :].clone()
            outs.append(o[:, M:, :])
        return torch.concatenate(outs, axis=1)

    def _B_ref(u, A_re, A_im, B_re, B_im, C_re, C_im, log_dt, Dskip):
        Bsz, L, D = u.shape
        dt = torch.exp(log_dt)[:, None]
        A = A_re + 1j * A_im
        Bc = B_re + 1j * B_im
        Cc = C_re + 1j * C_im
        logdA = dt * A
        dB = dt * Bc
        l = (lambda x, dt: x.to(dt))(torch.arange(L), A_re.dtype)
        P = torch.exp(logdA[:, :, None] * l[None, None, :])
        K = torch.einsum('dn,dnl,dn->dl', Cc, P, dB).real
        L2 = 2 * L
        Kp = _pad(K, ((0, 0), (0, L)))
        up = (lambda x, *d: x.permute(*d))(u, 0, 2, 1)
        up = _pad(up, ((0, 0), (0, 0), (0, L)))
        Kf = (lambda x, axes=(-2, -1): torch.fft.rfft2(x.float(), dim=axes))(Kp[:, None, :], axes=(-2, -1))
        Uf = (lambda x, axes=(-2, -1): torch.fft.rfft2(x.float(), dim=axes))(up[:, :, None, :], axes=(-2, -1))
        Yf = Uf * Kf[None, :, :, :]
        y = (lambda x, s, axes=(-2, -1): torch.fft.irfft2(x, s=s, dim=axes).to(torch.bfloat16))(Yf, (1, L2), axes=(-2, -1))[:, :, 0, :L]
        y = (lambda x, *d: x.permute(*d))(y, 0, 2, 1) + u * Dskip[None, None, :]
        return y
    x = A_x
    g = _sigmoid((x * gate_w).sum(-1, keepdims=True))
    a = _A_ref(x, A_mem0, A_Wq, A_Wk, A_Wv, A_Wo, A_seg_len)
    b = _B_ref(x, B_A_re, B_A_im, B_B_re, B_B_im, B_C_re, B_C_im, B_log_dt, B_Dskip)
    return g * a + (1 - g) * b
```

```asm
; @launch kernel=mega_kernel grid=(256,1,1) block=(512,1,1) lds=163840
.amdgcn_target "amdgcn-amd-amdhsa--gfx950"
.text
.globl mega_kernel
.p2align 8
.type mega_kernel,@function
mega_kernel:
    s_cmp_ge_u32 s2, 256
    s_cbranch_scc1 L_mg_end_1
    s_load_dwordx2 s[22:23], s[0:1], 152
    s_load_dwordx2 s[12:13], s[0:1], 144
    v_lshrrev_b32 v16, 6, v0
    s_nop 0
    v_readfirstlane_b32 s14, v16
    s_waitcnt lgkmcnt(0)
    s_mov_b32 s4, s22
    s_and_b32 s5, s23, 0xffff
    s_mov_b32 s6, 0x10000000
    s_mov_b32 s7, 0x00020000
    s_getreg_b32 s24, hwreg(HW_REG_XCC_ID)
    s_and_b32 s24, s24, 7
    s_cmp_eq_u32 s24, 0
    s_cbranch_scc1 L_mg_nt_3
    s_lshr_b32 s24, s2, 6
    s_lshl_b32 s24, s24, 3
    s_add_u32 s24, s24, 16
    s_load_dwordx2 s[26:27], s[0:1], s24
    s_and_b32 s25, s2, 63
    s_lshl_b32 s25, s25, 16
    v_lshlrev_b32 v124, 4, v0
    s_waitcnt lgkmcnt(0)
    s_mov_b32 s28, s26
    s_and_b32 s29, s27, 0xffff
    s_mov_b32 s30, 0x400000
    s_mov_b32 s31, 0x00020000
    s_add_u32 s24, s25, 0
    buffer_load_dwordx4 v[92:95], v124, s[28:31], s24 offen
    s_add_u32 s24, s25, 8192
    buffer_load_dwordx4 v[96:99], v124, s[28:31], s24 offen
    s_add_u32 s24, s25, 16384
    buffer_load_dwordx4 v[100:103], v124, s[28:31], s24 offen
    s_add_u32 s24, s25, 24576
    buffer_load_dwordx4 v[104:107], v124, s[28:31], s24 offen
    s_add_u32 s24, s25, 32768
    buffer_load_dwordx4 v[108:111], v124, s[28:31], s24 offen
    s_add_u32 s24, s25, 40960
    buffer_load_dwordx4 v[112:115], v124, s[28:31], s24 offen
    s_add_u32 s24, s25, 49152
    buffer_load_dwordx4 v[116:119], v124, s[28:31], s24 offen
    s_add_u32 s24, s25, 57344
    buffer_load_dwordx4 v[120:123], v124, s[28:31], s24 offen
L_mg_nt_3:
    s_getreg_b32 s16, hwreg(HW_REG_XCC_ID)
    s_and_b32 s16, s16, 7
    s_cmp_lg_u32 s14, 0
    s_cbranch_scc1 L_e3_wait_4
    s_lshl_b32 s17, s16, 3
    s_lshl_b64 s[24:25], 1, s17
    v_mov_b32 v20, s24
    v_mov_b32 v21, s25
    v_mov_b32 v22, 0
    s_mov_b64 exec, 1
    global_atomic_add_x2 v[24:25], v22, v[20:21], s[12:13] sc0
    s_waitcnt vmcnt(0)
    v_mov_b32 v22, 148480
    ds_write_b64 v22, v[24:25]
    v_readfirstlane_b32 s18, v24
    v_readfirstlane_b32 s19, v25
    s_lshr_b64 s[20:21], s[18:19], s17
    s_and_b32 s21, s20, 0xff
    s_mov_b32 s26, 1
    s_cmp_eq_u32 s16, 0
    s_cselect_b32 s27, s21, 0
    s_cmp_eq_u32 s27, 31
    s_cbranch_scc1 L_e3_decl_6
    s_add_u32 s24, s18, s24
    s_addc_u32 s25, s19, s25
    s_and_b32 s27, s24, 0x00ff00ff
    s_lshr_b32 s28, s24, 8
    s_and_b32 s28, s28, 0x00ff00ff
    s_add_u32 s27, s27, s28
    s_and_b32 s28, s25, 0x00ff00ff
    s_add_u32 s27, s27, s28
    s_lshr_b32 s28, s25, 8
    s_and_b32 s28, s28, 0x00ff00ff
    s_add_u32 s27, s27, s28
    s_lshr_b32 s28, s27, 16
    s_and_b32 s27, s27, 0xffff
    s_add_u32 s27, s27, s28
    s_cmp_lg_u32 s27, 256
    s_cbranch_scc1 L_e3_nd_5
    s_lshr_b64 s[28:29], s[24:25], 0
    s_and_b32 s28, s28, 0xff
    s_cmp_ge_u32 s28, 32
    s_cbranch_scc1 L_e3_nd_5
    s_mov_b32 s26, 1
L_e3_fb_7:
    s_and_b32 s28, s24, 0xff
    s_cmp_ge_u32 s28, 32
    s_cbranch_scc1 L_e3_decl_6
    s_lshr_b64 s[24:25], s[24:25], 8
    s_add_u32 s26, s26, 1
    s_cmp_le_u32 s26, 8
    s_cbranch_scc1 L_e3_fb_7
L_e3_decl_6:
    v_mov_b32 v24, s26
    v_mov_b32 v22, 32
    global_store_dword v22, v24, s[12:13] sc1
L_e3_nd_5:
    s_mov_b64 exec, -1
    s_waitcnt lgkmcnt(0)
L_e3_wait_4:
    s_barrier
    v_mov_b32 v22, 148480
    ds_read_b64 v[24:25], v22
    s_waitcnt lgkmcnt(0)
    v_readfirstlane_b32 s18, v24
    v_readfirstlane_b32 s19, v25
    s_lshl_b32 s17, s16, 3
    s_lshr_b64 s[20:21], s[18:19], s17
    s_and_b32 s21, s20, 0xff
    s_mov_b32 s76, s18
    s_mov_b32 s77, s19
    s_mov_b32 s78, s16
    s_mov_b32 s79, s21
    s_barrier
    s_mov_b32 s75, 1
    s_mov_b32 s15, s79
    s_cmp_eq_u32 s78, 0
    s_cselect_b32 s24, s79, 0xffff
    s_cmp_lt_u32 s24, 32
    s_cbranch_scc1 L_mg_chain_8
L_mg_res_9:
    s_cmp_lg_u32 s14, 0
    s_cbranch_scc1 L_mg_r0_10
    v_mov_b32 v24, 32
L_e3_spin_11:
    global_load_dword v25, v24, s[12:13] sc1
    s_waitcnt vmcnt(0)
    v_readfirstlane_b32 s24, v25
    s_cmp_lg_u32 s24, 0
    s_cbranch_scc1 L_e3_got_12
    s_sleep 3
    s_branch L_e3_spin_11
L_e3_got_12:
    s_sub_u32 s24, s24, 1
    s_and_b32 s25, s76, 0x00ff00ff
    s_lshr_b32 s26, s76, 8
    s_and_b32 s26, s26, 0x00ff00ff
    s_add_u32 s25, s25, s26
    s_and_b32 s26, s77, 0x00ff00ff
    s_add_u32 s25, s25, s26
    s_lshr_b32 s26, s77, 8
    s_and_b32 s26, s26, 0x00ff00ff
    s_add_u32 s25, s25, s26
    s_lshr_b32 s26, s25, 16
    s_and_b32 s25, s25, 0xffff
    s_add_u32 s25, s25, s26
    s_lshl_b32 s26, s24, 3
    s_lshr_b64 s[26:27], s[76:77], s26
    s_and_b32 s26, s26, 0xff
    s_min_u32 s26, s26, 32
    s_sub_u32 s90, s25, s26
    s_cmp_eq_u32 s24, s78
    s_cselect_b32 s15, s79, 0xffff
    s_cmp_lt_u32 s15, 32
    s_cselect_b32 s15, s15, 0xffff
    v_mov_b32 v24, s15
    v_mov_b32 v25, s90
    v_mov_b32 v22, 148496
    ds_write_b64 v22, v[24:25]
    s_waitcnt lgkmcnt(0)
L_mg_r0_10:
    s_barrier
    v_mov_b32 v22, 148496
    ds_read_b64 v[24:25], v22
    s_waitcnt lgkmcnt(0)
    v_readfirstlane_b32 s15, v24
    v_readfirstlane_b32 s90, v25
    s_barrier
    s_mov_b32 s75, 0
    s_cmp_ge_u32 s15, 32
    s_cbranch_scc1 L_mg_worker_2
L_mg_chain_8:
    v_and_b32 v40, 63, v0
    v_and_b32 v41, 15, v40
    v_lshrrev_b32 v42, 4, v40
    v_and_b32 v43, 1, v42
    v_lshrrev_b32 v44, 1, v42
    s_mov_b32 s30, 0x05040100
    s_mov_b32 s31, 0x07060302
    s_and_b32 s20, s14, 3
    s_mov_b32 s48, 0
    s_mov_b32 s80, 0
    s_mov_b32 s88, 0
    s_lshl_b32 s81, s15, 7
    s_add_u32 s81, s81, 0x5810000
    v_mov_b32 v46, 0x4444
    v_mov_b32 v47, 0xeeee
    v_and_b32 v45, 1, v41
    v_cmp_eq_u32 vcc, 0, v45
    s_nop 1
    v_cndmask_b32 v2, v47, v46, vcc
    v_lshlrev_b32 v1, 4, v40
    v_add_u32 v1, 131072, v1
    v_lshlrev_b32 v45, 20, v44
    v_lshl_add_u32 v45, v43, 16, v45
    s_lshl_b32 s19, s15, 8
    v_add_u32 v45, s19, v45
    s_cmp_ge_u32 s14, 4
    s_cbranch_scc1 L_c8_B_14
    s_cmp_lg_u32 s20, 0
    s_cbranch_scc1 L_cA_q0_16
    s_cmp_eq_u32 s75, 0
    s_cbranch_scc1 L_cf_ok_17
    v_mov_b32 v50, 32
L_e3_spin_18:
    global_load_dword v51, v50, s[12:13] sc1
    s_waitcnt vmcnt(0)
    v_readfirstlane_b32 s24, v51
    s_cmp_lg_u32 s24, 0
    s_cbranch_scc1 L_e3_got_19
    s_sleep 3
    s_branch L_e3_spin_18
L_e3_got_19:
    s_sub_u32 s24, s24, 1
    s_and_b32 s25, s76, 0x00ff00ff
    s_lshr_b32 s26, s76, 8
    s_and_b32 s26, s26, 0x00ff00ff
    s_add_u32 s25, s25, s26
    s_and_b32 s26, s77, 0x00ff00ff
    s_add_u32 s25, s25, s26
    s_lshr_b32 s26, s77, 8
    s_and_b32 s26, s26, 0x00ff00ff
    s_add_u32 s25, s25, s26
    s_lshr_b32 s26, s25, 16
    s_and_b32 s25, s25, 0xffff
    s_add_u32 s25, s25, s26
    s_lshl_b32 s26, s24, 3
    s_lshr_b64 s[26:27], s[76:77], s26
    s_and_b32 s26, s26, 0xff
    s_min_u32 s26, s26, 32
    s_sub_u32 s90, s25, s26
    s_cmp_eq_u32 s24, s78
    s_cselect_b32 s15, s79, 0xffff
    s_cmp_lt_u32 s15, 32
    s_cselect_b32 s15, s15, 0xffff
    s_mov_b32 s75, 0
    s_cmp_lt_u32 s15, 32
    s_cbranch_scc1 L_cf_ok_17
    s_waitcnt vmcnt(0) lgkmcnt(0)
    v_mbcnt_lo_u32_b32 v0, -1, 0
    v_mbcnt_hi_u32_b32 v0, -1, v0
    s_lshl_b32 s24, s14, 6
    v_add_u32 v0, s24, v0
    s_branch L_mg_div_13
L_cf_ok_17:
    s_mov_b64 exec, 1
    v_mov_b32 v50, 0
    v_mov_b32 v51, 0
    v_mov_b32 v52, 0
    v_mov_b32 v53, 0
    buffer_store_dwordx4 v[50:53], v50, s[4:7], s81 offen sc1
    s_waitcnt vmcnt(0)
    v_mov_b32 v51, 1
    v_mov_b32 v50, 56
    global_atomic_add v50, v51, s[12:13]
    s_mov_b64 exec, -1
L_cA_q0_16:
    v_lshlrev_b32 v9, 4, v0
    s_lshl_b32 s18, s20, 14
    v_lshlrev_b32 v0, 4, v40
    v_add_u32 v0, s18, v0
    s_lshr_b32 s18, s20, 1
    s_lshl_b32 s18, s18, 3
    v_lshlrev_b32 v50, 1, v42
    v_add_u32 v50, s18, v50
    v_mul_u32_u24 v50, 288, v50
    s_and_b32 s18, s20, 1
    s_lshl_b32 s18, s18, 7
    s_add_u32 s18, s18, 139264
    v_lshl_add_u32 v50, v41, 3, v50
    v_add_u32 v3, s18, v50
    v_lshrrev_b32 v50, 1, v41
    v_mul_u32_u24 v50, 288, v50
    v_lshl_add_u32 v50, v42, 4, v50
    v_add_u32 v4, 139264, v50
    v_lshrrev_b32 v50, 1, v41
    v_mul_u32_u24 v50, 288, v50
    v_lshl_add_u32 v50, v42, 4, v50
    s_lshl_b32 s18, s20, 6
    s_add_u32 s18, s18, 139264
    v_add_u32 v5, s18, v50
    v_and_b32 v50, 3, v41
    v_lshrrev_b32 v51, 3, v41
    v_lshl_add_u32 v50, v51, 2, v50
    v_lshlrev_b32 v50, 1, v50
    v_xor_b32 v50, v50, v42
    v_lshlrev_b32 v50, 4, v50
    v_lshl_add_u32 v50, v41, 8, v50
    v_add_u32 v6, 147456, v50
    v_lshlrev_b32 v50, 7, v41
    v_lshl_add_u32 v50, v42, 4, v50
    s_lshl_b32 s18, s15, 13
    s_lshl_b32 s19, s20, 11
    s_add_u32 s18, s18, s19
    s_add_u32 s18, s18, 0x2000000
    v_add_u32 v7, s18, v50
    v_lshlrev_b32 v50, 2, v42
    v_lshl_add_u32 v50, v41, 5, v50
    s_lshl_b32 s18, s20, 9
    s_add_u32 s18, s18, 144896
    v_add_u32 v8, s18, v50
    s_lshr_b32 s18, s20, 1
    s_lshl_b32 s18, s18, 3
    s_add_u32 s18, s18, 16
    s_load_dwordx2 s[24:25], s[0:1], s18
    s_and_b32 s18, s20, 1
    s_lshl_b32 s18, s18, 7
    v_lshl_add_u32 v30, v41, 3, v45
    v_add_u32 v30, s18, v30
    s_waitcnt lgkmcnt(0)
    s_mov_b32 s8, s24
    s_and_b32 s9, s25, 0xffff
    s_mov_b32 s10, 0x400000
    s_mov_b32 s11, 0x00020000
    s_mov_b32 s18, 0
    buffer_load_dwordx2 v[32:33], v30, s[8:11], s18 offen
    s_mov_b32 s18, 8192
    buffer_load_dwordx2 v[34:35], v30, s[8:11], s18 offen
    s_mov_b32 s18, 131072
    buffer_load_dwordx2 v[36:37], v30, s[8:11], s18 offen
    s_mov_b32 s18, 139264
    buffer_load_dwordx2 v[38:39], v30, s[8:11], s18 offen
    s_mov_b32 s18, 16384
    buffer_load_dwordx2 v[40:41], v30, s[8:11], s18 offen
    s_mov_b32 s18, 24576
    buffer_load_dwordx2 v[42:43], v30, s[8:11], s18 offen
    s_mov_b32 s18, 147456
    buffer_load_dwordx2 v[44:45], v30, s[8:11], s18 offen
    s_mov_b32 s18, 155648
    buffer_load_dwordx2 v[46:47], v30, s[8:11], s18 offen
    s_mov_b32 s18, 2097152
    buffer_load_dwordx2 v[48:49], v30, s[8:11], s18 offen
    s_mov_b32 s18, 2105344
    buffer_load_dwordx2 v[50:51], v30, s[8:11], s18 offen
    s_mov_b32 s18, 2228224
    buffer_load_dwordx2 v[52:53], v30, s[8:11], s18 offen
    s_mov_b32 s18, 2236416
    buffer_load_dwordx2 v[54:55], v30, s[8:11], s18 offen
    s_mov_b32 s18, 2113536
    buffer_load_dwordx2 v[56:57], v30, s[8:11], s18 offen
    s_mov_b32 s18, 2121728
    buffer_load_dwordx2 v[58:59], v30, s[8:11], s18 offen
    s_mov_b32 s18, 2244608
    buffer_load_dwordx2 v[60:61], v30, s[8:11], s18 offen
    s_mov_b32 s18, 2252800
    buffer_load_dwordx2 v[62:63], v30, s[8:11], s18 offen
    s_mov_b32 s18, 262144
    buffer_load_dwordx2 v[12:13], v30, s[8:11], s18 offen
    s_mov_b32 s18, 270336
    buffer_load_dwordx2 v[14:15], v30, s[8:11], s18 offen
    s_mov_b32 s18, 393216
    buffer_load_dwordx2 v[16:17], v30, s[8:11], s18 offen
    s_mov_b32 s18, 401408
    buffer_load_dwordx2 v[18:19], v30, s[8:11], s18 offen
    s_mov_b32 s18, 278528
    buffer_load_dwordx2 v[20:21], v30, s[8:11], s18 offen
    s_mov_b32 s18, 286720
    buffer_load_dwordx2 v[22:23], v30, s[8:11], s18 offen
    s_mov_b32 s18, 409600
    buffer_load_dwordx2 v[24:25], v30, s[8:11], s18 offen
    s_mov_b32 s18, 417792
    buffer_load_dwordx2 v[26:27], v30, s[8:11], s18 offen
    s_waitcnt vmcnt(16)
    v_perm_b32 v31, v34, v32, s30
    v_accvgpr_write_b32 a0, v31
    v_perm_b32 v31, v38, v36, s30
    v_accvgpr_write_b32 a1, v31
    v_perm_b32 v31, v42, v40, s30
    v_accvgpr_write_b32 a2, v31
    v_perm_b32 v31, v46, v44, s30
    v_accvgpr_write_b32 a3, v31
    v_perm_b32 v31, v34, v32, s31
    v_accvgpr_write_b32 a64, v31
    v_perm_b32 v31, v38, v36, s31
    v_accvgpr_write_b32 a65, v31
    v_perm_b32 v31, v42, v40, s31
    v_accvgpr_write_b32 a66, v31
    v_perm_b32 v31, v46, v44, s31
    v_accvgpr_write_b32 a67, v31
    v_perm_b32 v64, v35, v33, s30
    v_perm_b32 v65, v39, v37, s30
    v_perm_b32 v66, v43, v41, s30
    v_perm_b32 v67, v47, v45, s30
    v_perm_b32 v28, v35, v33, s31
    v_perm_b32 v29, v39, v37, s31
    ds_write_b64 v0, v[28:29] offset:0
    s_nop 0
    v_perm_b32 v28, v43, v41, s31
    v_perm_b32 v29, v47, v45, s31
    ds_write_b64 v0, v[28:29] offset:8
    s_nop 0
    s_mov_b32 s18, 2359296
    buffer_load_dwordx2 v[32:33], v30, s[8:11], s18 offen
    s_mov_b32 s18, 2367488
    buffer_load_dwordx2 v[34:35], v30, s[8:11], s18 offen
    s_mov_b32 s18, 2490368
    buffer_load_dwordx2 v[36:37], v30, s[8:11], s18 offen
    s_mov_b32 s18, 2498560
    buffer_load_dwordx2 v[38:39], v30, s[8:11], s18 offen
    s_mov_b32 s18, 2375680
    buffer_load_dwordx2 v[40:41], v30, s[8:11], s18 offen
    s_mov_b32 s18, 2383872
    buffer_load_dwordx2 v[42:43], v30, s[8:11], s18 offen
    s_mov_b32 s18, 2506752
    buffer_load_dwordx2 v[44:45], v30, s[8:11], s18 offen
    s_mov_b32 s18, 2514944
    buffer_load_dwordx2 v[46:47], v30, s[8:11], s18 offen
    s_waitcnt vmcnt(16)
    v_perm_b32 v31, v50, v48, s30
    v_accvgpr_write_b32 a4, v31
    v_perm_b32 v31, v54, v52, s30
    v_accvgpr_write_b32 a5, v31
    v_perm_b32 v31, v58, v56, s30
    v_accvgpr_write_b32 a6, v31
    v_perm_b32 v31, v62, v60, s30
    v_accvgpr_write_b32 a7, v31
    v_perm_b32 v31, v50, v48, s31
    v_accvgpr_write_b32 a68, v31
    v_perm_b32 v31, v54, v52, s31
    v_accvgpr_write_b32 a69, v31
    v_perm_b32 v31, v58, v56, s31
    v_accvgpr_write_b32 a70, v31
    v_perm_b32 v31, v62, v60, s31
    v_accvgpr_write_b32 a71, v31
    v_perm_b32 v68, v51, v49, s30
    v_perm_b32 v69, v55, v53, s30
    v_perm_b32 v70, v59, v57, s30
    v_perm_b32 v71, v63, v61, s30
    v_perm_b32 v28, v51, v49, s31
    v_perm_b32 v29, v55, v53, s31
    ds_write_b64 v0, v[28:29] offset:1024
    s_nop 0
    v_perm_b32 v28, v59, v57, s31
    v_perm_b32 v29, v63, v61, s31
    ds_write_b64 v0, v[28:29] offset:1032
    s_nop 0
    s_mov_b32 s18, 524288
    buffer_load_dwordx2 v[48:49], v30, s[8:11], s18 offen
    s_mov_b32 s18, 532480
    buffer_load_dwordx2 v[50:51], v30, s[8:11], s18 offen
    s_mov_b32 s18, 655360
    buffer_load_dwordx2 v[52:53], v30, s[8:11], s18 offen
    s_mov_b32 s18, 663552
    buffer_load_dwordx2 v[54:55], v30, s[8:11], s18 offen
    s_mov_b32 s18, 540672
    buffer_load_dwordx2 v[56:57], v30, s[8:11], s18 offen
    s_mov_b32 s18, 548864
    buffer_load_dwordx2 v[58:59], v30, s[8:11], s18 offen
    s_mov_b32 s18, 671744
    buffer_load_dwordx2 v[60:61], v30, s[8:11], s18 offen
    s_mov_b32 s18, 679936
    buffer_load_dwordx2 v[62:63], v30, s[8:11], s18 offen
    s_waitcnt vmcnt(16)
    v_perm_b32 v31, v14, v12, s30
    v_accvgpr_write_b32 a8, v31
    v_perm_b32 v31, v18, v16, s30
    v_accvgpr_write_b32 a9, v31
    v_perm_b32 v31, v22, v20, s30
    v_accvgpr_write_b32 a10, v31
    v_perm_b32 v31, v26, v24, s30
    v_accvgpr_write_b32 a11, v31
    v_perm_b32 v31, v14, v12, s31
    v_accvgpr_write_b32 a72, v31
    v_perm_b32 v31, v18, v16, s31
    v_accvgpr_write_b32 a73, v31
    v_perm_b32 v31, v22, v20, s31
    v_accvgpr_write_b32 a74, v31
    v_perm_b32 v31, v26, v24, s31
    v_accvgpr_write_b32 a75, v31
    v_perm_b32 v72, v15, v13, s30
    v_perm_b32 v73, v19, v17, s30
    v_perm_b32 v74, v23, v21, s30
    v_perm_b32 v75, v27, v25, s30
    v_perm_b32 v28, v15, v13, s31
    v_perm_b32 v29, v19, v17, s31
    ds_write_b64 v0, v[28:29] offset:2048
    s_nop 0
    v_perm_b32 v28, v23, v21, s31
    v_perm_b32 v29, v27, v25, s31
    ds_write_b64 v0, v[28:29] offset:2056
    s_nop 0
    s_mov_b32 s18, 2621440
    buffer_load_dwordx2 v[12:13], v30, s[8:11], s18 offen
    s_mov_b32 s18, 2629632
    buffer_load_dwordx2 v[14:15], v30, s[8:11], s18 offen
    s_mov_b32 s18, 2752512
    buffer_load_dwordx2 v[16:17], v30, s[8:11], s18 offen
    s_mov_b32 s18, 2760704
    buffer_load_dwordx2 v[18:19], v30, s[8:11], s18 offen
    s_mov_b32 s18, 2637824
    buffer_load_dwordx2 v[20:21], v30, s[8:11], s18 offen
    s_mov_b32 s18, 2646016
    buffer_load_dwordx2 v[22:23], v30, s[8:11], s18 offen
    s_mov_b32 s18, 2768896
    buffer_load_dwordx2 v[24:25], v30, s[8:11], s18 offen
    s_mov_b32 s18, 2777088
    buffer_load_dwordx2 v[26:27], v30, s[8:11], s18 offen
    s_waitcnt vmcnt(16)
    v_perm_b32 v31, v34, v32, s30
    v_accvgpr_write_b32 a12, v31
    v_perm_b32 v31, v38, v36, s30
    v_accvgpr_write_b32 a13, v31
    v_perm_b32 v31, v42, v40, s30
    v_accvgpr_write_b32 a14, v31
    v_perm_b32 v31, v46, v44, s30
    v_accvgpr_write_b32 a15, v31
    v_perm_b32 v31, v34, v32, s31
    v_accvgpr_write_b32 a76, v31
    v_perm_b32 v31, v38, v36, s31
    v_accvgpr_write_b32 a77, v31
    v_perm_b32 v31, v42, v40, s31
    v_accvgpr_write_b32 a78, v31
    v_perm_b32 v31, v46, v44, s31
    v_accvgpr_write_b32 a79, v31
    v_perm_b32 v76, v35, v33, s30
    v_perm_b32 v77, v39, v37, s30
    v_perm_b32 v78, v43, v41, s30
    v_perm_b32 v79, v47, v45, s30
    v_perm_b32 v28, v35, v33, s31
    v_perm_b32 v29, v39, v37, s31
    ds_write_b64 v0, v[28:29] offset:3072
    s_nop 0
    v_perm_b32 v28, v43, v41, s31
    v_perm_b32 v29, v47, v45, s31
    ds_write_b64 v0, v[28:29] offset:3080
    s_nop 0
    s_mov_b32 s18, 786432
    buffer_load_dwordx2 v[32:33], v30, s[8:11], s18 offen
    s_mov_b32 s18, 794624
    buffer_load_dwordx2 v[34:35], v30, s[8:11], s18 offen
    s_mov_b32 s18, 917504
    buffer_load_dwordx2 v[36:37], v30, s[8:11], s18 offen
    s_mov_b32 s18, 925696
    buffer_load_dwordx2 v[38:39], v30, s[8:11], s18 offen
    s_mov_b32 s18, 802816
    buffer_load_dwordx2 v[40:41], v30, s[8:11], s18 offen
    s_mov_b32 s18, 811008
    buffer_load_dwordx2 v[42:43], v30, s[8:11], s18 offen
    s_mov_b32 s18, 933888
    buffer_load_dwordx2 v[44:45], v30, s[8:11], s18 offen
    s_mov_b32 s18, 942080
    buffer_load_dwordx2 v[46:47], v30, s[8:11], s18 offen
    s_waitcnt vmcnt(16)
    v_perm_b32 v31, v50, v48, s30
    v_accvgpr_write_b32 a16, v31
    v_perm_b32 v31, v54, v52, s30
    v_accvgpr_write_b32 a17, v31
    v_perm_b32 v31, v58, v56, s30
    v_accvgpr_write_b32 a18, v31
    v_perm_b32 v31, v62, v60, s30
    v_accvgpr_write_b32 a19, v31
    v_perm_b32 v31, v50, v48, s31
    v_accvgpr_write_b32 a80, v31
    v_perm_b32 v31, v54, v52, s31
    v_accvgpr_write_b32 a81, v31
    v_perm_b32 v31, v58, v56, s31
    v_accvgpr_write_b32 a82, v31
    v_perm_b32 v31, v62, v60, s31
    v_accvgpr_write_b32 a83, v31
    v_perm_b32 v80, v51, v49, s30
    v_perm_b32 v81, v55, v53, s30
    v_perm_b32 v82, v59, v57, s30
    v_perm_b32 v83, v63, v61, s30
    v_perm_b32 v28, v51, v49, s31
    v_perm_b32 v29, v55, v53, s31
    ds_write_b64 v0, v[28:29] offset:4096
    s_nop 0
    v_perm_b32 v28, v59, v57, s31
    v_perm_b32 v29, v63, v61, s31
    ds_write_b64 v0, v[28:29] offset:4104
    s_nop 0
    s_mov_b32 s18, 2883584
    buffer_load_dwordx2 v[48:49], v30, s[8:11], s18 offen
    s_mov_b32 s18, 2891776
    buffer_load_dwordx2 v[50:51], v30, s[8:11], s18 offen
    s_mov_b32 s18, 3014656
    buffer_load_dwordx2 v[52:53], v30, s[8:11], s18 offen
    s_mov_b32 s18, 3022848
    buffer_load_dwordx2 v[54:55], v30, s[8:11], s18 offen
    s_mov_b32 s18, 2899968
    buffer_load_dwordx2 v[56:57], v30, s[8:11], s18 offen
    s_mov_b32 s18, 2908160
    buffer_load_dwordx2 v[58:59], v30, s[8:11], s18 offen
    s_mov_b32 s18, 3031040
    buffer_load_dwordx2 v[60:61], v30, s[8:11], s18 offen
    s_mov_b32 s18, 3039232
    buffer_load_dwordx2 v[62:63], v30, s[8:11], s18 offen
    s_waitcnt vmcnt(16)
    v_perm_b32 v31, v14, v12, s30
    v_accvgpr_write_b32 a20, v31
    v_perm_b32 v31, v18, v16, s30
    v_accvgpr_write_b32 a21, v31
    v_perm_b32 v31, v22, v20, s30
    v_accvgpr_write_b32 a22, v31
    v_perm_b32 v31, v26, v24, s30
    v_accvgpr_write_b32 a23, v31
    v_perm_b32 v31, v14, v12, s31
    v_accvgpr_write_b32 a84, v31
    v_perm_b32 v31, v18, v16, s31
    v_accvgpr_write_b32 a85, v31
    v_perm_b32 v31, v22, v20, s31
    v_accvgpr_write_b32 a86, v31
    v_perm_b32 v31, v26, v24, s31
    v_accvgpr_write_b32 a87, v31
    v_perm_b32 v84, v15, v13, s30
    v_perm_b32 v85, v19, v17, s30
    v_perm_b32 v86, v23, v21, s30
    v_perm_b32 v87, v27, v25, s30
    v_perm_b32 v28, v15, v13, s31
    v_perm_b32 v29, v19, v17, s31
    ds_write_b64 v0, v[28:29] offset:5120
    s_nop 0
    v_perm_b32 v28, v23, v21, s31
    v_perm_b32 v29, v27, v25, s31
    ds_write_b64 v0, v[28:29] offset:5128
    s_nop 0
    s_mov_b32 s18, 32768
    buffer_load_dwordx2 v[12:13], v30, s[8:11], s18 offen
    s_mov_b32 s18, 40960
    buffer_load_dwordx2 v[14:15], v30, s[8:11], s18 offen
    s_mov_b32 s18, 163840
    buffer_load_dwordx2 v[16:17], v30, s[8:11], s18 offen
    s_mov_b32 s18, 172032
    buffer_load_dwordx2 v[18:19], v30, s[8:11], s18 offen
    s_mov_b32 s18, 49152
    buffer_load_dwordx2 v[20:21], v30, s[8:11], s18 offen
    s_mov_b32 s18, 57344
    buffer_load_dwordx2 v[22:23], v30, s[8:11], s18 offen
    s_mov_b32 s18, 180224
    buffer_load_dwordx2 v[24:25], v30, s[8:11], s18 offen
    s_mov_b32 s18, 188416
    buffer_load_dwordx2 v[26:27], v30, s[8:11], s18 offen
    s_waitcnt vmcnt(16)
    v_perm_b32 v31, v34, v32, s30
    v_accvgpr_write_b32 a24, v31
    v_perm_b32 v31, v38, v36, s30
    v_accvgpr_write_b32 a25, v31
    v_perm_b32 v31, v42, v40, s30
    v_accvgpr_write_b32 a26, v31
    v_perm_b32 v31, v46, v44, s30
    v_accvgpr_write_b32 a27, v31
    v_perm_b32 v31, v34, v32, s31
    v_accvgpr_write_b32 a88, v31
    v_perm_b32 v31, v38, v36, s31
    v_accvgpr_write_b32 a89, v31
    v_perm_b32 v31, v42, v40, s31
    v_accvgpr_write_b32 a90, v31
    v_perm_b32 v31, v46, v44, s31
    v_accvgpr_write_b32 a91, v31
    v_perm_b32 v88, v35, v33, s30
    v_perm_b32 v89, v39, v37, s30
    v_perm_b32 v90, v43, v41, s30
    v_perm_b32 v91, v47, v45, s30
    v_perm_b32 v28, v35, v33, s31
    v_perm_b32 v29, v39, v37, s31
    ds_write_b64 v0, v[28:29] offset:6144
    s_nop 0
    v_perm_b32 v28, v43, v41, s31
    v_perm_b32 v29, v47, v45, s31
    ds_write_b64 v0, v[28:29] offset:6152
    s_nop 0
    s_mov_b32 s18, 2129920
    buffer_load_dwordx2 v[32:33], v30, s[8:11], s18 offen
    s_mov_b32 s18, 2138112
    buffer_load_dwordx2 v[34:35], v30, s[8:11], s18 offen
    s_mov_b32 s18, 2260992
    buffer_load_dwordx2 v[36:37], v30, s[8:11], s18 offen
    s_mov_b32 s18, 2269184
    buffer_load_dwordx2 v[38:39], v30, s[8:11], s18 offen
    s_mov_b32 s18, 2146304
    buffer_load_dwordx2 v[40:41], v30, s[8:11], s18 offen
    s_mov_b32 s18, 2154496
    buffer_load_dwordx2 v[42:43], v30, s[8:11], s18 offen
    s_mov_b32 s18, 2277376
    buffer_load_dwordx2 v[44:45], v30, s[8:11], s18 offen
    s_mov_b32 s18, 2285568
    buffer_load_dwordx2 v[46:47], v30, s[8:11], s18 offen
    s_waitcnt vmcnt(16)
    v_perm_b32 v31, v50, v48, s30
    v_accvgpr_write_b32 a28, v31
    v_perm_b32 v31, v54, v52, s30
    v_accvgpr_write_b32 a29, v31
    v_perm_b32 v31, v58, v56, s30
    v_accvgpr_write_b32 a30, v31
    v_perm_b32 v31, v62, v60, s30
    v_accvgpr_write_b32 a31, v31
    v_perm_b32 v31, v50, v48, s31
    v_accvgpr_write_b32 a92, v31
    v_perm_b32 v31, v54, v52, s31
    v_accvgpr_write_b32 a93, v31
    v_perm_b32 v31, v58, v56, s31
    v_accvgpr_write_b32 a94, v31
    v_perm_b32 v31, v62, v60, s31
    v_accvgpr_write_b32 a95, v31
    v_perm_b32 v92, v51, v49, s30
    v_perm_b32 v93, v55, v53, s30
    v_perm_b32 v94, v59, v57, s30
    v_perm_b32 v95, v63, v61, s30
    v_perm_b32 v28, v51, v49, s31
    v_perm_b32 v29, v55, v53, s31
    ds_write_b64 v0, v[28:29] offset:7168
    s_nop 0
    v_perm_b32 v28, v59, v57, s31
    v_perm_b32 v29, v63, v61, s31
    ds_write_b64 v0, v[28:29] offset:7176
    s_nop 0
    s_mov_b32 s18, 294912
    buffer_load_dwordx2 v[48:49], v30, s[8:11], s18 offen
    s_mov_b32 s18, 303104
    buffer_load_dwordx2 v[50:51], v30, s[8:11], s18 offen
    s_mov_b32 s18, 425984
    buffer_load_dwordx2 v[52:53], v30, s[8:11], s18 offen
    s_mov_b32 s18, 434176
    buffer_load_dwordx2 v[54:55], v30, s[8:11], s18 offen
    s_mov_b32 s18, 311296
    buffer_load_dwordx2 v[56:57], v30, s[8:11], s18 offen
    s_mov_b32 s18, 319488
    buffer_load_dwordx2 v[58:59], v30, s[8:11], s18 offen
    s_mov_b32 s18, 442368
    buffer_load_dwordx2 v[60:61], v30, s[8:11], s18 offen
    s_mov_b32 s18, 450560
    buffer_load_dwordx2 v[62:63], v30, s[8:11], s18 offen
    s_waitcnt vmcnt(16)
    v_perm_b32 v31, v14, v12, s30
    v_accvgpr_write_b32 a32, v31
    v_perm_b32 v31, v18, v16, s30
    v_accvgpr_write_b32 a33, v31
    v_perm_b32 v31, v22, v20, s30
    v_accvgpr_write_b32 a34, v31
    v_perm_b32 v31, v26, v24, s30
    v_accvgpr_write_b32 a35, v31
    v_perm_b32 v31, v14, v12, s31
    v_accvgpr_write_b32 a96, v31
    v_perm_b32 v31, v18, v16, s31
    v_accvgpr_write_b32 a97, v31
    v_perm_b32 v31, v22, v20, s31
    v_accvgpr_write_b32 a98, v31
    v_perm_b32 v31, v26, v24, s31
    v_accvgpr_write_b32 a99, v31
    v_perm_b32 v96, v15, v13, s30
    v_perm_b32 v97, v19, v17, s30
    v_perm_b32 v98, v23, v21, s30
    v_perm_b32 v99, v27, v25, s30
    v_perm_b32 v28, v15, v13, s31
    v_perm_b32 v29, v19, v17, s31
    ds_write_b64 v0, v[28:29] offset:8192
    s_nop 0
    v_perm_b32 v28, v23, v21, s31
    v_perm_b32 v29, v27, v25, s31
    ds_write_b64 v0, v[28:29] offset:8200
    s_nop 0
    s_mov_b32 s18, 2392064
    buffer_load_dwordx2 v[12:13], v30, s[8:11], s18 offen
    s_mov_b32 s18, 2400256
    buffer_load_dwordx2 v[14:15], v30, s[8:11], s18 offen
    s_mov_b32 s18, 2523136
    buffer_load_dwordx2 v[16:17], v30, s[8:11], s18 offen
    s_mov_b32 s18, 2531328
    buffer_load_dwordx2 v[18:19], v30, s[8:11], s18 offen
    s_mov_b32 s18, 2408448
    buffer_load_dwordx2 v[20:21], v30, s[8:11], s18 offen
    s_mov_b32 s18, 2416640
    buffer_load_dwordx2 v[22:23], v30, s[8:11], s18 offen
    s_mov_b32 s18, 2539520
    buffer_load_dwordx2 v[24:25], v30, s[8:11], s18 offen
    s_mov_b32 s18, 2547712
    buffer_load_dwordx2 v[26:27], v30, s[8:11], s18 offen
    s_waitcnt vmcnt(16)
    v_perm_b32 v31, v34, v32, s30
    v_accvgpr_write_b32 a36, v31
    v_perm_b32 v31, v38, v36, s30
    v_accvgpr_write_b32 a37, v31
    v_perm_b32 v31, v42, v40, s30
    v_accvgpr_write_b32 a38, v31
    v_perm_b32 v31, v46, v44, s30
    v_accvgpr_write_b32 a39, v31
    v_perm_b32 v31, v34, v32, s31
    v_accvgpr_write_b32 a100, v31
    v_perm_b32 v31, v38, v36, s31
    v_accvgpr_write_b32 a101, v31
    v_perm_b32 v31, v42, v40, s31
    v_accvgpr_write_b32 a102, v31
    v_perm_b32 v31, v46, v44, s31
    v_accvgpr_write_b32 a103, v31
    v_perm_b32 v100, v35, v33, s30
    v_perm_b32 v101, v39, v37, s30
    v_perm_b32 v102, v43, v41, s30
    v_perm_b32 v103, v47, v45, s30
    v_perm_b32 v28, v35, v33, s31
    v_perm_b32 v29, v39, v37, s31
    ds_write_b64 v0, v[28:29] offset:9216
    s_nop 0
    v_perm_b32 v28, v43, v41, s31
    v_perm_b32 v29, v47, v45, s31
    ds_write_b64 v0, v[28:29] offset:9224
    s_nop 0
    s_mov_b32 s18, 557056
    buffer_load_dwordx2 v[32:33], v30, s[8:11], s18 offen
    s_mov_b32 s18, 565248
    buffer_load_dwordx2 v[34:35], v30, s[8:11], s18 offen
    s_mov_b32 s18, 688128
    buffer_load_dwordx2 v[36:37], v30, s[8:11], s18 offen
    s_mov_b32 s18, 696320
    buffer_load_dwordx2 v[38:39], v30, s[8:11], s18 offen
    s_mov_b32 s18, 573440
    buffer_load_dwordx2 v[40:41], v30, s[8:11], s18 offen
    s_mov_b32 s18, 581632
    buffer_load_dwordx2 v[42:43], v30, s[8:11], s18 offen
    s_mov_b32 s18, 704512
    buffer_load_dwordx2 v[44:45], v30, s[8:11], s18 offen
    s_mov_b32 s18, 712704
    buffer_load_dwordx2 v[46:47], v30, s[8:11], s18 offen
    s_waitcnt vmcnt(16)
    v_perm_b32 v31, v50, v48, s30
    v_accvgpr_write_b32 a40, v31
    v_perm_b32 v31, v54, v52, s30
    v_accvgpr_write_b32 a41, v31
    v_perm_b32 v31, v58, v56, s30
    v_accvgpr_write_b32 a42, v31
    v_perm_b32 v31, v62, v60, s30
    v_accvgpr_write_b32 a43, v31
    v_perm_b32 v31, v50, v48, s31
    v_accvgpr_write_b32 a104, v31
    v_perm_b32 v31, v54, v52, s31
    v_accvgpr_write_b32 a105, v31
    v_perm_b32 v31, v58, v56, s31
    v_accvgpr_write_b32 a106, v31
    v_perm_b32 v31, v62, v60, s31
    v_accvgpr_write_b32 a107, v31
    v_perm_b32 v104, v51, v49, s30
    v_perm_b32 v105, v55, v53, s30
    v_perm_b32 v106, v59, v57, s30
    v_perm_b32 v107, v63, v61, s30
    v_perm_b32 v28, v51, v49, s31
    v_perm_b32 v29, v55, v53, s31
    ds_write_b64 v0, v[28:29] offset:10240
    s_nop 0
    v_perm_b32 v28, v59, v57, s31
    v_perm_b32 v29, v63, v61, s31
    ds_write_b64 v0, v[28:29] offset:10248
    s_nop 0
    s_mov_b32 s18, 2654208
    buffer_load_dwordx2 v[48:49], v30, s[8:11], s18 offen
    s_mov_b32 s18, 2662400
    buffer_load_dwordx2 v[50:51], v30, s[8:11], s18 offen
    s_mov_b32 s18, 2785280
    buffer_load_dwordx2 v[52:53], v30, s[8:11], s18 offen
    s_mov_b32 s18, 2793472
    buffer_load_dwordx2 v[54:55], v30, s[8:11], s18 offen
    s_mov_b32 s18, 2670592
    buffer_load_dwordx2 v[56:57], v30, s[8:11], s18 offen
    s_mov_b32 s18, 2678784
    buffer_load_dwordx2 v[58:59], v30, s[8:11], s18 offen
    s_mov_b32 s18, 2801664
    buffer_load_dwordx2 v[60:61], v30, s[8:11], s18 offen
    s_mov_b32 s18, 2809856
    buffer_load_dwordx2 v[62:63], v30, s[8:11], s18 offen
    s_waitcnt vmcnt(16)
    v_perm_b32 v31, v14, v12, s30
    v_accvgpr_write_b32 a44, v31
    v_perm_b32 v31, v18, v16, s30
    v_accvgpr_write_b32 a45, v31
    v_perm_b32 v31, v22, v20, s30
    v_accvgpr_write_b32 a46, v31
    v_perm_b32 v31, v26, v24, s30
    v_accvgpr_write_b32 a47, v31
    v_perm_b32 v31, v14, v12, s31
    v_accvgpr_write_b32 a108, v31
    v_perm_b32 v31, v18, v16, s31
    v_accvgpr_write_b32 a109, v31
    v_perm_b32 v31, v22, v20, s31
    v_accvgpr_write_b32 a110, v31
    v_perm_b32 v31, v26, v24, s31
    v_accvgpr_write_b32 a111, v31
    v_perm_b32 v108, v15, v13, s30
    v_perm_b32 v109, v19, v17, s30
    v_perm_b32 v110, v23, v21, s30
    v_perm_b32 v111, v27, v25, s30
    v_perm_b32 v28, v15, v13, s31
    v_perm_b32 v29, v19, v17, s31
    ds_write_b64 v0, v[28:29] offset:11264
    s_nop 0
    v_perm_b32 v28, v23, v21, s31
    v_perm_b32 v29, v27, v25, s31
    ds_write_b64 v0, v[28:29] offset:11272
    s_nop 0
    s_mov_b32 s18, 819200
    buffer_load_dwordx2 v[12:13], v30, s[8:11], s18 offen
    s_mov_b32 s18, 827392
    buffer_load_dwordx2 v[14:15], v30, s[8:11], s18 offen
    s_mov_b32 s18, 950272
    buffer_load_dwordx2 v[16:17], v30, s[8:11], s18 offen
    s_mov_b32 s18, 958464
    buffer_load_dwordx2 v[18:19], v30, s[8:11], s18 offen
    s_mov_b32 s18, 835584
    buffer_load_dwordx2 v[20:21], v30, s[8:11], s18 offen
    s_mov_b32 s18, 843776
    buffer_load_dwordx2 v[22:23], v30, s[8:11], s18 offen
    s_mov_b32 s18, 966656
    buffer_load_dwordx2 v[24:25], v30, s[8:11], s18 offen
    s_mov_b32 s18, 974848
    buffer_load_dwordx2 v[26:27], v30, s[8:11], s18 offen
    s_waitcnt vmcnt(16)
    v_perm_b32 v31, v34, v32, s30
    v_accvgpr_write_b32 a48, v31
    v_perm_b32 v31, v38, v36, s30
    v_accvgpr_write_b32 a49, v31
    v_perm_b32 v31, v42, v40, s30
    v_accvgpr_write_b32 a50, v31
    v_perm_b32 v31, v46, v44, s30
    v_accvgpr_write_b32 a51, v31
    v_perm_b32 v31, v34, v32, s31
    v_accvgpr_write_b32 a112, v31
    v_perm_b32 v31, v38, v36, s31
    v_accvgpr_write_b32 a113, v31
    v_perm_b32 v31, v42, v40, s31
    v_accvgpr_write_b32 a114, v31
    v_perm_b32 v31, v46, v44, s31
    v_accvgpr_write_b32 a115, v31
    v_perm_b32 v112, v35, v33, s30
    v_perm_b32 v113, v39, v37, s30
    v_perm_b32 v114, v43, v41, s30
    v_perm_b32 v115, v47, v45, s30
    v_perm_b32 v28, v35, v33, s31
    v_perm_b32 v29, v39, v37, s31
    ds_write_b64 v0, v[28:29] offset:12288
    s_nop 0
    v_perm_b32 v28, v43, v41, s31
    v_perm_b32 v29, v47, v45, s31
    ds_write_b64 v0, v[28:29] offset:12296
    s_nop 0
    s_mov_b32 s18, 2916352
    buffer_load_dwordx2 v[32:33], v30, s[8:11], s18 offen
    s_mov_b32 s18, 2924544
    buffer_load_dwordx2 v[34:35], v30, s[8:11], s18 offen
    s_mov_b32 s18, 3047424
    buffer_load_dwordx2 v[36:37], v30, s[8:11], s18 offen
    s_mov_b32 s18, 3055616
    buffer_load_dwordx2 v[38:39], v30, s[8:11], s18 offen
    s_mov_b32 s18, 2932736
    buffer_load_dwordx2 v[40:41], v30, s[8:11], s18 offen
    s_mov_b32 s18, 2940928
    buffer_load_dwordx2 v[42:43], v30, s[8:11], s18 offen
    s_mov_b32 s18, 3063808
    buffer_load_dwordx2 v[44:45], v30, s[8:11], s18 offen
    s_mov_b32 s18, 3072000
    buffer_load_dwordx2 v[46:47], v30, s[8:11], s18 offen
    s_waitcnt vmcnt(16)
    v_perm_b32 v31, v50, v48, s30
    v_accvgpr_write_b32 a52, v31
    v_perm_b32 v31, v54, v52, s30
    v_accvgpr_write_b32 a53, v31
    v_perm_b32 v31, v58, v56, s30
    v_accvgpr_write_b32 a54, v31
    v_perm_b32 v31, v62, v60, s30
    v_accvgpr_write_b32 a55, v31
    v_perm_b32 v31, v50, v48, s31
    v_accvgpr_write_b32 a116, v31
    v_perm_b32 v31, v54, v52, s31
    v_accvgpr_write_b32 a117, v31
    v_perm_b32 v31, v58, v56, s31
    v_accvgpr_write_b32 a118, v31
    v_perm_b32 v31, v62, v60, s31
    v_accvgpr_write_b32 a119, v31
    v_perm_b32 v116, v51, v49, s30
    v_perm_b32 v117, v55, v53, s30
    v_perm_b32 v118, v59, v57, s30
    v_perm_b32 v119, v63, v61, s30
    v_perm_b32 v28, v51, v49, s31
    v_perm_b32 v29, v55, v53, s31
    ds_write_b64 v0, v[28:29] offset:13312
    s_nop 0
    v_perm_b32 v28, v59, v57, s31
    v_perm_b32 v29, v63, v61, s31
    ds_write_b64 v0, v[28:29] offset:13320
    s_nop 0
    s_waitcnt vmcnt(8)
    v_perm_b32 v31, v14, v12, s30
    v_accvgpr_write_b32 a56, v31
    v_perm_b32 v31, v18, v16, s30
    v_accvgpr_write_b32 a57, v31
    v_perm_b32 v31, v22, v20, s30
    v_accvgpr_write_b32 a58, v31
    v_perm_b32 v31, v26, v24, s30
    v_accvgpr_write_b32 a59, v31
    v_perm_b32 v31, v14, v12, s31
    v_accvgpr_write_b32 a120, v31
    v_perm_b32 v31, v18, v16, s31
    v_accvgpr_write_b32 a121, v31
    v_perm_b32 v31, v22, v20, s31
    v_accvgpr_write_b32 a122, v31
    v_perm_b32 v31, v26, v24, s31
    v_accvgpr_write_b32 a123, v31
    v_perm_b32 v120, v15, v13, s30
    v_perm_b32 v121, v19, v17, s30
    v_perm_b32 v122, v23, v21, s30
    v_perm_b32 v123, v27, v25, s30
    v_perm_b32 v28, v15, v13, s31
    v_perm_b32 v29, v19, v17, s31
    ds_write_b64 v0, v[28:29] offset:14336
    s_nop 0
    v_perm_b32 v28, v23, v21, s31
    v_perm_b32 v29, v27, v25, s31
    ds_write_b64 v0, v[28:29] offset:14344
    s_nop 0
    s_waitcnt vmcnt(0)
    v_perm_b32 v31, v34, v32, s30
    v_accvgpr_write_b32 a60, v31
    v_perm_b32 v31, v38, v36, s30
    v_accvgpr_write_b32 a61, v31
    v_perm_b32 v31, v42, v40, s30
    v_accvgpr_write_b32 a62, v31
    v_perm_b32 v31, v46, v44, s30
    v_accvgpr_write_b32 a63, v31
    v_perm_b32 v31, v34, v32, s31
    v_accvgpr_write_b32 a124, v31
    v_perm_b32 v31, v38, v36, s31
    v_accvgpr_write_b32 a125, v31
    v_perm_b32 v31, v42, v40, s31
    v_accvgpr_write_b32 a126, v31
    v_perm_b32 v31, v46, v44, s31
    v_accvgpr_write_b32 a127, v31
    v_perm_b32 v124, v35, v33, s30
    v_perm_b32 v125, v39, v37, s30
    v_perm_b32 v126, v43, v41, s30
    v_perm_b32 v127, v47, v45, s30
    v_perm_b32 v28, v35, v33, s31
    v_perm_b32 v29, v39, v37, s31
    ds_write_b64 v0, v[28:29] offset:15360
    s_nop 0
    v_perm_b32 v28, v43, v41, s31
    v_perm_b32 v29, v47, v45, s31
    ds_write_b64 v0, v[28:29] offset:15368
    s_nop 0
    s_cmp_eq_u32 s75, 0
    s_cbranch_scc1 L_cf_ok_20
    v_mov_b32 v32, 32
L_e3_spin_21:
    global_load_dword v33, v32, s[12:13] sc1
    s_waitcnt vmcnt(0)
    v_readfirstlane_b32 s24, v33
    s_cmp_lg_u32 s24, 0
    s_cbranch_scc1 L_e3_got_22
    s_sleep 3
    s_branch L_e3_spin_21
L_e3_got_22:
    s_sub_u32 s24, s24, 1
    s_and_b32 s25, s76, 0x00ff00ff
    s_lshr_b32 s26, s76, 8
    s_and_b32 s26, s26, 0x00ff00ff
    s_add_u32 s25, s25, s26
    s_and_b32 s26, s77, 0x00ff00ff
    s_add_u32 s25, s25, s26
    s_lshr_b32 s26, s77, 8
    s_and_b32 s26, s26, 0x00ff00ff
    s_add_u32 s25, s25, s26
    s_lshr_b32 s26, s25, 16
    s_and_b32 s25, s25, 0xffff
    s_add_u32 s25, s25, s26
    s_lshl_b32 s26, s24, 3
    s_lshr_b64 s[26:27], s[76:77], s26
    s_and_b32 s26, s26, 0xff
    s_min_u32 s26, s26, 32
    s_sub_u32 s90, s25, s26
    s_cmp_eq_u32 s24, s78
    s_cselect_b32 s15, s79, 0xffff
    s_cmp_lt_u32 s15, 32
    s_cselect_b32 s15, s15, 0xffff
    s_mov_b32 s75, 0
    s_cmp_lt_u32 s15, 32
    s_cbranch_scc1 L_cf_ok_20
    s_waitcnt vmcnt(0) lgkmcnt(0)
    v_mbcnt_lo_u32_b32 v0, -1, 0
    v_mbcnt_hi_u32_b32 v0, -1, v0
    s_lshl_b32 s24, s14, 6
    v_add_u32 v0, s24, v0
    s_branch L_mg_div_13
L_cf_ok_20:
    v_bfe_u32 v40, v1, 4, 6
    v_and_b32 v41, 15, v40
    v_lshrrev_b32 v42, 4, v40
    s_lshl_b32 s16, s15, 13
    s_add_u32 s16, s16, 0x3800000
    v_mov_b32 v50, 1
    v_mov_b32 v51, 1
    v_mov_b32 v52, 1
    v_mov_b32 v53, 1
    s_add_u32 s17, s16, 0
    buffer_store_dwordx4 v[50:53], v9, s[4:7], s17 offen
    s_add_u32 s17, s16, 4096
    buffer_store_dwordx4 v[50:53], v9, s[4:7], s17 offen
    s_add_u32 s17, s16, 262144
    buffer_store_dwordx4 v[50:53], v9, s[4:7], s17 offen
    s_add_u32 s17, s16, 266240
    buffer_store_dwordx4 v[50:53], v9, s[4:7], s17 offen
    s_and_b32 s17, s15, 7
    s_lshl_b32 s17, s17, 10
    s_lshr_b32 s18, s15, 3
    s_lshl_b32 s18, s18, 8
    s_add_u32 s17, s17, s18
    s_add_u32 s17, s17, 0x3900000
    v_mov_b32 v54, -1
    v_lshlrev_b32 v55, 2, v40
    s_add_u32 s18, s17, 0
    buffer_store_dword v54, v55, s[4:7], s18 offen
    s_add_u32 s18, s17, 8192
    buffer_store_dword v54, v55, s[4:7], s18 offen
    s_add_u32 s18, s17, 16384
    buffer_store_dword v54, v55, s[4:7], s18 offen
    v_mov_b32 v54, 0
    v_add_u32 v56, 143936, v55
    v_cmp_gt_u32 vcc, 16, v40
    s_and_saveexec_b64 s[22:23], vcc
    ds_write_b32 v56, v54
    s_mov_b64 exec, s[22:23]
    s_cmp_lg_u32 s15, 0
    s_cbranch_scc1 L_cA_z_23
    s_mov_b32 s18, 0x5800000
    buffer_store_dword v54, v55, s[4:7], s18 offen sc1
L_cA_z_23:
    s_lshl_b32 s19, s15, 11
    s_and_b32 s18, s20, 1
    s_lshl_b32 s18, s18, 10
    s_add_u32 s18, s18, s19
    s_cmp_lt_u32 s20, 2
    s_mov_b32 s19, 0x37a0000
    s_cselect_b32 s19, 0x33a0000, s19
    s_add_u32 s18, s18, s19
    s_add_u32 s19, s18, 0x10000
    v_mov_b32 v50, -1
    v_mov_b32 v51, -1
    v_mov_b32 v52, -1
    v_mov_b32 v53, -1
    buffer_store_dwordx4 v[50:53], v1, s[4:7], s18 offen sc1
    buffer_store_dwordx4 v[50:53], v1, s[4:7], s19 offen sc1
    s_add_u32 s18, s18, 0x20000
    s_add_u32 s19, s19, 0x20000
    buffer_store_dwordx4 v[50:53], v1, s[4:7], s18 offen sc1
    buffer_store_dwordx4 v[50:53], v1, s[4:7], s19 offen sc1
    s_waitcnt vmcnt(0)
    s_mov_b64 exec, 1
    v_mov_b32 v50, 1
    v_mov_b32 v51, 36
    global_atomic_add v51, v50, s[12:13]
    s_mov_b64 exec, -1
    s_load_dwordx2 s[32:33], s[0:1], 8
    v_lshrrev_b32 v50, 1, v41
    v_lshlrev_b32 v50, 10, v50
    v_lshl_add_u32 v50, v42, 8, v50
    v_and_b32 v51, 1, v41
    v_lshl_add_u32 v50, v51, 5, v50
    s_and_b32 s18, s20, 1
    s_lshl_b32 s18, s18, 7
    s_lshr_b32 s19, s20, 1
    s_lshl_b32 s19, s19, 3
    s_add_u32 s18, s18, s19
    v_add_u32 v30, s18, v50
    s_waitcnt lgkmcnt(0)
    s_mov_b32 s8, s32
    s_and_b32 s9, s33, 0xffff
    s_mov_b32 s10, 0x2000
    s_mov_b32 s11, 0x00020000
    buffer_load_ushort v32, v30, s[8:11], 0 offen offset:0
    buffer_load_ushort v33, v30, s[8:11], 0 offen offset:2
    buffer_load_ushort v34, v30, s[8:11], 0 offen offset:4
    buffer_load_ushort v35, v30, s[8:11], 0 offen offset:6
    buffer_load_ushort v36, v30, s[8:11], 0 offen offset:16
    buffer_load_ushort v37, v30, s[8:11], 0 offen offset:18
    buffer_load_ushort v38, v30, s[8:11], 0 offen offset:20
    buffer_load_ushort v39, v30, s[8:11], 0 offen offset:22
    buffer_load_ushort v40, v30, s[8:11], 0 offen offset:64
    buffer_load_ushort v41, v30, s[8:11], 0 offen offset:66
    buffer_load_ushort v42, v30, s[8:11], 0 offen offset:68
    buffer_load_ushort v43, v30, s[8:11], 0 offen offset:70
    buffer_load_ushort v44, v30, s[8:11], 0 offen offset:80
    buffer_load_ushort v45, v30, s[8:11], 0 offen offset:82
    buffer_load_ushort v46, v30, s[8:11], 0 offen offset:84
    buffer_load_ushort v47, v30, s[8:11], 0 offen offset:86
    s_waitcnt vmcnt(0)
    s_lshl_b32 s18, s20, 11
    v_add_u32 v31, s18, v1
    v_lshl_or_b32 v48, v33, 16, v32
    v_lshl_or_b32 v49, v35, 16, v34
    v_lshl_or_b32 v50, v37, 16, v36
    v_lshl_or_b32 v51, v39, 16, v38
    ds_write_b128 v31, v[48:51] offset:0
    s_waitcnt lgkmcnt(0)
    v_lshl_or_b32 v48, v41, 16, v40
    v_lshl_or_b32 v49, v43, 16, v42
    v_lshl_or_b32 v50, v45, 16, v44
    v_lshl_or_b32 v51, v47, 16, v46
    ds_write_b128 v31, v[48:51] offset:1024
    s_waitcnt lgkmcnt(0)
    s_mov_b32 s34, 0
    s_mov_b32 s44, 0x3e02939f
    s_mov_b32 s45, 0x3e02939f
    s_mov_b32 s68, 0x3f803f80
    s_mov_b32 s69, 0x3f803f80
    s_cmp_eq_u32 s20, 1
    s_cselect_b32 s87, 1, 0x7fff
    s_lshl_b32 s50, s20, 2
    s_add_u32 s50, s50, 143936
    s_waitcnt vmcnt(0) lgkmcnt(0)
    s_barrier
    s_barrier
    s_setprio 3
    ds_read_b128 v[32:35], v0 offset:0
    ds_read_b128 v[36:39], v0 offset:1024
    ds_read_b128 v[40:43], v0 offset:2048
    ds_read_b128 v[44:47], v0 offset:3072
    v_mov_b64 v[48:49], 0
    v_mov_b64 v[50:51], 0
    v_mov_b64 v[52:53], 0
    v_mov_b64 v[54:55], 0
    v_mov_b64 v[56:57], 0
    v_mov_b64 v[58:59], 0
    v_mov_b64 v[60:61], 0
    v_mov_b64 v[62:63], 0
.p2align 6
L_cA_loop_24:
    s_waitcnt lgkmcnt(0)
    s_barrier
    ds_read_b128 v[18:21], v1 offset:0
    ds_read_b128 v[22:25], v1 offset:1024
    ds_read_b128 v[26:29], v1 offset:2048
    s_add_u32 s35, s34, 1
    s_lshl_b32 s43, s34, 18
    s_waitcnt lgkmcnt(2)
    v_smfmac_f32_16x16x64_bf16 v[48:51], v[18:21], a[0:7], v2
    v_smfmac_f32_16x16x64_bf16 v[52:55], v[18:21], a[64:71], v2
    v_smfmac_f32_16x16x64_bf16 v[56:59], v[18:21], v[64:71], v2
    v_smfmac_f32_16x16x64_bf16 v[60:63], v[18:21], v[32:39], v2
    ds_read_b128 v[32:35], v0 offset:4096
    s_waitcnt lgkmcnt(2)
    v_smfmac_f32_16x16x64_bf16 v[48:51], v[22:25], a[8:15], v2
    ds_read_b128 v[36:39], v0 offset:5120
    v_smfmac_f32_16x16x64_bf16 v[52:55], v[22:25], a[72:79], v2
    ds_read_b128 v[18:21], v1 offset:3072
    v_smfmac_f32_16x16x64_bf16 v[56:59], v[22:25], v[72:79], v2
    v_smfmac_f32_16x16x64_bf16 v[60:63], v[22:25], v[40:47], v2
    ds_read_b128 v[40:43], v0 offset:6144
    ds_read_b128 v[44:47], v0 offset:7168
    s_barrier
    ds_read_b128 v[22:25], v1 offset:4096
    buffer_load_dwordx4 v[10:13], v7, s[4:7], s43 offen offset:0
    buffer_load_dwordx4 v[14:17], v7, s[4:7], s43 offen offset:64
    s_waitcnt lgkmcnt(6)
    v_smfmac_f32_16x16x64_bf16 v[48:51], v[26:29], a[16:23], v2
    v_smfmac_f32_16x16x64_bf16 v[52:55], v[26:29], a[80:87], v2
    v_smfmac_f32_16x16x64_bf16 v[56:59], v[26:29], v[80:87], v2
    s_waitcnt lgkmcnt(4)
    v_smfmac_f32_16x16x64_bf16 v[60:63], v[26:29], v[32:39], v2
    ds_read_b128 v[32:35], v0 offset:8192
    s_waitcnt lgkmcnt(4)
    v_smfmac_f32_16x16x64_bf16 v[48:51], v[18:21], a[24:31], v2
    ds_read_b128 v[36:39], v0 offset:9216
    v_smfmac_f32_16x16x64_bf16 v[52:55], v[18:21], a[88:95], v2
    ds_read_b128 v[26:29], v1 offset:5120
    v_smfmac_f32_16x16x64_bf16 v[56:59], v[18:21], v[88:95], v2
    s_waitcnt lgkmcnt(4)
    v_smfmac_f32_16x16x64_bf16 v[60:63], v[18:21], v[40:47], v2
    ds_read_b128 v[40:43], v0 offset:10240
    s_waitcnt lgkmcnt(4)
    v_smfmac_f32_16x16x64_bf16 v[48:51], v[22:25], a[32:39], v2
    ds_read_b128 v[44:47], v0 offset:11264
    v_smfmac_f32_16x16x64_bf16 v[52:55], v[22:25], a[96:103], v2
    ds_read_b128 v[18:21], v1 offset:6144
    v_smfmac_f32_16x16x64_bf16 v[56:59], v[22:25], v[96:103], v2
    s_waitcnt lgkmcnt(4)
    v_smfmac_f32_16x16x64_bf16 v[60:63], v[22:25], v[32:39], v2
    ds_read_b128 v[32:35], v0 offset:12288
    s_waitcnt lgkmcnt(4)
    v_smfmac_f32_16x16x64_bf16 v[48:51], v[26:29], a[40:47], v2
    ds_read_b128 v[36:39], v0 offset:13312
    v_smfmac_f32_16x16x64_bf16 v[52:55], v[26:29], a[104:111], v2
    ds_read_b128 v[22:25], v1 offset:7168
    v_smfmac_f32_16x16x64_bf16 v[56:59], v[26:29], v[104:111], v2
    s_waitcnt lgkmcnt(4)
    v_smfmac_f32_16x16x64_bf16 v[60:63], v[26:29], v[40:47], v2
    ds_read_b128 v[40:43], v0 offset:14336
    s_waitcnt lgkmcnt(4)
    v_smfmac_f32_16x16x64_bf16 v[48:51], v[18:21], a[48:55], v2
    ds_read_b128 v[44:47], v0 offset:15360
    v_smfmac_f32_16x16x64_bf16 v[52:55], v[18:21], a[112:119], v2
    v_smfmac_f32_16x16x64_bf16 v[56:59], v[18:21], v[112:119], v2
    s_waitcnt lgkmcnt(3)
    v_smfmac_f32_16x16x64_bf16 v[60:63], v[18:21], v[32:39], v2
    ds_read_b128 v[32:35], v6
    s_waitcnt lgkmcnt(3)
    v_smfmac_f32_16x16x64_bf16 v[48:51], v[22:25], a[56:63], v2
    ds_read_b128 v[36:39], v6 offset:4096
    v_smfmac_f32_16x16x64_bf16 v[52:55], v[22:25], a[120:127], v2
    v_smfmac_f32_16x16x64_bf16 v[56:59], v[22:25], v[120:127], v2
    s_waitcnt lgkmcnt(2)
    v_smfmac_f32_16x16x64_bf16 v[60:63], v[22:25], v[40:47], v2
    v_mov_b32 v30, s35
    v_mov_b32 v31, s50
    s_nop 1
    v_add_f32 v48, v48, v49
    v_add_f32 v50, v50, v51
    v_add_f32 v52, v52, v53
    v_add_f32 v54, v54, v55
    v_add_f32 v56, v56, v57
    v_add_f32 v58, v58, v59
    v_add_f32 v60, v60, v61
    v_add_f32 v62, v62, v63
    v_cvt_pk_bf16_f32 v48, v48, v52
    v_cvt_pk_bf16_f32 v49, v56, v60
    v_cvt_pk_bf16_f32 v50, v50, v54
    v_cvt_pk_bf16_f32 v51, v58, v62
    ds_write_b64 v3, v[48:49]
    ds_write_b64 v3, v[50:51] offset:288
    ds_write_b32 v31, v30
    v_xor_b32 v44, 64, v6
    ds_read_b128 v[40:43], v44
    ds_read_b128 v[44:47], v44 offset:4096
    v_mov_b32 v31, 143936
    s_cmp_eq_u32 s34, 63
    s_cbranch_scc1 L_cA_fin_25
L_cA_fl_26:
    ds_read_b128 v[18:21], v31
    ds_read_b128 v[48:51], v4
    ds_read_b128 v[52:55], v4 offset:2304
    ds_read_b128 v[56:59], v4 offset:64
    ds_read_b128 v[60:63], v4 offset:2368
    s_waitcnt lgkmcnt(4)
    v_min3_u32 v18, v18, v19, v20
    v_min_u32 v18, v18, v21
    v_cmp_gt_u32 vcc, s35, v18
    s_cbranch_vccnz L_cA_fl_26
    s_waitcnt lgkmcnt(2)
    v_mfma_f32_16x16x32_bf16 v[18:21], v[52:55], v[48:51], 0
    v_mfma_f32_16x16x32_bf16 v[22:25], v[32:35], v[48:51], 0
    v_mfma_f32_16x16x32_bf16 v[26:29], v[36:39], v[48:51], 0
    ds_read_b128 v[48:51], v4 offset:128
    ds_read_b128 v[52:55], v4 offset:2432
    v_xor_b32 v36, 128, v6
    ds_read_b128 v[32:35], v36
    ds_read_b128 v[36:39], v36 offset:4096
    s_waitcnt lgkmcnt(4)
    v_mfma_f32_16x16x32_bf16 v[18:21], v[60:63], v[56:59], v[18:21]
    v_mfma_f32_16x16x32_bf16 v[22:25], v[40:43], v[56:59], v[22:25]
    v_mfma_f32_16x16x32_bf16 v[26:29], v[44:47], v[56:59], v[26:29]
    ds_read_b128 v[56:59], v4 offset:192
    ds_read_b128 v[60:63], v4 offset:2496
    v_xor_b32 v44, 192, v6
    ds_read_b128 v[40:43], v44
    ds_read_b128 v[44:47], v44 offset:4096
    s_waitcnt lgkmcnt(4)
    v_mfma_f32_16x16x32_bf16 v[18:21], v[52:55], v[48:51], v[18:21]
    v_mfma_f32_16x16x32_bf16 v[22:25], v[32:35], v[48:51], v[22:25]
    v_mfma_f32_16x16x32_bf16 v[26:29], v[36:39], v[48:51], v[26:29]
    s_waitcnt lgkmcnt(0)
    v_mfma_f32_16x16x32_bf16 v[18:21], v[60:63], v[56:59], v[18:21]
    v_mfma_f32_16x16x32_bf16 v[22:25], v[40:43], v[56:59], v[22:25]
    v_mfma_f32_16x16x32_bf16 v[26:29], v[44:47], v[56:59], v[26:29]
    s_nop 2
    v_mov_b32 v55, 0
    v_mov_b32 v57, 0
    v_mov_b32 v53, 0
    v_mov_b64 v[60:61], s[68:69]
    v_mov_b64 v[62:63], s[68:69]
    v_max3_f32 v30, v18, v20, v22
    v_max3_f32 v31, v23, v24, v25
    v_max3_f32 v30, v30, v26, v27
    v_max3_f32 v31, v31, v28, v29
    v_max_f32 v30, v30, v31
    v_mov_b32 v31, v30
    s_nop 1
    v_permlane32_swap_b32 v31, v30
    v_max_f32 v30, v30, v31
    v_mov_b32 v31, v30
    s_nop 1
    v_permlane16_swap_b32 v31, v30
    v_max_f32 v30, v30, v31
    v_mul_f32 v30, s44, v30
    v_pk_fma_f32 v[22:23], v[22:23], s[44:45], v[30:31] op_sel_hi:[1,1,0] neg_lo:[0,0,1] neg_hi:[0,0,1]
    v_pk_fma_f32 v[24:25], v[24:25], s[44:45], v[30:31] op_sel_hi:[1,1,0] neg_lo:[0,0,1] neg_hi:[0,0,1]
    v_pk_fma_f32 v[26:27], v[26:27], s[44:45], v[30:31] op_sel_hi:[1,1,0] neg_lo:[0,0,1] neg_hi:[0,0,1]
    v_pk_fma_f32 v[28:29], v[28:29], s[44:45], v[30:31] op_sel_hi:[1,1,0] neg_lo:[0,0,1] neg_hi:[0,0,1]
    v_fma_f32 v18, v18, s44, -v30
    v_fma_f32 v20, v20, s44, -v30
    v_exp_f32 v22, v22
    v_exp_f32 v23, v23
    v_exp_f32 v24, v24
    v_exp_f32 v25, v25
    v_exp_f32 v26, v26
    v_exp_f32 v27, v27
    v_exp_f32 v28, v28
    v_exp_f32 v29, v29
    v_exp_f32 v18, v18
    v_exp_f32 v20, v20
    s_barrier
    ds_read_b32 v54, v8
    ds_read_b32 v56, v8 offset:16
    v_cvt_pk_bf16_f32 v48, v22, v23
    v_cvt_pk_bf16_f32 v49, v24, v25
    v_cvt_pk_bf16_f32 v50, v26, v27
    v_cvt_pk_bf16_f32 v51, v28, v29
    v_cvt_pk_bf16_f32 v52, v18, v20
    s_waitcnt vmcnt(0)
    v_mfma_f32_16x16x32_bf16 v[40:43], v[60:63], v[48:51], 0
    v_mfma_f32_16x16x32_bf16 v[32:35], v[10:13], v[48:51], 0
    v_mfma_f32_16x16x32_bf16 v[36:39], v[14:17], v[48:51], 0
    v_mfma_f32_16x16x16_bf16 v[40:43], v[60:61], v[52:53], v[40:43]
    s_waitcnt lgkmcnt(0)
    v_mfma_f32_16x16x16_bf16 v[32:35], v[54:55], v[52:53], v[32:35]
    v_mfma_f32_16x16x16_bf16 v[36:39], v[56:57], v[52:53], v[36:39]
    s_nop 5
    v_rcp_f32 v44, v40
    s_nop 0
    v_pk_mul_f32 v[32:33], v[32:33], v[44:45] op_sel_hi:[1,0]
    v_pk_mul_f32 v[34:35], v[34:35], v[44:45] op_sel_hi:[1,0]
    v_pk_mul_f32 v[36:37], v[36:37], v[44:45] op_sel_hi:[1,0]
    v_pk_mul_f32 v[38:39], v[38:39], v[44:45] op_sel_hi:[1,0]
    v_cvt_pk_bf16_f32 v18, v32, v36
    v_cvt_pk_bf16_f32 v19, v33, v37
    v_cvt_pk_bf16_f32 v20, v34, v38
    v_cvt_pk_bf16_f32 v21, v35, v39
    ds_write_b128 v5, v[18:21]
    s_waitcnt lgkmcnt(0)
    s_barrier
    s_mov_b32 s34, s35
    v_xor_b32 v6, 0x2000, v6
    ds_read_b128 v[32:35], v0 offset:0
    ds_read_b128 v[36:39], v0 offset:1024
    ds_read_b128 v[40:43], v0 offset:2048
    ds_read_b128 v[44:47], v0 offset:3072
    v_mov_b64 v[48:49], 0
    v_mov_b64 v[50:51], 0
    v_mov_b64 v[52:53], 0
    v_mov_b64 v[54:55], 0
    v_mov_b64 v[56:57], 0
    v_mov_b64 v[58:59], 0
    v_mov_b64 v[60:61], 0
    v_mov_b64 v[62:63], 0
    s_branch L_cA_loop_24
L_cA_fin_25:
    s_waitcnt lgkmcnt(0)
    s_barrier
    s_branch L_c8_exit_15
L_c8_B_14:
    v_subrev_u32 v46, 256, v0
    v_lshlrev_b32 v6, 4, v46
    s_lshl_b32 s16, s15, 13
    s_add_u32 s16, s16, 0x3800000
    s_and_b32 s17, s15, 7
    s_lshl_b32 s17, s17, 10
    s_lshr_b32 s18, s15, 3
    s_lshl_b32 s18, s18, 8
    s_add_u32 s17, s17, s18
    s_add_u32 s17, s17, 0x3900000
    s_lshl_b32 s18, s20, 14
    s_add_u32 s18, s18, 65536
    v_lshlrev_b32 v0, 4, v40
    v_add_u32 v0, s18, v0
    s_lshl_b32 s18, s20, 16
    s_lshl_b32 s19, s15, 6
    s_add_u32 s18, s18, s19
    s_add_u32 s18, s18, 0x3800000
    v_and_b32 v50, 3, v41
    v_lshlrev_b32 v50, 4, v50
    v_lshl_add_u32 v50, v42, 11, v50
    v_lshrrev_b32 v51, 2, v41
    v_lshl_add_u32 v50, v51, 13, v50
    v_add_u32 v3, s18, v50
    s_lshl_b32 s18, s20, 11
    v_lshlrev_b32 v50, 4, v40
    v_add_u32 v4, s18, v50
    s_mov_b32 s59, s16
    s_lshl_b32 s18, s20, 1
    v_add_u32 v50, s18, v42
    v_bfe_u32 v51, v41, 1, 1
    v_lshl_add_u32 v50, v50, 1, v51
    v_lshlrev_b32 v50, 4, v50
    v_and_b32 v51, 1, v41
    v_lshl_add_u32 v50, v51, 3, v50
    v_add_u32 v5, s17, v50
    v_lshrrev_b32 v50, 1, v41
    v_mul_u32_u24 v50, 288, v50
    v_lshl_add_u32 v50, v42, 5, v50
    v_and_b32 v51, 1, v41
    v_lshl_add_u32 v50, v51, 4, v50
    v_add_u32 v7, 139264, v50
    v_lshlrev_b32 v50, 1, v42
    v_xor_b32 v50, v50, v41
    v_lshlrev_b32 v50, 4, v50
    v_lshl_add_u32 v50, v42, 8, v50
    s_lshl_b32 s18, s15, 19
    s_and_b32 s19, s20, 1
    s_lshl_b32 s19, s19, 12
    s_add_u32 s18, s18, s19
    s_add_u32 s18, s18, 0x1000000
    v_add_u32 v8, s18, v50
    v_lshlrev_b32 v50, 2, v42
    v_lshl_add_u32 v50, v41, 5, v50
    s_lshl_b32 s18, s20, 9
    s_add_u32 s18, s18, 144896
    v_add_u32 v9, s18, v50
    s_load_dwordx2 s[26:27], s[0:1], 32
    s_load_dwordx2 s[28:29], s[0:1], 40
    s_load_dwordx2 s[32:33], s[0:1], 8
    s_lshl_b32 s18, s20, 6
    v_lshl_add_u32 v10, v41, 2, v45
    v_add_u32 v10, s18, v10
    v_lshlrev_b32 v50, 14, v44
    v_lshl_add_u32 v50, v43, 12, v50
    v_lshl_add_u32 v50, v41, 4, v50
    s_lshl_b32 s18, s15, 17
    s_lshl_b32 s19, s20, 8
    s_add_u32 s18, s18, s19
    v_add_u32 v11, s18, v50
    v_lshrrev_b32 v50, 1, v41
    v_lshlrev_b32 v50, 10, v50
    v_lshl_add_u32 v50, v42, 8, v50
    v_and_b32 v51, 1, v41
    v_lshl_add_u32 v50, v51, 5, v50
    s_and_b32 s18, s20, 1
    s_lshl_b32 s18, s18, 7
    s_lshr_b32 s19, s20, 1
    s_lshl_b32 s19, s19, 3
    s_add_u32 s18, s18, s19
    v_add_u32 v12, s18, v50
    s_waitcnt lgkmcnt(0)
    s_mov_b32 s60, s26
    s_and_b32 s61, s27, 0xffff
    s_mov_b32 s62, 0x400000
    s_mov_b32 s63, 0x00020000
    s_mov_b32 s64, s28
    s_and_b32 s65, s29, 0xffff
    s_mov_b32 s66, 0x400000
    s_mov_b32 s67, 0x00020000
    s_mov_b32 s8, s32
    s_and_b32 s9, s33, 0xffff
    s_mov_b32 s10, 0x2000
    s_mov_b32 s11, 0x00020000
    s_mov_b32 s18, 0
    buffer_load_dwordx4 v[64:67], v11, s[64:67], s18 offen
    s_mov_b32 s18, 1024
    buffer_load_dwordx4 v[68:71], v11, s[64:67], s18 offen
    s_mov_b32 s18, 8192
    buffer_load_dwordx4 v[72:75], v11, s[64:67], s18 offen
    s_mov_b32 s18, 9216
    buffer_load_dwordx4 v[76:79], v11, s[64:67], s18 offen
    s_mov_b32 s18, 2048
    buffer_load_dwordx4 v[80:83], v11, s[64:67], s18 offen
    s_mov_b32 s18, 3072
    buffer_load_dwordx4 v[84:87], v11, s[64:67], s18 offen
    s_mov_b32 s18, 10240
    buffer_load_dwordx4 v[88:91], v11, s[64:67], s18 offen
    s_mov_b32 s18, 11264
    buffer_load_dwordx4 v[92:95], v11, s[64:67], s18 offen
    s_mov_b32 s18, 32768
    buffer_load_dwordx4 v[96:99], v11, s[64:67], s18 offen
    s_mov_b32 s18, 33792
    buffer_load_dwordx4 v[100:103], v11, s[64:67], s18 offen
    s_mov_b32 s18, 40960
    buffer_load_dwordx4 v[104:107], v11, s[64:67], s18 offen
    s_mov_b32 s18, 41984
    buffer_load_dwordx4 v[108:111], v11, s[64:67], s18 offen
    s_mov_b32 s18, 34816
    buffer_load_dwordx4 v[112:115], v11, s[64:67], s18 offen
    s_mov_b32 s18, 35840
    buffer_load_dwordx4 v[116:119], v11, s[64:67], s18 offen
    s_mov_b32 s18, 43008
    buffer_load_dwordx4 v[120:123], v11, s[64:67], s18 offen
    s_mov_b32 s18, 44032
    buffer_load_dwordx4 v[124:127], v11, s[64:67], s18 offen
    s_mov_b32 s18, 0
    buffer_load_dword v16, v10, s[60:63], s18 offen
    s_mov_b32 s18, 8192
    buffer_load_dword v17, v10, s[60:63], s18 offen
    s_mov_b32 s18, 131072
    buffer_load_dword v18, v10, s[60:63], s18 offen
    s_mov_b32 s18, 139264
    buffer_load_dword v19, v10, s[60:63], s18 offen
    s_mov_b32 s18, 16384
    buffer_load_dword v20, v10, s[60:63], s18 offen
    s_mov_b32 s18, 24576
    buffer_load_dword v21, v10, s[60:63], s18 offen
    s_mov_b32 s18, 147456
    buffer_load_dword v22, v10, s[60:63], s18 offen
    s_mov_b32 s18, 155648
    buffer_load_dword v23, v10, s[60:63], s18 offen
    s_mov_b32 s18, 2097152
    buffer_load_dword v24, v10, s[60:63], s18 offen
    s_mov_b32 s18, 2105344
    buffer_load_dword v25, v10, s[60:63], s18 offen
    s_mov_b32 s18, 2228224
    buffer_load_dword v26, v10, s[60:63], s18 offen
    s_mov_b32 s18, 2236416
    buffer_load_dword v27, v10, s[60:63], s18 offen
    s_mov_b32 s18, 2113536
    buffer_load_dword v28, v10, s[60:63], s18 offen
    s_mov_b32 s18, 2121728
    buffer_load_dword v29, v10, s[60:63], s18 offen
    s_mov_b32 s18, 2244608
    buffer_load_dword v30, v10, s[60:63], s18 offen
    s_mov_b32 s18, 2252800
    buffer_load_dword v31, v10, s[60:63], s18 offen
    s_mov_b32 s18, 262144
    buffer_load_dword v32, v10, s[60:63], s18 offen
    s_mov_b32 s18, 270336
    buffer_load_dword v33, v10, s[60:63], s18 offen
    s_mov_b32 s18, 393216
    buffer_load_dword v34, v10, s[60:63], s18 offen
    s_mov_b32 s18, 401408
    buffer_load_dword v35, v10, s[60:63], s18 offen
    s_mov_b32 s18, 278528
    buffer_load_dword v36, v10, s[60:63], s18 offen
    s_mov_b32 s18, 286720
    buffer_load_dword v37, v10, s[60:63], s18 offen
    s_mov_b32 s18, 409600
    buffer_load_dword v38, v10, s[60:63], s18 offen
    s_mov_b32 s18, 417792
    buffer_load_dword v39, v10, s[60:63], s18 offen
    s_mov_b32 s18, 2359296
    buffer_load_dword v40, v10, s[60:63], s18 offen
    s_mov_b32 s18, 2367488
    buffer_load_dword v41, v10, s[60:63], s18 offen
    s_mov_b32 s18, 2490368
    buffer_load_dword v42, v10, s[60:63], s18 offen
    s_mov_b32 s18, 2498560
    buffer_load_dword v43, v10, s[60:63], s18 offen
    s_mov_b32 s18, 2375680
    buffer_load_dword v44, v10, s[60:63], s18 offen
    s_mov_b32 s18, 2383872
    buffer_load_dword v45, v10, s[60:63], s18 offen
    s_mov_b32 s18, 2506752
    buffer_load_dword v46, v10, s[60:63], s18 offen
    s_mov_b32 s18, 2514944
    buffer_load_dword v47, v10, s[60:63], s18 offen
    s_waitcnt vmcnt(40)
    v_perm_b32 v12, v68, v64, s30
    v_accvgpr_write_b32 a0, v12
    v_perm_b32 v12, v76, v72, s30
    v_accvgpr_write_b32 a1, v12
    v_perm_b32 v12, v84, v80, s30
    v_accvgpr_write_b32 a2, v12
    v_perm_b32 v12, v92, v88, s30
    v_accvgpr_write_b32 a3, v12
    v_perm_b32 v12, v68, v64, s31
    v_accvgpr_write_b32 a16, v12
    v_perm_b32 v12, v76, v72, s31
    v_accvgpr_write_b32 a17, v12
    v_perm_b32 v12, v84, v80, s31
    v_accvgpr_write_b32 a18, v12
    v_perm_b32 v12, v92, v88, s31
    v_accvgpr_write_b32 a19, v12
    v_perm_b32 v12, v69, v65, s30
    v_accvgpr_write_b32 a32, v12
    v_perm_b32 v12, v77, v73, s30
    v_accvgpr_write_b32 a33, v12
    v_perm_b32 v12, v85, v81, s30
    v_accvgpr_write_b32 a34, v12
    v_perm_b32 v12, v93, v89, s30
    v_accvgpr_write_b32 a35, v12
    v_perm_b32 v12, v69, v65, s31
    v_accvgpr_write_b32 a48, v12
    v_perm_b32 v12, v77, v73, s31
    v_accvgpr_write_b32 a49, v12
    v_perm_b32 v12, v85, v81, s31
    v_accvgpr_write_b32 a50, v12
    v_perm_b32 v12, v93, v89, s31
    v_accvgpr_write_b32 a51, v12
    v_perm_b32 v12, v70, v66, s30
    v_accvgpr_write_b32 a64, v12
    v_perm_b32 v12, v78, v74, s30
    v_accvgpr_write_b32 a65, v12
    v_perm_b32 v12, v86, v82, s30
    v_accvgpr_write_b32 a66, v12
    v_perm_b32 v12, v94, v90, s30
    v_accvgpr_write_b32 a67, v12
    v_perm_b32 v12, v70, v66, s31
    v_accvgpr_write_b32 a80, v12
    v_perm_b32 v12, v78, v74, s31
    v_accvgpr_write_b32 a81, v12
    v_perm_b32 v12, v86, v82, s31
    v_accvgpr_write_b32 a82, v12
    v_perm_b32 v12, v94, v90, s31
    v_accvgpr_write_b32 a83, v12
    v_perm_b32 v12, v71, v67, s30
    v_accvgpr_write_b32 a96, v12
    v_perm_b32 v12, v79, v75, s30
    v_accvgpr_write_b32 a97, v12
    v_perm_b32 v12, v87, v83, s30
    v_accvgpr_write_b32 a98, v12
    v_perm_b32 v12, v95, v91, s30
    v_accvgpr_write_b32 a99, v12
    v_perm_b32 v12, v71, v67, s31
    v_accvgpr_write_b32 a112, v12
    v_perm_b32 v12, v79, v75, s31
    v_accvgpr_write_b32 a113, v12
    v_perm_b32 v12, v87, v83, s31
    v_accvgpr_write_b32 a114, v12
    v_perm_b32 v12, v95, v91, s31
    v_accvgpr_write_b32 a115, v12
    s_mov_b32 s18, 65536
    buffer_load_dwordx4 v[64:67], v11, s[64:67], s18 offen
    s_mov_b32 s18, 66560
    buffer_load_dwordx4 v[68:71], v11, s[64:67], s18 offen
    s_mov_b32 s18, 73728
    buffer_load_dwordx4 v[72:75], v11, s[64:67], s18 offen
    s_mov_b32 s18, 74752
    buffer_load_dwordx4 v[76:79], v11, s[64:67], s18 offen
    s_mov_b32 s18, 67584
    buffer_load_dwordx4 v[80:83], v11, s[64:67], s18 offen
    s_mov_b32 s18, 68608
    buffer_load_dwordx4 v[84:87], v11, s[64:67], s18 offen
    s_mov_b32 s18, 75776
    buffer_load_dwordx4 v[88:91], v11, s[64:67], s18 offen
    s_mov_b32 s18, 76800
    buffer_load_dwordx4 v[92:95], v11, s[64:67], s18 offen
    s_waitcnt vmcnt(40)
    v_perm_b32 v12, v100, v96, s30
    v_accvgpr_write_b32 a4, v12
    v_perm_b32 v12, v108, v104, s30
    v_accvgpr_write_b32 a5, v12
    v_perm_b32 v12, v116, v112, s30
    v_accvgpr_write_b32 a6, v12
    v_perm_b32 v12, v124, v120, s30
    v_accvgpr_write_b32 a7, v12
    v_perm_b32 v12, v100, v96, s31
    v_accvgpr_write_b32 a20, v12
    v_perm_b32 v12, v108, v104, s31
    v_accvgpr_write_b32 a21, v12
    v_perm_b32 v12, v116, v112, s31
    v_accvgpr_write_b32 a22, v12
    v_perm_b32 v12, v124, v120, s31
    v_accvgpr_write_b32 a23, v12
    v_perm_b32 v12, v101, v97, s30
    v_accvgpr_write_b32 a36, v12
    v_perm_b32 v12, v109, v105, s30
    v_accvgpr_write_b32 a37, v12
    v_perm_b32 v12, v117, v113, s30
    v_accvgpr_write_b32 a38, v12
    v_perm_b32 v12, v125, v121, s30
    v_accvgpr_write_b32 a39, v12
    v_perm_b32 v12, v101, v97, s31
    v_accvgpr_write_b32 a52, v12
    v_perm_b32 v12, v109, v105, s31
    v_accvgpr_write_b32 a53, v12
    v_perm_b32 v12, v117, v113, s31
    v_accvgpr_write_b32 a54, v12
    v_perm_b32 v12, v125, v121, s31
    v_accvgpr_write_b32 a55, v12
    v_perm_b32 v12, v102, v98, s30
    v_accvgpr_write_b32 a68, v12
    v_perm_b32 v12, v110, v106, s30
    v_accvgpr_write_b32 a69, v12
    v_perm_b32 v12, v118, v114, s30
    v_accvgpr_write_b32 a70, v12
    v_perm_b32 v12, v126, v122, s30
    v_accvgpr_write_b32 a71, v12
    v_perm_b32 v12, v102, v98, s31
    v_accvgpr_write_b32 a84, v12
    v_perm_b32 v12, v110, v106, s31
    v_accvgpr_write_b32 a85, v12
    v_perm_b32 v12, v118, v114, s31
    v_accvgpr_write_b32 a86, v12
    v_perm_b32 v12, v126, v122, s31
    v_accvgpr_write_b32 a87, v12
    v_perm_b32 v12, v103, v99, s30
    v_accvgpr_write_b32 a100, v12
    v_perm_b32 v12, v111, v107, s30
    v_accvgpr_write_b32 a101, v12
    v_perm_b32 v12, v119, v115, s30
    v_accvgpr_write_b32 a102, v12
    v_perm_b32 v12, v127, v123, s30
    v_accvgpr_write_b32 a103, v12
    v_perm_b32 v12, v103, v99, s31
    v_accvgpr_write_b32 a116, v12
    v_perm_b32 v12, v111, v107, s31
    v_accvgpr_write_b32 a117, v12
    v_perm_b32 v12, v119, v115, s31
    v_accvgpr_write_b32 a118, v12
    v_perm_b32 v12, v127, v123, s31
    v_accvgpr_write_b32 a119, v12
    s_mov_b32 s18, 98304
    buffer_load_dwordx4 v[96:99], v11, s[64:67], s18 offen
    s_mov_b32 s18, 99328
    buffer_load_dwordx4 v[100:103], v11, s[64:67], s18 offen
    s_mov_b32 s18, 106496
    buffer_load_dwordx4 v[104:107], v11, s[64:67], s18 offen
    s_mov_b32 s18, 107520
    buffer_load_dwordx4 v[108:111], v11, s[64:67], s18 offen
    s_mov_b32 s18, 100352
    buffer_load_dwordx4 v[112:115], v11, s[64:67], s18 offen
    s_mov_b32 s18, 101376
    buffer_load_dwordx4 v[116:119], v11, s[64:67], s18 offen
    s_mov_b32 s18, 108544
    buffer_load_dwordx4 v[120:123], v11, s[64:67], s18 offen
    s_mov_b32 s18, 109568
    buffer_load_dwordx4 v[124:127], v11, s[64:67], s18 offen
    s_waitcnt vmcnt(8)
    v_perm_b32 v12, v68, v64, s30
    v_accvgpr_write_b32 a8, v12
    v_perm_b32 v12, v76, v72, s30
    v_accvgpr_write_b32 a9, v12
    v_perm_b32 v12, v84, v80, s30
    v_accvgpr_write_b32 a10, v12
    v_perm_b32 v12, v92, v88, s30
    v_accvgpr_write_b32 a11, v12
    v_perm_b32 v12, v68, v64, s31
    v_accvgpr_write_b32 a24, v12
    v_perm_b32 v12, v76, v72, s31
    v_accvgpr_write_b32 a25, v12
    v_perm_b32 v12, v84, v80, s31
    v_accvgpr_write_b32 a26, v12
    v_perm_b32 v12, v92, v88, s31
    v_accvgpr_write_b32 a27, v12
    v_perm_b32 v12, v69, v65, s30
    v_accvgpr_write_b32 a40, v12
    v_perm_b32 v12, v77, v73, s30
    v_accvgpr_write_b32 a41, v12
    v_perm_b32 v12, v85, v81, s30
    v_accvgpr_write_b32 a42, v12
    v_perm_b32 v12, v93, v89, s30
    v_accvgpr_write_b32 a43, v12
    v_perm_b32 v12, v69, v65, s31
    v_accvgpr_write_b32 a56, v12
    v_perm_b32 v12, v77, v73, s31
    v_accvgpr_write_b32 a57, v12
    v_perm_b32 v12, v85, v81, s31
    v_accvgpr_write_b32 a58, v12
    v_perm_b32 v12, v93, v89, s31
    v_accvgpr_write_b32 a59, v12
    v_perm_b32 v12, v70, v66, s30
    v_accvgpr_write_b32 a72, v12
    v_perm_b32 v12, v78, v74, s30
    v_accvgpr_write_b32 a73, v12
    v_perm_b32 v12, v86, v82, s30
    v_accvgpr_write_b32 a74, v12
    v_perm_b32 v12, v94, v90, s30
    v_accvgpr_write_b32 a75, v12
    v_perm_b32 v12, v70, v66, s31
    v_accvgpr_write_b32 a88, v12
    v_perm_b32 v12, v78, v74, s31
    v_accvgpr_write_b32 a89, v12
    v_perm_b32 v12, v86, v82, s31
    v_accvgpr_write_b32 a90, v12
    v_perm_b32 v12, v94, v90, s31
    v_accvgpr_write_b32 a91, v12
    v_perm_b32 v12, v71, v67, s30
    v_accvgpr_write_b32 a104, v12
    v_perm_b32 v12, v79, v75, s30
    v_accvgpr_write_b32 a105, v12
    v_perm_b32 v12, v87, v83, s30
    v_accvgpr_write_b32 a106, v12
    v_perm_b32 v12, v95, v91, s30
    v_accvgpr_write_b32 a107, v12
    v_perm_b32 v12, v71, v67, s31
    v_accvgpr_write_b32 a120, v12
    v_perm_b32 v12, v79, v75, s31
    v_accvgpr_write_b32 a121, v12
    v_perm_b32 v12, v87, v83, s31
    v_accvgpr_write_b32 a122, v12
    v_perm_b32 v12, v95, v91, s31
    v_accvgpr_write_b32 a123, v12
    s_mov_b32 s18, 524288
    buffer_load_dword v48, v10, s[60:63], s18 offen
    s_mov_b32 s18, 532480
    buffer_load_dword v49, v10, s[60:63], s18 offen
    s_mov_b32 s18, 655360
    buffer_load_dword v50, v10, s[60:63], s18 offen
    s_mov_b32 s18, 663552
    buffer_load_dword v51, v10, s[60:63], s18 offen
    s_mov_b32 s18, 540672
    buffer_load_dword v52, v10, s[60:63], s18 offen
    s_mov_b32 s18, 548864
    buffer_load_dword v53, v10, s[60:63], s18 offen
    s_mov_b32 s18, 671744
    buffer_load_dword v54, v10, s[60:63], s18 offen
    s_mov_b32 s18, 679936
    buffer_load_dword v55, v10, s[60:63], s18 offen
    s_mov_b32 s18, 2621440
    buffer_load_dword v56, v10, s[60:63], s18 offen
    s_mov_b32 s18, 2629632
    buffer_load_dword v57, v10, s[60:63], s18 offen
    s_mov_b32 s18, 2752512
    buffer_load_dword v58, v10, s[60:63], s18 offen
    s_mov_b32 s18, 2760704
    buffer_load_dword v59, v10, s[60:63], s18 offen
    s_mov_b32 s18, 2637824
    buffer_load_dword v60, v10, s[60:63], s18 offen
    s_mov_b32 s18, 2646016
    buffer_load_dword v61, v10, s[60:63], s18 offen
    s_mov_b32 s18, 2768896
    buffer_load_dword v62, v10, s[60:63], s18 offen
    s_mov_b32 s18, 2777088
    buffer_load_dword v63, v10, s[60:63], s18 offen
    s_waitcnt vmcnt(16)
    v_perm_b32 v12, v100, v96, s30
    v_accvgpr_write_b32 a12, v12
    v_perm_b32 v12, v108, v104, s30
    v_accvgpr_write_b32 a13, v12
    v_perm_b32 v12, v116, v112, s30
    v_accvgpr_write_b32 a14, v12
    v_perm_b32 v12, v124, v120, s30
    v_accvgpr_write_b32 a15, v12
    v_perm_b32 v12, v100, v96, s31
    v_accvgpr_write_b32 a28, v12
    v_perm_b32 v12, v108, v104, s31
    v_accvgpr_write_b32 a29, v12
    v_perm_b32 v12, v116, v112, s31
    v_accvgpr_write_b32 a30, v12
    v_perm_b32 v12, v124, v120, s31
    v_accvgpr_write_b32 a31, v12
    v_perm_b32 v12, v101, v97, s30
    v_accvgpr_write_b32 a44, v12
    v_perm_b32 v12, v109, v105, s30
    v_accvgpr_write_b32 a45, v12
    v_perm_b32 v12, v117, v113, s30
    v_accvgpr_write_b32 a46, v12
    v_perm_b32 v12, v125, v121, s30
    v_accvgpr_write_b32 a47, v12
    v_perm_b32 v12, v101, v97, s31
    v_accvgpr_write_b32 a60, v12
    v_perm_b32 v12, v109, v105, s31
    v_accvgpr_write_b32 a61, v12
    v_perm_b32 v12, v117, v113, s31
    v_accvgpr_write_b32 a62, v12
    v_perm_b32 v12, v125, v121, s31
    v_accvgpr_write_b32 a63, v12
    v_perm_b32 v12, v102, v98, s30
    v_accvgpr_write_b32 a76, v12
    v_perm_b32 v12, v110, v106, s30
    v_accvgpr_write_b32 a77, v12
    v_perm_b32 v12, v118, v114, s30
    v_accvgpr_write_b32 a78, v12
    v_perm_b32 v12, v126, v122, s30
    v_accvgpr_write_b32 a79, v12
    v_perm_b32 v12, v102, v98, s31
    v_accvgpr_write_b32 a92, v12
    v_perm_b32 v12, v110, v106, s31
    v_accvgpr_write_b32 a93, v12
    v_perm_b32 v12, v118, v114, s31
    v_accvgpr_write_b32 a94, v12
    v_perm_b32 v12, v126, v122, s31
    v_accvgpr_write_b32 a95, v12
    v_perm_b32 v12, v103, v99, s30
    v_accvgpr_write_b32 a108, v12
    v_perm_b32 v12, v111, v107, s30
    v_accvgpr_write_b32 a109, v12
    v_perm_b32 v12, v119, v115, s30
    v_accvgpr_write_b32 a110, v12
    v_perm_b32 v12, v127, v123, s30
    v_accvgpr_write_b32 a111, v12
    v_perm_b32 v12, v103, v99, s31
    v_accvgpr_write_b32 a124, v12
    v_perm_b32 v12, v111, v107, s31
    v_accvgpr_write_b32 a125, v12
    v_perm_b32 v12, v119, v115, s31
    v_accvgpr_write_b32 a126, v12
    v_perm_b32 v12, v127, v123, s31
    v_accvgpr_write_b32 a127, v12
    s_waitcnt vmcnt(48)
    v_perm_b32 v64, v17, v16, s30
    v_perm_b32 v65, v19, v18, s30
    v_perm_b32 v66, v21, v20, s30
    v_perm_b32 v67, v23, v22, s30
    v_perm_b32 v12, v17, v16, s31
    v_perm_b32 v13, v19, v18, s31
    v_perm_b32 v14, v21, v20, s31
    v_perm_b32 v15, v23, v22, s31
    ds_write_b128 v0, v[12:15] offset:0
    s_nop 1
    v_perm_b32 v68, v25, v24, s30
    v_perm_b32 v69, v27, v26, s30
    v_perm_b32 v70, v29, v28, s30
    v_perm_b32 v71, v31, v30, s30
    v_perm_b32 v12, v25, v24, s31
    v_perm_b32 v13, v27, v26, s31
    v_perm_b32 v14, v29, v28, s31
    v_perm_b32 v15, v31, v30, s31
    ds_write_b128 v0, v[12:15] offset:1024
    s_nop 1
    s_mov_b32 s18, 786432
    buffer_load_dword v16, v10, s[60:63], s18 offen
    s_mov_b32 s18, 794624
    buffer_load_dword v17, v10, s[60:63], s18 offen
    s_mov_b32 s18, 917504
    buffer_load_dword v18, v10, s[60:63], s18 offen
    s_mov_b32 s18, 925696
    buffer_load_dword v19, v10, s[60:63], s18 offen
    s_mov_b32 s18, 802816
    buffer_load_dword v20, v10, s[60:63], s18 offen
    s_mov_b32 s18, 811008
    buffer_load_dword v21, v10, s[60:63], s18 offen
    s_mov_b32 s18, 933888
    buffer_load_dword v22, v10, s[60:63], s18 offen
    s_mov_b32 s18, 942080
    buffer_load_dword v23, v10, s[60:63], s18 offen
    s_mov_b32 s18, 2883584
    buffer_load_dword v24, v10, s[60:63], s18 offen
    s_mov_b32 s18, 2891776
    buffer_load_dword v25, v10, s[60:63], s18 offen
    s_mov_b32 s18, 3014656
    buffer_load_dword v26, v10, s[60:63], s18 offen
    s_mov_b32 s18, 3022848
    buffer_load_dword v27, v10, s[60:63], s18 offen
    s_mov_b32 s18, 2899968
    buffer_load_dword v28, v10, s[60:63], s18 offen
    s_mov_b32 s18, 2908160
    buffer_load_dword v29, v10, s[60:63], s18 offen
    s_mov_b32 s18, 3031040
    buffer_load_dword v30, v10, s[60:63], s18 offen
    s_mov_b32 s18, 3039232
    buffer_load_dword v31, v10, s[60:63], s18 offen
    s_waitcnt vmcnt(48)
    v_perm_b32 v72, v33, v32, s30
    v_perm_b32 v73, v35, v34, s30
    v_perm_b32 v74, v37, v36, s30
    v_perm_b32 v75, v39, v38, s30
    v_perm_b32 v12, v33, v32, s31
    v_perm_b32 v13, v35, v34, s31
    v_perm_b32 v14, v37, v36, s31
    v_perm_b32 v15, v39, v38, s31
    ds_write_b128 v0, v[12:15] offset:2048
    s_nop 1
    v_perm_b32 v76, v41, v40, s30
    v_perm_b32 v77, v43, v42, s30
    v_perm_b32 v78, v45, v44, s30
    v_perm_b32 v79, v47, v46, s30
    v_perm_b32 v12, v41, v40, s31
    v_perm_b32 v13, v43, v42, s31
    v_perm_b32 v14, v45, v44, s31
    v_perm_b32 v15, v47, v46, s31
    ds_write_b128 v0, v[12:15] offset:3072
    s_nop 1
    s_mov_b32 s18, 32768
    buffer_load_dword v32, v10, s[60:63], s18 offen
    s_mov_b32 s18, 40960
    buffer_load_dword v33, v10, s[60:63], s18 offen
    s_mov_b32 s18, 163840
    buffer_load_dword v34, v10, s[60:63], s18 offen
    s_mov_b32 s18, 172032
    buffer_load_dword v35, v10, s[60:63], s18 offen
    s_mov_b32 s18, 49152
    buffer_load_dword v36, v10, s[60:63], s18 offen
    s_mov_b32 s18, 57344
    buffer_load_dword v37, v10, s[60:63], s18 offen
    s_mov_b32 s18, 180224
    buffer_load_dword v38, v10, s[60:63], s18 offen
    s_mov_b32 s18, 188416
    buffer_load_dword v39, v10, s[60:63], s18 offen
    s_mov_b32 s18, 2129920
    buffer_load_dword v40, v10, s[60:63], s18 offen
    s_mov_b32 s18, 2138112
    buffer_load_dword v41, v10, s[60:63], s18 offen
    s_mov_b32 s18, 2260992
    buffer_load_dword v42, v10, s[60:63], s18 offen
    s_mov_b32 s18, 2269184
    buffer_load_dword v43, v10, s[60:63], s18 offen
    s_mov_b32 s18, 2146304
    buffer_load_dword v44, v10, s[60:63], s18 offen
    s_mov_b32 s18, 2154496
    buffer_load_dword v45, v10, s[60:63], s18 offen
    s_mov_b32 s18, 2277376
    buffer_load_dword v46, v10, s[60:63], s18 offen
    s_mov_b32 s18, 2285568
    buffer_load_dword v47, v10, s[60:63], s18 offen
    s_waitcnt vmcnt(32)
    v_perm_b32 v80, v49, v48, s30
    v_perm_b32 v81, v51, v50, s30
    v_perm_b32 v82, v53, v52, s30
    v_perm_b32 v83, v55, v54, s30
    v_perm_b32 v12, v49, v48, s31
    v_perm_b32 v13, v51, v50, s31
    v_perm_b32 v14, v53, v52, s31
    v_perm_b32 v15, v55, v54, s31
    ds_write_b128 v0, v[12:15] offset:4096
    s_nop 1
    v_perm_b32 v84, v57, v56, s30
    v_perm_b32 v85, v59, v58, s30
    v_perm_b32 v86, v61, v60, s30
    v_perm_b32 v87, v63, v62, s30
    v_perm_b32 v12, v57, v56, s31
    v_perm_b32 v13, v59, v58, s31
    v_perm_b32 v14, v61, v60, s31
    v_perm_b32 v15, v63, v62, s31
    ds_write_b128 v0, v[12:15] offset:5120
    s_nop 1
    s_mov_b32 s18, 294912
    buffer_load_dword v48, v10, s[60:63], s18 offen
    s_mov_b32 s18, 303104
    buffer_load_dword v49, v10, s[60:63], s18 offen
    s_mov_b32 s18, 425984
    buffer_load_dword v50, v10, s[60:63], s18 offen
    s_mov_b32 s18, 434176
    buffer_load_dword v51, v10, s[60:63], s18 offen
    s_mov_b32 s18, 311296
    buffer_load_dword v52, v10, s[60:63], s18 offen
    s_mov_b32 s18, 319488
    buffer_load_dword v53, v10, s[60:63], s18 offen
    s_mov_b32 s18, 442368
    buffer_load_dword v54, v10, s[60:63], s18 offen
    s_mov_b32 s18, 450560
    buffer_load_dword v55, v10, s[60:63], s18 offen
    s_mov_b32 s18, 2392064
    buffer_load_dword v56, v10, s[60:63], s18 offen
    s_mov_b32 s18, 2400256
    buffer_load_dword v57, v10, s[60:63], s18 offen
    s_mov_b32 s18, 2523136
    buffer_load_dword v58, v10, s[60:63], s18 offen
    s_mov_b32 s18, 2531328
    buffer_load_dword v59, v10, s[60:63], s18 offen
    s_mov_b32 s18, 2408448
    buffer_load_dword v60, v10, s[60:63], s18 offen
    s_mov_b32 s18, 2416640
    buffer_load_dword v61, v10, s[60:63], s18 offen
    s_mov_b32 s18, 2539520
    buffer_load_dword v62, v10, s[60:63], s18 offen
    s_mov_b32 s18, 2547712
    buffer_load_dword v63, v10, s[60:63], s18 offen
    s_waitcnt vmcnt(32)
    v_perm_b32 v88, v17, v16, s30
    v_perm_b32 v89, v19, v18, s30
    v_perm_b32 v90, v21, v20, s30
    v_perm_b32 v91, v23, v22, s30
    v_perm_b32 v12, v17, v16, s31
    v_perm_b32 v13, v19, v18, s31
    v_perm_b32 v14, v21, v20, s31
    v_perm_b32 v15, v23, v22, s31
    ds_write_b128 v0, v[12:15] offset:6144
    s_nop 1
    v_perm_b32 v92, v25, v24, s30
    v_perm_b32 v93, v27, v26, s30
    v_perm_b32 v94, v29, v28, s30
    v_perm_b32 v95, v31, v30, s30
    v_perm_b32 v12, v25, v24, s31
    v_perm_b32 v13, v27, v26, s31
    v_perm_b32 v14, v29, v28, s31
    v_perm_b32 v15, v31, v30, s31
    ds_write_b128 v0, v[12:15] offset:7168
    s_nop 1
    s_mov_b32 s18, 557056
    buffer_load_dword v16, v10, s[60:63], s18 offen
    s_mov_b32 s18, 565248
    buffer_load_dword v17, v10, s[60:63], s18 offen
    s_mov_b32 s18, 688128
    buffer_load_dword v18, v10, s[60:63], s18 offen
    s_mov_b32 s18, 696320
    buffer_load_dword v19, v10, s[60:63], s18 offen
    s_mov_b32 s18, 573440
    buffer_load_dword v20, v10, s[60:63], s18 offen
    s_mov_b32 s18, 581632
    buffer_load_dword v21, v10, s[60:63], s18 offen
    s_mov_b32 s18, 704512
    buffer_load_dword v22, v10, s[60:63], s18 offen
    s_mov_b32 s18, 712704
    buffer_load_dword v23, v10, s[60:63], s18 offen
    s_mov_b32 s18, 2654208
    buffer_load_dword v24, v10, s[60:63], s18 offen
    s_mov_b32 s18, 2662400
    buffer_load_dword v25, v10, s[60:63], s18 offen
    s_mov_b32 s18, 2785280
    buffer_load_dword v26, v10, s[60:63], s18 offen
    s_mov_b32 s18, 2793472
    buffer_load_dword v27, v10, s[60:63], s18 offen
    s_mov_b32 s18, 2670592
    buffer_load_dword v28, v10, s[60:63], s18 offen
    s_mov_b32 s18, 2678784
    buffer_load_dword v29, v10, s[60:63], s18 offen
    s_mov_b32 s18, 2801664
    buffer_load_dword v30, v10, s[60:63], s18 offen
    s_mov_b32 s18, 2809856
    buffer_load_dword v31, v10, s[60:63], s18 offen
    s_waitcnt vmcnt(32)
    v_perm_b32 v96, v33, v32, s30
    v_perm_b32 v97, v35, v34, s30
    v_perm_b32 v98, v37, v36, s30
    v_perm_b32 v99, v39, v38, s30
    v_perm_b32 v12, v33, v32, s31
    v_perm_b32 v13, v35, v34, s31
    v_perm_b32 v14, v37, v36, s31
    v_perm_b32 v15, v39, v38, s31
    ds_write_b128 v0, v[12:15] offset:8192
    s_nop 1
    v_perm_b32 v100, v41, v40, s30
    v_perm_b32 v101, v43, v42, s30
    v_perm_b32 v102, v45, v44, s30
    v_perm_b32 v103, v47, v46, s30
    v_perm_b32 v12, v41, v40, s31
    v_perm_b32 v13, v43, v42, s31
    v_perm_b32 v14, v45, v44, s31
    v_perm_b32 v15, v47, v46, s31
    ds_write_b128 v0, v[12:15] offset:9216
    s_nop 1
    s_mov_b32 s18, 819200
    buffer_load_dword v32, v10, s[60:63], s18 offen
    s_mov_b32 s18, 827392
    buffer_load_dword v33, v10, s[60:63], s18 offen
    s_mov_b32 s18, 950272
    buffer_load_dword v34, v10, s[60:63], s18 offen
    s_mov_b32 s18, 958464
    buffer_load_dword v35, v10, s[60:63], s18 offen
    s_mov_b32 s18, 835584
    buffer_load_dword v36, v10, s[60:63], s18 offen
    s_mov_b32 s18, 843776
    buffer_load_dword v37, v10, s[60:63], s18 offen
    s_mov_b32 s18, 966656
    buffer_load_dword v38, v10, s[60:63], s18 offen
    s_mov_b32 s18, 974848
    buffer_load_dword v39, v10, s[60:63], s18 offen
    s_mov_b32 s18, 2916352
    buffer_load_dword v40, v10, s[60:63], s18 offen
    s_mov_b32 s18, 2924544
    buffer_load_dword v41, v10, s[60:63], s18 offen
    s_mov_b32 s18, 3047424
    buffer_load_dword v42, v10, s[60:63], s18 offen
    s_mov_b32 s18, 3055616
    buffer_load_dword v43, v10, s[60:63], s18 offen
    s_mov_b32 s18, 2932736
    buffer_load_dword v44, v10, s[60:63], s18 offen
    s_mov_b32 s18, 2940928
    buffer_load_dword v45, v10, s[60:63], s18 offen
    s_mov_b32 s18, 3063808
    buffer_load_dword v46, v10, s[60:63], s18 offen
    s_mov_b32 s18, 3072000
    buffer_load_dword v47, v10, s[60:63], s18 offen
    s_waitcnt vmcnt(32)
    v_perm_b32 v104, v49, v48, s30
    v_perm_b32 v105, v51, v50, s30
    v_perm_b32 v106, v53, v52, s30
    v_perm_b32 v107, v55, v54, s30
    v_perm_b32 v12, v49, v48, s31
    v_perm_b32 v13, v51, v50, s31
    v_perm_b32 v14, v53, v52, s31
    v_perm_b32 v15, v55, v54, s31
    ds_write_b128 v0, v[12:15] offset:10240
    s_nop 1
    v_perm_b32 v108, v57, v56, s30
    v_perm_b32 v109, v59, v58, s30
    v_perm_b32 v110, v61, v60, s30
    v_perm_b32 v111, v63, v62, s30
    v_perm_b32 v12, v57, v56, s31
    v_perm_b32 v13, v59, v58, s31
    v_perm_b32 v14, v61, v60, s31
    v_perm_b32 v15, v63, v62, s31
    ds_write_b128 v0, v[12:15] offset:11264
    s_nop 1
    s_waitcnt vmcnt(16)
    v_perm_b32 v112, v17, v16, s30
    v_perm_b32 v113, v19, v18, s30
    v_perm_b32 v114, v21, v20, s30
    v_perm_b32 v115, v23, v22, s30
    v_perm_b32 v12, v17, v16, s31
    v_perm_b32 v13, v19, v18, s31
    v_perm_b32 v14, v21, v20, s31
    v_perm_b32 v15, v23, v22, s31
    ds_write_b128 v0, v[12:15] offset:12288
    s_nop 1
    v_perm_b32 v116, v25, v24, s30
    v_perm_b32 v117, v27, v26, s30
    v_perm_b32 v118, v29, v28, s30
    v_perm_b32 v119, v31, v30, s30
    v_perm_b32 v12, v25, v24, s31
    v_perm_b32 v13, v27, v26, s31
    v_perm_b32 v14, v29, v28, s31
    v_perm_b32 v15, v31, v30, s31
    ds_write_b128 v0, v[12:15] offset:13312
    s_nop 1
    s_waitcnt vmcnt(0)
    v_perm_b32 v120, v33, v32, s30
    v_perm_b32 v121, v35, v34, s30
    v_perm_b32 v122, v37, v36, s30
    v_perm_b32 v123, v39, v38, s30
    v_perm_b32 v12, v33, v32, s31
    v_perm_b32 v13, v35, v34, s31
    v_perm_b32 v14, v37, v36, s31
    v_perm_b32 v15, v39, v38, s31
    ds_write_b128 v0, v[12:15] offset:14336
    s_nop 1
    v_perm_b32 v124, v41, v40, s30
    v_perm_b32 v125, v43, v42, s30
    v_perm_b32 v126, v45, v44, s30
    v_perm_b32 v127, v47, v46, s30
    v_perm_b32 v12, v41, v40, s31
    v_perm_b32 v13, v43, v42, s31
    v_perm_b32 v14, v45, v44, s31
    v_perm_b32 v15, v47, v46, s31
    ds_write_b128 v0, v[12:15] offset:15360
    s_nop 1
    s_cmp_eq_u32 s75, 0
    s_cbranch_scc1 L_cf_ok_27
    v_mov_b32 v16, 32
L_e3_spin_28:
    global_load_dword v17, v16, s[12:13] sc1
    s_waitcnt vmcnt(0)
    v_readfirstlane_b32 s24, v17
    s_cmp_lg_u32 s24, 0
    s_cbranch_scc1 L_e3_got_29
    s_sleep 3
    s_branch L_e3_spin_28
L_e3_got_29:
    s_sub_u32 s24, s24, 1
    s_and_b32 s25, s76, 0x00ff00ff
    s_lshr_b32 s26, s76, 8
    s_and_b32 s26, s26, 0x00ff00ff
    s_add_u32 s25, s25, s26
    s_and_b32 s26, s77, 0x00ff00ff
    s_add_u32 s25, s25, s26
    s_lshr_b32 s26, s77, 8
    s_and_b32 s26, s26, 0x00ff00ff
    s_add_u32 s25, s25, s26
    s_lshr_b32 s26, s25, 16
    s_and_b32 s25, s25, 0xffff
    s_add_u32 s25, s25, s26
    s_lshl_b32 s26, s24, 3
    s_lshr_b64 s[26:27], s[76:77], s26
    s_and_b32 s26, s26, 0xff
    s_min_u32 s26, s26, 32
    s_sub_u32 s90, s25, s26
    s_cmp_eq_u32 s24, s78
    s_cselect_b32 s15, s79, 0xffff
    s_cmp_lt_u32 s15, 32
    s_cselect_b32 s15, s15, 0xffff
    s_mov_b32 s75, 0
    s_cmp_lt_u32 s15, 32
    s_cbranch_scc1 L_cf_ok_27
    s_waitcnt vmcnt(0) lgkmcnt(0)
    v_mbcnt_lo_u32_b32 v0, -1, 0
    v_mbcnt_hi_u32_b32 v0, -1, v0
    s_lshl_b32 s24, s14, 6
    v_add_u32 v0, s24, v0
    s_branch L_mg_div_13
L_cf_ok_27:
    s_and_b32 s53, s20, 1
    s_lshl_b32 s53, s53, 12
    s_add_u32 s53, s53, 147456
    v_add_u32 v6, 131072, v6
    v_bfe_u32 v16, v1, 4, 4
    v_bfe_u32 v17, v1, 8, 2
    s_lshl_b32 s18, s20, 2
    s_add_u32 s18, s18, 8
    v_add_u32 v18, s18, v17
    v_mul_u32_u24 v18, 288, v18
    v_lshl_add_u32 v18, v16, 4, v18
    v_add_u32 v18, 139264, v18
    s_lshl_b32 s18, s20, 10
    s_add_u32 s18, s18, 11776
    v_add_u32 v19, s18, v1
    s_cmp_lt_u32 s20, 2
    s_cselect_b64 vcc, -1, 0
    v_cndmask_b32 v11, v19, v18, vcc
    s_lshl_b32 s19, s15, 11
    s_and_b32 s18, s20, 1
    s_lshl_b32 s18, s18, 10
    s_add_u32 s18, s18, s19
    s_cmp_lt_u32 s20, 2
    s_mov_b32 s57, 0x33e0000
    s_cselect_b32 s57, 0x2fe0000, s57
    s_add_u32 s57, s57, s18
    s_cmp_eq_u32 s20, 1
    s_cselect_b32 s87, 2, 0x7fff
    s_waitcnt vmcnt(0) lgkmcnt(0)
    s_barrier
L_kv_chk_30:
    s_cmp_gt_u32 s80, 0
    s_cbranch_scc1 L_kv_ok_31
    v_mov_b32 v16, s81
    buffer_load_dword v17, v16, s[4:7], 0 offen sc1
    s_waitcnt vmcnt(0)
    v_readfirstlane_b32 s82, v17
    s_nop 3
    s_and_b32 s84, s82, 0xff
    s_bfe_u32 s85, s82, 0x80010
    s_min_u32 s84, s84, s85
    s_lshl_b32 s84, s84, 1
    s_bfe_u32 s83, s82, 0x80008
    s_lshr_b32 s82, s82, 24
    s_min_u32 s82, s82, s83
    s_lshl_b32 s82, s82, 1
    s_add_u32 s82, s82, 1
    s_min_u32 s80, s84, s82
    s_cmp_gt_u32 s80, 0
    s_cbranch_scc1 L_kv_ok_31
    s_sleep 4
    s_add_u32 s88, s88, 1
    s_cmp_lt_u32 s88, 0x80000
    s_cbranch_scc1 L_kv_chk_30
L_kv_ok_31:
    s_mov_b32 s18, 0
    s_cmp_lt_u32 s20, 2
    s_cbranch_scc1 L_cB_d0_32
    s_mov_b32 m0, s53
    v_xor_b32 v16, 128, v8
    buffer_load_dwordx4 v8, s[4:7], s18 offen lds
    buffer_load_dwordx4 v8, s[4:7], s18 offen offset:1024 lds
    buffer_load_dwordx4 v16, s[4:7], s18 offen offset:2048 lds
    buffer_load_dwordx4 v16, s[4:7], s18 offen offset:3072 lds
L_cB_d0_32:
    s_waitcnt vmcnt(0)
    s_cmp_lg_u32 s20, 0
    s_cbranch_scc1 L_cb_wait_33
    s_mov_b64 exec, 1
    v_mov_b32 v17, 36
L_cb_spin_34:
    global_load_dword v16, v17, s[12:13] sc1
    s_waitcnt vmcnt(0)
    v_readfirstlane_b32 s18, v16
    s_cmp_lt_u32 s18, 128
    s_cbranch_scc1 L_cb_spin_34
    s_mov_b64 exec, -1
L_cb_wait_33:
    s_barrier
    s_mov_b32 s34, 0
    s_mov_b32 s35, 8192
    s_mov_b32 s36, 0
    s_lshl_b32 s50, s15, 13
    s_add_u32 s50, s50, 0x1f80000
    s_and_b32 s51, s20, 1
    s_lshl_b32 s51, s51, 12
    s_add_u32 s50, s50, s51
    s_mov_b32 s46, 0x000f000f
    s_mov_b32 s47, 0
    s_mov_b32 s89, 0x3f80
    s_lshl_b32 s60, s20, 2
    s_add_u32 s60, s60, 143936
    s_waitcnt lgkmcnt(0)
.p2align 6
L_cB_loop_35:
    s_barrier
    s_cmp_eq_u32 s34, 0
    s_cbranch_scc1 L_cB_nob_37
    ds_read_b128 v[24:27], v11
L_cB_pb_38:
    s_waitcnt vmcnt(0)
    v_max3_u32 v16, v12, v13, v14
    v_max_u32 v16, v16, v15
    v_cmp_eq_u32 vcc, -1, v16
    s_cbranch_vccz L_cB_okb_39
    s_add_u32 s48, s48, 1
    s_cmp_gt_u32 s48, 0x200000
    s_cbranch_scc1 L_c8_exit_15
    buffer_load_dwordx4 v[12:15], v6, s[4:7], s40 offen sc1
    s_branch L_cB_pb_38
L_cB_okb_39:
    ds_write_b128 v6, v[12:15] offset:4096
    s_waitcnt lgkmcnt(0)
L_cB_nob_37:
    s_barrier
    s_add_u32 s41, s34, 1
    ds_read_b128 v[32:35], v1 offset:0
    ds_read_b128 v[36:39], v1 offset:1024
    ds_read_b128 v[40:43], v1 offset:2048
    ds_read_b128 v[44:47], v1 offset:3072
    ds_read_b128 v[48:51], v0 offset:0
    ds_read_b128 v[52:55], v0 offset:1024
    ds_read_b128 v[56:59], v0 offset:2048
    ds_read_b128 v[60:63], v0 offset:3072
    s_and_b32 s37, s34, 1
    s_lshl_b32 s37, s37, 18
    s_bfe_u32 s38, s34, 0x10001
    s_add_u32 s52, s37, s59
    s_add_u32 s51, s52, 1024
    s_xor_b32 s53, s53, 0x2000
    s_cmp_eq_u32 s34, 0
    s_cbranch_scc1 L_cB_np_42
    s_lshl_b32 s58, s34, 16
    s_add_u32 s58, s58, s57
    s_sub_u32 s58, s58, 0x10000
    v_min_u32 v24, -2, v24
    v_min_u32 v26, -2, v26
    buffer_store_dwordx4 v[24:27], v1, s[4:7], s58 offen sc1
L_cB_np_42:
    s_cmp_lt_u32 s34, s87
    s_cbranch_scc1 L_cB_pa_43
    s_mov_b64 exec, 1
    s_sub_u32 s58, s34, 1
    v_mov_b32 v14, s58
    v_mov_b32 v15, 8
    buffer_store_byte v14, v15, s[4:7], s81 offen sc1
    s_mov_b64 exec, -1
L_cB_pa_43:
    s_cmp_ge_u32 s34, 63
    s_cbranch_scc1 L_cB_nw2_44
    s_cmp_ge_u32 s80, 64
    s_cbranch_scc1 L_cB_ka_45
    s_cmp_eq_u32 s34, 0
    s_cbranch_scc1 L_cB_ka_45
    v_readfirstlane_b32 s82, v10
    s_nop 3
    s_and_b32 s84, s82, 0xff
    s_bfe_u32 s85, s82, 0x80010
    s_min_u32 s84, s84, s85
    s_lshl_b32 s84, s84, 1
    s_bfe_u32 s83, s82, 0x80008
    s_lshr_b32 s82, s82, 24
    s_min_u32 s82, s82, s83
    s_lshl_b32 s82, s82, 1
    s_add_u32 s82, s82, 1
    s_min_u32 s80, s84, s82
L_cB_ka_45:
L_kv_chk_46:
    s_cmp_gt_u32 s80, s41
    s_cbranch_scc1 L_kv_ok_47
    v_mov_b32 v13, s81
    buffer_load_dword v14, v13, s[4:7], 0 offen sc1
    s_waitcnt vmcnt(0)
    v_readfirstlane_b32 s82, v14
    s_nop 3
    s_and_b32 s84, s82, 0xff
    s_bfe_u32 s85, s82, 0x80010
    s_min_u32 s84, s84, s85
    s_lshl_b32 s84, s84, 1
    s_bfe_u32 s83, s82, 0x80008
    s_lshr_b32 s82, s82, 24
    s_min_u32 s82, s82, s83
    s_lshl_b32 s82, s82, 1
    s_add_u32 s82, s82, 1
    s_min_u32 s80, s84, s82
    s_cmp_gt_u32 s80, s41
    s_cbranch_scc1 L_kv_ok_47
    s_sleep 4
    s_add_u32 s88, s88, 1
    s_cmp_lt_u32 s88, 0x80000
    s_cbranch_scc1 L_kv_chk_46
L_kv_ok_47:
    s_cmp_lt_u32 s20, 2
    s_cbranch_scc0 L_cB_k2_48
    v_lshlrev_b32 v12, 2, v1
    s_lshl_b32 s54, s41, 18
    s_add_u32 s54, s54, s50
    s_mov_b32 m0, 144128
    s_nop 0
    buffer_load_dword v12, s[4:7], s54 offen lds
    s_branch L_cB_nw2_44
L_cB_k2_48:
    s_lshl_b32 s42, s41, 13
    s_mov_b32 m0, s53
    v_xor_b32 v12, 128, v8
    buffer_load_dwordx4 v8, s[4:7], s42 offen lds
    buffer_load_dwordx4 v8, s[4:7], s42 offen offset:1024 lds
    buffer_load_dwordx4 v12, s[4:7], s42 offen offset:2048 lds
    buffer_load_dwordx4 v12, s[4:7], s42 offen offset:3072 lds
L_cB_nw2_44:
    s_cmp_ge_u32 s80, 64
    s_cbranch_scc1 L_cB_kb_49
    v_mov_b32 v13, s81
    buffer_load_dword v10, v13, s[4:7], 0 offen sc1
L_cB_kb_49:
    v_mov_b64 v[16:17], 0
    v_mov_b64 v[18:19], 0
    v_mov_b64 v[20:21], 0
    v_mov_b64 v[22:23], 0
    ds_read_b128 v[24:27], v0 offset:4096
    ds_read_b128 v[28:31], v0 offset:5120
    s_waitcnt lgkmcnt(0)
    v_smfmac_f32_16x16x64_bf16 v[16:19], v[32:35], v[64:71], v2
    v_smfmac_f32_16x16x64_bf16 v[20:23], v[32:35], v[48:55], v2
    ds_read_b128 v[48:51], v0 offset:6144
    ds_read_b128 v[52:55], v0 offset:7168
    ds_read_b128 v[32:35], v1 offset:4096
    v_smfmac_f32_16x16x64_bf16 v[16:19], v[36:39], v[72:79], v2
    v_smfmac_f32_16x16x64_bf16 v[20:23], v[36:39], v[56:63], v2
    ds_read_b128 v[56:59], v0 offset:8192
    ds_read_b128 v[60:63], v0 offset:9216
    ds_read_b128 v[36:39], v1 offset:5120
    v_smfmac_f32_16x16x64_bf16 v[16:19], v[40:43], v[80:87], v2
    v_smfmac_f32_16x16x64_bf16 v[20:23], v[40:43], v[24:31], v2
    ds_read_b128 v[24:27], v0 offset:10240
    ds_read_b128 v[28:31], v0 offset:11264
    ds_read_b128 v[40:43], v1 offset:6144
    v_smfmac_f32_16x16x64_bf16 v[16:19], v[44:47], v[88:95], v2
    s_waitcnt lgkmcnt(7)
    v_smfmac_f32_16x16x64_bf16 v[20:23], v[44:47], v[48:55], v2
    ds_read_b128 v[48:51], v0 offset:12288
    ds_read_b128 v[52:55], v0 offset:13312
    ds_read_b128 v[44:47], v1 offset:7168
    s_waitcnt lgkmcnt(9)
    v_smfmac_f32_16x16x64_bf16 v[16:19], v[32:35], v[96:103], v2
    s_waitcnt lgkmcnt(7)
    v_smfmac_f32_16x16x64_bf16 v[20:23], v[32:35], v[56:63], v2
    ds_read_b128 v[56:59], v0 offset:14336
    ds_read_b128 v[60:63], v0 offset:15360
    s_waitcnt lgkmcnt(8)
    v_smfmac_f32_16x16x64_bf16 v[16:19], v[36:39], v[104:111], v2
    s_waitcnt lgkmcnt(6)
    v_smfmac_f32_16x16x64_bf16 v[20:23], v[36:39], v[24:31], v2
    s_waitcnt lgkmcnt(5)
    v_smfmac_f32_16x16x64_bf16 v[16:19], v[40:43], v[112:119], v2
    s_waitcnt lgkmcnt(3)
    v_smfmac_f32_16x16x64_bf16 v[20:23], v[40:43], v[48:55], v2
    s_waitcnt lgkmcnt(2)
    v_smfmac_f32_16x16x64_bf16 v[16:19], v[44:47], v[120:127], v2
    s_waitcnt lgkmcnt(0)
    v_smfmac_f32_16x16x64_bf16 v[20:23], v[44:47], v[56:63], v2
    s_nop 7
    v_add_f32 v16, v16, v17
    v_add_f32 v18, v18, v19
    v_cvt_pk_bf16_f32 v16, v16, v18
    ds_write_b32 v9, v16 offset:0
    v_add_f32 v20, v20, v21
    v_add_f32 v22, v22, v23
    v_cvt_pk_bf16_f32 v20, v20, v22
    ds_write_b32 v9, v20 offset:16
    v_mov_b64 v[24:25], 0
    v_mov_b64 v[26:27], 0
    s_waitcnt lgkmcnt(0)
    s_barrier
    s_cmp_eq_u32 s34, 63
    s_cbranch_scc1 L_cB_fin_36
    v_mfma_f32_32x32x16_bf16 v[32:47], v[24:27], v[24:27], 0
    v_mfma_f32_32x32x16_bf16 v[48:63], v[24:27], v[24:27], 0
    v_bfe_u32 v12, v1, 5, 3
    v_and_b32 v13, 16, v1
    v_lshlrev_b32_e64 v13, v13, s89
    v_cmp_eq_u32 vcc, 0, v12
    s_nop 1
    v_cndmask_b32 v16, 0, v13, vcc
    v_cmp_eq_u32 vcc, 1, v12
    s_nop 1
    v_cndmask_b32 v17, 0, v13, vcc
    v_cmp_eq_u32 vcc, 2, v12
    s_nop 1
    v_cndmask_b32 v18, 0, v13, vcc
    v_cmp_eq_u32 vcc, 3, v12
    s_nop 1
    v_cndmask_b32 v19, 0, v13, vcc
    v_mov_b32 v14, -1
    v_mov_b32 v15, -1
    s_mov_b32 s41, s37
    s_add_u32 s40, s35, 0x38e0000
    s_nop 0
    s_setprio 3
    s_barrier
    ds_read_b128 v[24:27], v7
    ds_read_b128 v[28:31], v7 offset:128
    s_waitcnt lgkmcnt(1)
    v_smfmac_f32_16x16x64_bf16 v[32:35], v[24:27], a[0:7], v2
    v_smfmac_f32_16x16x64_bf16 v[36:39], v[24:27], a[16:23], v2
    s_waitcnt lgkmcnt(0)
    v_smfmac_f32_16x16x64_bf16 v[32:35], v[28:31], a[8:15], v2
    v_smfmac_f32_16x16x64_bf16 v[36:39], v[28:31], a[24:31], v2
    v_smfmac_f32_16x16x64_bf16 v[40:43], v[24:27], a[32:39], v2
    v_smfmac_f32_16x16x64_bf16 v[40:43], v[28:31], a[40:47], v2
    v_smfmac_f32_16x16x64_bf16 v[44:47], v[24:27], a[48:55], v2
    v_smfmac_f32_16x16x64_bf16 v[44:47], v[28:31], a[56:63], v2
    v_smfmac_f32_16x16x64_bf16 v[48:51], v[24:27], a[64:71], v2
    v_add_f32 v32, v32, v33
    v_smfmac_f32_16x16x64_bf16 v[48:51], v[28:31], a[72:79], v2
    v_add_f32 v34, v34, v35
    v_add_f32 v36, v36, v37
    v_add_f32 v38, v38, v39
    v_add_f32 v40, v40, v41
    v_add_f32 v42, v42, v43
    v_add_f32 v44, v44, v45
    v_add_f32 v46, v46, v47
    v_cvt_pk_bf16_f32 v32, v32, v36
    v_cvt_pk_bf16_f32 v33, v40, v44
    v_cvt_pk_bf16_f32 v34, v34, v38
    v_cvt_pk_bf16_f32 v35, v42, v46
    v_and_or_b32 v32, v32, -2, s38
    buffer_store_dwordx4 v[32:35], v3, s[4:7], s41 offen
    v_smfmac_f32_16x16x64_bf16 v[52:55], v[24:27], a[80:87], v2
    s_add_u32 s41, s41, 32768
    v_smfmac_f32_16x16x64_bf16 v[52:55], v[28:31], a[88:95], v2
    v_smfmac_f32_16x16x64_bf16 v[56:59], v[24:27], a[96:103], v2
    v_smfmac_f32_16x16x64_bf16 v[56:59], v[28:31], a[104:111], v2
    v_smfmac_f32_16x16x64_bf16 v[60:63], v[24:27], a[112:119], v2
    v_smfmac_f32_16x16x64_bf16 v[60:63], v[28:31], a[120:127], v2
    s_nop 1
    v_add_f32 v48, v48, v49
    v_add_f32 v50, v50, v51
    v_add_f32 v52, v52, v53
    v_add_f32 v54, v54, v55
    v_add_f32 v56, v56, v57
    v_add_f32 v58, v58, v59
    v_add_f32 v60, v60, v61
    v_add_f32 v62, v62, v63
    v_cvt_pk_bf16_f32 v48, v48, v52
    v_cvt_pk_bf16_f32 v49, v56, v60
    v_cvt_pk_bf16_f32 v50, v50, v54
    v_cvt_pk_bf16_f32 v51, v58, v62
    v_and_or_b32 v48, v48, -2, s38
    buffer_store_dwordx4 v[48:51], v3, s[4:7], s41 offen
    s_sleep 2
    s_bitcmp0_b32 s15, 2
    s_cbranch_scc1 L_cB_pd2_52
    s_sleep 1
L_cB_pd2_52:
    buffer_load_dwordx4 v[24:27], v4, s[4:7], s52 offen sc1
    buffer_load_dwordx4 v[28:31], v4, s[4:7], s51 offen sc1
    s_nop 15
    s_nop 15
    s_nop 7
    buffer_load_dwordx4 v[56:59], v4, s[4:7], s52 offen sc1
    buffer_load_dwordx4 v[60:63], v4, s[4:7], s51 offen sc1
L_cB_pollP_50:
    s_waitcnt vmcnt(2)
    v_xor_b32 v12, s38, v24
    v_xor_b32 v13, s38, v28
    v_or_b32 v12, v12, v13
    v_and_b32 v12, 1, v12
    v_cmp_ne_u32 vcc, 0, v12
    s_cbranch_vccz L_cB_okP_51
    buffer_load_dwordx4 v[24:27], v4, s[4:7], s52 offen sc1
    buffer_load_dwordx4 v[28:31], v4, s[4:7], s51 offen sc1
    s_waitcnt vmcnt(2)
    v_xor_b32 v12, s38, v56
    v_xor_b32 v13, s38, v60
    v_or_b32 v12, v12, v13
    v_and_b32 v12, 1, v12
    v_cmp_ne_u32 vcc, 0, v12
    s_cbranch_vccz L_cB_okP1_53
    buffer_load_dwordx4 v[56:59], v4, s[4:7], s52 offen sc1
    buffer_load_dwordx4 v[60:63], v4, s[4:7], s51 offen sc1
    s_add_u32 s48, s48, 1
    s_cmp_gt_u32 s48, 0x200000
    s_cbranch_scc1 L_c8_exit_15
    s_branch L_cB_pollP_50
L_cB_okP1_53:
    v_mfma_f32_16x16x32_bf16 v[20:23], v[16:19], v[56:59], 0
    v_mfma_f32_16x16x32_bf16 v[20:23], v[16:19], v[60:63], v[20:23]
    s_branch L_cB_okP2_54
L_cB_okP_51:
    v_mfma_f32_16x16x32_bf16 v[20:23], v[16:19], v[24:27], 0
    v_mfma_f32_16x16x32_bf16 v[20:23], v[16:19], v[28:31], v[20:23]
L_cB_okP2_54:
    s_mov_b32 s56, s36
    s_mov_b32 s36, s35
    s_add_u32 s34, s34, 1
    s_nop 4
    v_add_f32_dpp v20, v20, v20 row_ror:4 row_mask:0xf bank_mask:0xf
    v_add_f32_dpp v21, v21, v21 row_ror:4 row_mask:0xf bank_mask:0xf
    v_add_f32_dpp v22, v22, v22 row_ror:4 row_mask:0xf bank_mask:0xf
    v_add_f32_dpp v23, v23, v23 row_ror:4 row_mask:0xf bank_mask:0xf
    v_add_f32_dpp v20, v20, v20 row_ror:8 row_mask:0xf bank_mask:0xf
    v_add_f32_dpp v21, v21, v21 row_ror:8 row_mask:0xf bank_mask:0xf
    v_add_f32_dpp v22, v22, v22 row_ror:8 row_mask:0xf bank_mask:0xf
    v_add_f32_dpp v23, v23, v23 row_ror:8 row_mask:0xf bank_mask:0xf
    s_mov_b64 exec, s[46:47]
    v_cvt_pk_bf16_f32 v12, v20, v21
    v_cvt_pk_bf16_f32 v13, v22, v23
    v_min_u32 v12, -2, v12
    v_min_u32 v13, -2, v13
    buffer_store_dwordx2 v[12:13], v5, s[4:7], s35 offen
    buffer_store_dwordx2 v[14:15], v5, s[4:7], s56 offen
    s_mov_b64 exec, -1
    s_add_u32 s35, s35, 8192
    s_cmp_eq_u32 s35, 24576
    s_cselect_b32 s35, 0, s35
    s_add_u32 s56, s40, 4096
    s_sleep 2
    buffer_load_dwordx4 v[32:35], v6, s[4:7], s40 offen sc1
    s_nop 15
    s_nop 15
    s_nop 7
    buffer_load_dwordx4 v[36:39], v6, s[4:7], s40 offen sc1
L_cB_pollM_55:
    s_waitcnt vmcnt(1)
    v_max3_u32 v40, v32, v33, v34
    v_max_u32 v40, v40, v35
    v_cmp_eq_u32 vcc, -1, v40
    s_cbranch_vccz L_cB_okM_56
    buffer_load_dwordx4 v[32:35], v6, s[4:7], s40 offen sc1
    s_waitcnt vmcnt(1)
    v_max3_u32 v40, v36, v37, v38
    v_max_u32 v40, v40, v39
    v_cmp_eq_u32 vcc, -1, v40
    s_cbranch_vccz L_cB_okM1_57
    buffer_load_dwordx4 v[36:39], v6, s[4:7], s40 offen sc1
    s_add_u32 s48, s48, 1
    s_cmp_gt_u32 s48, 0x200000
    s_cbranch_scc1 L_c8_exit_15
    s_branch L_cB_pollM_55
L_cB_okM1_57:
    ds_write_b128 v6, v[36:39]
    s_branch L_cB_okM2_58
L_cB_okM_56:
    ds_write_b128 v6, v[32:35]
L_cB_okM2_58:
    s_nop 0
    s_nop 0
    s_nop 0
    buffer_load_dwordx4 v[12:15], v6, s[4:7], s56 offen sc1
    s_mov_b32 s40, s56
    s_setprio 0
    s_waitcnt lgkmcnt(0)
    s_branch L_cB_loop_35
L_cB_fin_36:
    ds_read_b128 v[24:27], v11
    s_lshl_b32 s58, s34, 16
    s_add_u32 s58, s58, s57
    s_waitcnt lgkmcnt(0)
    v_min_u32 v24, -2, v24
    v_min_u32 v26, -2, v26
    buffer_store_dwordx4 v[24:27], v1, s[4:7], s58 offen sc1
    s_waitcnt vmcnt(0)
    s_barrier
    s_cmp_lg_u32 s20, 1
    s_cbranch_scc1 L_c8_exit_15
    s_mov_b64 exec, 1
    v_mov_b32 v16, 64
    v_mov_b32 v17, 8
    buffer_store_byte v16, v17, s[4:7], s81 offen sc1
    s_mov_b64 exec, -1
L_c8_exit_15:
    s_waitcnt vmcnt(0)
    s_endpgm
L_mg_div_13:
    s_barrier
L_mg_worker_2:
    s_cmp_ge_u32 s90, 224
    s_cbranch_scc1 L_mg_end_1
    s_cmp_ge_u32 s14, 4
    s_cbranch_scc1 L_mg_end_1
    s_cmp_ge_u32 s90, 192
    s_cbranch_scc1 L_mg_ssm0_59
    s_mov_b32 s15, s90
    s_lshr_b32 s68, s15, 1
    s_and_b32 s69, s15, 1
    s_lshr_b32 s70, s68, 5
    s_and_b32 s71, s68, 31
    s_lshl_b32 s72, s70, 3
    s_add_u32 s72, s72, 16
    s_load_dwordx2 s[8:9], s[0:1], 0
    s_load_dwordx2 s[10:11], s[0:1], s72
    v_and_b32 v1, 63, v0
    v_and_b32 v3, 15, v1
    v_lshrrev_b32 v4, 4, v1
    s_waitcnt lgkmcnt(0)
    s_mov_b32 s16, s8
    s_and_b32 s17, s9, 0xffff
    s_mov_b32 s18, 0x200000
    s_mov_b32 s19, 0x00020000
    s_mov_b32 s20, s10
    s_and_b32 s21, s11, 0xffff
    s_mov_b32 s22, 0x400000
    s_mov_b32 s23, 0x00020000
    v_lshlrev_b32 v5, 16, v4
    s_lshl_b32 s28, s71, 8
    s_lshl_b32 s29, s14, 6
    s_add_u32 s28, s28, s29
    v_lshl_add_u32 v5, v3, 2, v5
    v_add_u32 v5, s28, v5
    s_mov_b32 s30, 0x05040100
    s_mov_b32 s31, 0x07060302
    s_lshl_b32 s32, s14, 3
    s_add_u32 s33, s32, 0
    s_and_b32 s33, s33, 15
    v_xor_b32 v8, s33, v1
    v_lshlrev_b32 v8, 4, v8
    s_add_u32 s33, s32, 1
    s_and_b32 s33, s33, 15
    v_xor_b32 v9, s33, v1
    v_lshlrev_b32 v9, 4, v9
    s_add_u32 s33, s32, 2
    s_and_b32 s33, s33, 15
    v_xor_b32 v10, s33, v1
    v_lshlrev_b32 v10, 4, v10
    s_add_u32 s33, s32, 3
    s_and_b32 s33, s33, 15
    v_xor_b32 v11, s33, v1
    v_lshlrev_b32 v11, 4, v11
    s_add_u32 s33, s32, 4
    s_and_b32 s33, s33, 15
    v_xor_b32 v12, s33, v1
    v_lshlrev_b32 v12, 4, v12
    s_add_u32 s33, s32, 5
    s_and_b32 s33, s33, 15
    v_xor_b32 v13, s33, v1
    v_lshlrev_b32 v13, 4, v13
    s_add_u32 s33, s32, 6
    s_and_b32 s33, s33, 15
    v_xor_b32 v14, s33, v1
    v_lshlrev_b32 v14, 4, v14
    s_add_u32 s33, s32, 7
    s_and_b32 s33, s33, 15
    v_xor_b32 v15, s33, v1
    v_lshlrev_b32 v15, 4, v15
    v_add_u32 v6, 0, v4
    v_xor_b32 v6, v6, v3
    v_lshlrev_b32 v6, 4, v6
    v_lshl_add_u32 v16, v3, 10, v6
    v_add_u32 v20, 0x10000, v16
    v_add_u32 v6, 4, v4
    v_xor_b32 v6, v6, v3
    v_lshlrev_b32 v6, 4, v6
    v_lshl_add_u32 v17, v3, 10, v6
    v_add_u32 v21, 0x10000, v17
    v_add_u32 v6, 8, v4
    v_xor_b32 v6, v6, v3
    v_lshlrev_b32 v6, 4, v6
    v_lshl_add_u32 v18, v3, 10, v6
    v_add_u32 v22, 0x10000, v18
    v_add_u32 v6, 12, v4
    v_xor_b32 v6, v6, v3
    v_lshlrev_b32 v6, 4, v6
    v_lshl_add_u32 v19, v3, 10, v6
    v_add_u32 v23, 0x10000, v19
    s_mov_b32 s34, s69
    s_lshl_b32 s36, s32, 10
    s_lshl_b32 s35, s34, 15
    s_add_u32 s35, s35, s36
    s_add_u32 m0, s36, 0
    s_add_u32 s37, s35, 0
    buffer_load_dwordx4 v8, s[16:19], s37 offen lds
    s_add_u32 m0, s36, 1024
    s_add_u32 s37, s35, 1024
    buffer_load_dwordx4 v9, s[16:19], s37 offen lds
    s_add_u32 m0, s36, 2048
    s_add_u32 s37, s35, 2048
    buffer_load_dwordx4 v10, s[16:19], s37 offen lds
    s_add_u32 m0, s36, 3072
    s_add_u32 s37, s35, 3072
    buffer_load_dwordx4 v11, s[16:19], s37 offen lds
    s_add_u32 m0, s36, 4096
    s_add_u32 s37, s35, 4096
    buffer_load_dwordx4 v12, s[16:19], s37 offen lds
    s_add_u32 m0, s36, 5120
    s_add_u32 s37, s35, 5120
    buffer_load_dwordx4 v13, s[16:19], s37 offen lds
    s_add_u32 m0, s36, 6144
    s_add_u32 s37, s35, 6144
    buffer_load_dwordx4 v14, s[16:19], s37 offen lds
    s_add_u32 m0, s36, 7168
    s_add_u32 s37, s35, 7168
    buffer_load_dwordx4 v15, s[16:19], s37 offen lds
    v_lshlrev_b32 v5, 13, v4
    v_lshl_add_u32 v5, v3, 4, v5
    s_lshl_b32 s28, s71, 8
    v_add_u32 v5, s28, v5
    s_lshl_b32 s38, s14, 20
    s_lshl_b32 s39, s14, 15
    s_add_u32 s39, s39, 32768
    s_add_u32 m0, s39, 0
    s_add_u32 s40, s38, 0
    buffer_load_dwordx4 v5, s[20:23], s40 offen lds
    s_add_u32 m0, s39, 1024
    s_add_u32 s40, s38, 32768
    buffer_load_dwordx4 v5, s[20:23], s40 offen lds
    s_add_u32 m0, s39, 2048
    s_add_u32 s40, s38, 65536
    buffer_load_dwordx4 v5, s[20:23], s40 offen lds
    s_add_u32 m0, s39, 3072
    s_add_u32 s40, s38, 98304
    buffer_load_dwordx4 v5, s[20:23], s40 offen lds
    s_add_u32 m0, s39, 4096
    s_add_u32 s40, s38, 131072
    buffer_load_dwordx4 v5, s[20:23], s40 offen lds
    s_add_u32 m0, s39, 5120
    s_add_u32 s40, s38, 163840
    buffer_load_dwordx4 v5, s[20:23], s40 offen lds
    s_add_u32 m0, s39, 6144
    s_add_u32 s40, s38, 196608
    buffer_load_dwordx4 v5, s[20:23], s40 offen lds
    s_add_u32 m0, s39, 7168
    s_add_u32 s40, s38, 229376
    buffer_load_dwordx4 v5, s[20:23], s40 offen lds
    s_add_u32 m0, s39, 8192
    s_add_u32 s40, s38, 262144
    buffer_load_dwordx4 v5, s[20:23], s40 offen lds
    s_add_u32 m0, s39, 9216
    s_add_u32 s40, s38, 294912
    buffer_load_dwordx4 v5, s[20:23], s40 offen lds
    s_add_u32 m0, s39, 10240
    s_add_u32 s40, s38, 327680
    buffer_load_dwordx4 v5, s[20:23], s40 offen lds
    s_add_u32 m0, s39, 11264
    s_add_u32 s40, s38, 360448
    buffer_load_dwordx4 v5, s[20:23], s40 offen lds
    s_add_u32 m0, s39, 12288
    s_add_u32 s40, s38, 393216
    buffer_load_dwordx4 v5, s[20:23], s40 offen lds
    s_add_u32 m0, s39, 13312
    s_add_u32 s40, s38, 425984
    buffer_load_dwordx4 v5, s[20:23], s40 offen lds
    s_add_u32 m0, s39, 14336
    s_add_u32 s40, s38, 458752
    buffer_load_dwordx4 v5, s[20:23], s40 offen lds
    s_add_u32 m0, s39, 15360
    s_add_u32 s40, s38, 491520
    buffer_load_dwordx4 v5, s[20:23], s40 offen lds
    s_add_u32 m0, s39, 16384
    s_add_u32 s40, s38, 524288
    buffer_load_dwordx4 v5, s[20:23], s40 offen lds
    s_add_u32 m0, s39, 17408
    s_add_u32 s40, s38, 557056
    buffer_load_dwordx4 v5, s[20:23], s40 offen lds
    s_add_u32 m0, s39, 18432
    s_add_u32 s40, s38, 589824
    buffer_load_dwordx4 v5, s[20:23], s40 offen lds
    s_add_u32 m0, s39, 19456
    s_add_u32 s40, s38, 622592
    buffer_load_dwordx4 v5, s[20:23], s40 offen lds
    s_add_u32 m0, s39, 20480
    s_add_u32 s40, s38, 655360
    buffer_load_dwordx4 v5, s[20:23], s40 offen lds
    s_add_u32 m0, s39, 21504
    s_add_u32 s40, s38, 688128
    buffer_load_dwordx4 v5, s[20:23], s40 offen lds
    s_add_u32 m0, s39, 22528
    s_add_u32 s40, s38, 720896
    buffer_load_dwordx4 v5, s[20:23], s40 offen lds
    s_add_u32 m0, s39, 23552
    s_add_u32 s40, s38, 753664
    buffer_load_dwordx4 v5, s[20:23], s40 offen lds
    s_add_u32 m0, s39, 24576
    s_add_u32 s40, s38, 786432
    buffer_load_dwordx4 v5, s[20:23], s40 offen lds
    s_add_u32 m0, s39, 25600
    s_add_u32 s40, s38, 819200
    buffer_load_dwordx4 v5, s[20:23], s40 offen lds
    s_add_u32 m0, s39, 26624
    s_add_u32 s40, s38, 851968
    buffer_load_dwordx4 v5, s[20:23], s40 offen lds
    s_add_u32 m0, s39, 27648
    s_add_u32 s40, s38, 884736
    buffer_load_dwordx4 v5, s[20:23], s40 offen lds
    s_add_u32 m0, s39, 28672
    s_add_u32 s40, s38, 917504
    buffer_load_dwordx4 v5, s[20:23], s40 offen lds
    s_add_u32 m0, s39, 29696
    s_add_u32 s40, s38, 950272
    buffer_load_dwordx4 v5, s[20:23], s40 offen lds
    s_add_u32 m0, s39, 30720
    s_add_u32 s40, s38, 983040
    buffer_load_dwordx4 v5, s[20:23], s40 offen lds
    s_add_u32 m0, s39, 31744
    s_add_u32 s40, s38, 1015808
    buffer_load_dwordx4 v5, s[20:23], s40 offen lds
    v_lshrrev_b32 v34, 2, v3
    v_lshl_add_u32 v34, v4, 3, v34
    v_lshlrev_b32 v34, 8, v34
    v_and_b32 v35, 3, v3
    v_lshl_add_u32 v34, v35, 4, v34
    s_add_u32 s40, s29, 32768
    v_add_u32 v34, s40, v34
    v_add_u32 v35, 0x10000, v34
    s_waitcnt vmcnt(0)
    s_barrier
    ds_read_b64_tr_b16 a[0:1], v34 offset:0
    ds_read_b64_tr_b16 a[2:3], v34 offset:1024
    ds_read_b64_tr_b16 a[4:5], v34 offset:8
    ds_read_b64_tr_b16 a[6:7], v34 offset:1032
    ds_read_b64_tr_b16 a[8:9], v34 offset:8192
    ds_read_b64_tr_b16 a[10:11], v34 offset:9216
    ds_read_b64_tr_b16 a[12:13], v34 offset:8200
    ds_read_b64_tr_b16 a[14:15], v34 offset:9224
    ds_read_b64_tr_b16 a[16:17], v34 offset:16384
    ds_read_b64_tr_b16 a[18:19], v34 offset:17408
    ds_read_b64_tr_b16 a[20:21], v34 offset:16392
    ds_read_b64_tr_b16 a[22:23], v34 offset:17416
    s_waitcnt lgkmcnt(0)
    ds_read_b64_tr_b16 a[24:25], v34 offset:24576
    ds_read_b64_tr_b16 a[26:27], v34 offset:25600
    ds_read_b64_tr_b16 a[28:29], v34 offset:24584
    ds_read_b64_tr_b16 a[30:31], v34 offset:25608
    ds_read_b64_tr_b16 a[32:33], v34 offset:32768
    ds_read_b64_tr_b16 a[34:35], v34 offset:33792
    ds_read_b64_tr_b16 a[36:37], v34 offset:32776
    ds_read_b64_tr_b16 a[38:39], v34 offset:33800
    ds_read_b64_tr_b16 a[40:41], v34 offset:40960
    ds_read_b64_tr_b16 a[42:43], v34 offset:41984
    ds_read_b64_tr_b16 a[44:45], v34 offset:40968
    ds_read_b64_tr_b16 a[46:47], v34 offset:41992
    s_waitcnt lgkmcnt(0)
    ds_read_b64_tr_b16 a[48:49], v34 offset:49152
    ds_read_b64_tr_b16 a[50:51], v34 offset:50176
    ds_read_b64_tr_b16 a[52:53], v34 offset:49160
    ds_read_b64_tr_b16 a[54:55], v34 offset:50184
    ds_read_b64_tr_b16 a[56:57], v34 offset:57344
    ds_read_b64_tr_b16 a[58:59], v34 offset:58368
    ds_read_b64_tr_b16 a[60:61], v34 offset:57352
    ds_read_b64_tr_b16 a[62:63], v34 offset:58376
    ds_read_b64_tr_b16 a[64:65], v35 offset:0
    ds_read_b64_tr_b16 a[66:67], v35 offset:1024
    ds_read_b64_tr_b16 a[68:69], v35 offset:8
    ds_read_b64_tr_b16 a[70:71], v35 offset:1032
    s_waitcnt lgkmcnt(0)
    ds_read_b64_tr_b16 a[72:73], v35 offset:8192
    ds_read_b64_tr_b16 a[74:75], v35 offset:9216
    ds_read_b64_tr_b16 a[76:77], v35 offset:8200
    ds_read_b64_tr_b16 a[78:79], v35 offset:9224
    ds_read_b64_tr_b16 a[80:81], v35 offset:16384
    ds_read_b64_tr_b16 a[82:83], v35 offset:17408
    ds_read_b64_tr_b16 a[84:85], v35 offset:16392
    ds_read_b64_tr_b16 a[86:87], v35 offset:17416
    ds_read_b64_tr_b16 a[88:89], v35 offset:24576
    ds_read_b64_tr_b16 a[90:91], v35 offset:25600
    ds_read_b64_tr_b16 a[92:93], v35 offset:24584
    ds_read_b64_tr_b16 a[94:95], v35 offset:25608
    s_waitcnt lgkmcnt(0)
    ds_read_b64_tr_b16 a[96:97], v35 offset:32768
    ds_read_b64_tr_b16 a[98:99], v35 offset:33792
    ds_read_b64_tr_b16 a[100:101], v35 offset:32776
    ds_read_b64_tr_b16 a[102:103], v35 offset:33800
    ds_read_b64_tr_b16 a[104:105], v35 offset:40960
    ds_read_b64_tr_b16 a[106:107], v35 offset:41984
    ds_read_b64_tr_b16 a[108:109], v35 offset:40968
    ds_read_b64_tr_b16 a[110:111], v35 offset:41992
    ds_read_b64_tr_b16 a[112:113], v35 offset:49152
    ds_read_b64_tr_b16 a[114:115], v35 offset:50176
    ds_read_b64_tr_b16 a[116:117], v35 offset:49160
    ds_read_b64_tr_b16 a[118:119], v35 offset:50184
    s_waitcnt lgkmcnt(0)
    ds_read_b64_tr_b16 a[120:121], v35 offset:57344
    ds_read_b64_tr_b16 a[122:123], v35 offset:58368
    ds_read_b64_tr_b16 a[124:125], v35 offset:57352
    ds_read_b64_tr_b16 a[126:127], v35 offset:58376
    s_waitcnt lgkmcnt(0)
    s_barrier
    s_add_u32 s42, s34, 2
    s_lshl_b32 s35, s42, 15
    s_add_u32 s35, s35, s36
    s_add_u32 m0, s36, 32768
    s_add_u32 s37, s35, 0
    buffer_load_dwordx4 v8, s[16:19], s37 offen lds
    s_add_u32 m0, s36, 33792
    s_add_u32 s37, s35, 1024
    buffer_load_dwordx4 v9, s[16:19], s37 offen lds
    s_add_u32 m0, s36, 34816
    s_add_u32 s37, s35, 2048
    buffer_load_dwordx4 v10, s[16:19], s37 offen lds
    s_add_u32 m0, s36, 35840
    s_add_u32 s37, s35, 3072
    buffer_load_dwordx4 v11, s[16:19], s37 offen lds
    s_add_u32 m0, s36, 36864
    s_add_u32 s37, s35, 4096
    buffer_load_dwordx4 v12, s[16:19], s37 offen lds
    s_add_u32 m0, s36, 37888
    s_add_u32 s37, s35, 5120
    buffer_load_dwordx4 v13, s[16:19], s37 offen lds
    s_add_u32 m0, s36, 38912
    s_add_u32 s37, s35, 6144
    buffer_load_dwordx4 v14, s[16:19], s37 offen lds
    s_add_u32 m0, s36, 39936
    s_add_u32 s37, s35, 7168
    buffer_load_dwordx4 v15, s[16:19], s37 offen lds
    s_add_u32 s42, s34, 4
    s_lshl_b32 s35, s42, 15
    s_add_u32 s35, s35, s36
    s_add_u32 m0, s36, 65536
    s_add_u32 s37, s35, 0
    buffer_load_dwordx4 v8, s[16:19], s37 offen lds
    s_add_u32 m0, s36, 66560
    s_add_u32 s37, s35, 1024
    buffer_load_dwordx4 v9, s[16:19], s37 offen lds
    s_add_u32 m0, s36, 67584
    s_add_u32 s37, s35, 2048
    buffer_load_dwordx4 v10, s[16:19], s37 offen lds
    s_add_u32 m0, s36, 68608
    s_add_u32 s37, s35, 3072
    buffer_load_dwordx4 v11, s[16:19], s37 offen lds
    s_add_u32 m0, s36, 69632
    s_add_u32 s37, s35, 4096
    buffer_load_dwordx4 v12, s[16:19], s37 offen lds
    s_add_u32 m0, s36, 70656
    s_add_u32 s37, s35, 5120
    buffer_load_dwordx4 v13, s[16:19], s37 offen lds
    s_add_u32 m0, s36, 71680
    s_add_u32 s37, s35, 6144
    buffer_load_dwordx4 v14, s[16:19], s37 offen lds
    s_add_u32 m0, s36, 72704
    s_add_u32 s37, s35, 7168
    buffer_load_dwordx4 v15, s[16:19], s37 offen lds
    s_lshl_b32 s73, s71, 7
    s_add_u32 s75, s70, 2
    s_cmp_ge_u32 s75, 3
    s_cselect_b32 s74, 3, 0
    s_sub_u32 s75, s75, s74
    s_lshl_b32 s75, s75, 1
    s_add_u32 s73, s73, s75
    s_add_u32 s73, s73, s69
    s_add_u32 s73, s73, 0x5810000
    v_mov_b32 v7, s73
    s_cmp_lg_u32 s14, 0
    s_cbranch_scc1 L_qkv_zo_63
    v_mov_b32 v6, 56
L_qkv_zi_62:
    global_load_dword v33, v6, s[12:13] sc1
    s_waitcnt vmcnt(0)
    v_readfirstlane_b32 s75, v33
    s_cmp_ge_u32 s75, 32
    s_cbranch_scc1 L_qkv_zo_63
    s_sleep 8
    s_branch L_qkv_zi_62
L_qkv_zo_63:
    s_cmp_eq_u32 s70, 2
    s_cbranch_scc1 L_qkv_v_64
    s_lshl_b32 s39, s70, 24
    s_lshl_b32 s40, s71, 19
    s_add_u32 s39, s39, s40
    s_add_u32 s39, s39, s29
    v_lshlrev_b32 v32, 8, v3
    v_lshl_add_u32 v32, v4, 4, v32
    v_add_u32 v32, s39, v32
    s_mov_b32 s41, 0
    s_mov_b32 s74, -3
L_qkv_loop_66:
    s_waitcnt vmcnt(22)
    s_barrier
    s_cmp_lg_u32 s14, 0
    s_cbranch_scc1 L_qkv_np_67
    s_cmp_lt_i32 s74, 3
    s_cbranch_scc1 L_qkv_np_67
    v_mov_b32 v6, s74
    s_mov_b64 exec, 1
    buffer_store_byte v6, v7, s[4:7], 0 offen sc1
    s_mov_b64 exec, -1
L_qkv_np_67:
    s_add_u32 s74, s74, 1
    s_add_u32 s42, s34, 6
    s_min_u32 s42, s42, 63
    s_lshl_b32 s35, s42, 15
    s_add_u32 s35, s35, s36
    s_add_u32 m0, s36, 98304
    s_add_u32 s37, s35, 0
    buffer_load_dwordx4 v8, s[16:19], s37 offen lds
    s_add_u32 m0, s36, 99328
    s_add_u32 s37, s35, 1024
    buffer_load_dwordx4 v9, s[16:19], s37 offen lds
    s_add_u32 m0, s36, 100352
    s_add_u32 s37, s35, 2048
    buffer_load_dwordx4 v10, s[16:19], s37 offen lds
    s_add_u32 m0, s36, 101376
    s_add_u32 s37, s35, 3072
    buffer_load_dwordx4 v11, s[16:19], s37 offen lds
    s_add_u32 m0, s36, 102400
    s_add_u32 s37, s35, 4096
    buffer_load_dwordx4 v12, s[16:19], s37 offen lds
    s_add_u32 m0, s36, 103424
    s_add_u32 s37, s35, 5120
    buffer_load_dwordx4 v13, s[16:19], s37 offen lds
    s_add_u32 m0, s36, 104448
    s_add_u32 s37, s35, 6144
    buffer_load_dwordx4 v14, s[16:19], s37 offen lds
    s_add_u32 m0, s36, 105472
    s_add_u32 s37, s35, 7168
    buffer_load_dwordx4 v15, s[16:19], s37 offen lds
    ds_read_b128 v[80:83], v16 offset:0
    ds_read_b128 v[84:87], v16 offset:16384
    ds_read_b128 v[88:91], v17 offset:0
    ds_read_b128 v[92:95], v17 offset:16384
    s_waitcnt lgkmcnt(2)
    v_mfma_f32_16x16x32_bf16 v[64:67], a[0:3], v[80:83], 0
    v_mfma_f32_16x16x32_bf16 v[68:71], a[4:7], v[80:83], 0
    v_mfma_f32_16x16x32_bf16 v[72:75], a[0:3], v[84:87], 0
    v_mfma_f32_16x16x32_bf16 v[76:79], a[4:7], v[84:87], 0
    ds_read_b128 v[80:83], v18 offset:0
    ds_read_b128 v[84:87], v18 offset:16384
    s_waitcnt lgkmcnt(2)
    v_mfma_f32_16x16x32_bf16 v[64:67], a[8:11], v[88:91], v[64:67]
    v_mfma_f32_16x16x32_bf16 v[68:71], a[12:15], v[88:91], v[68:71]
    v_mfma_f32_16x16x32_bf16 v[72:75], a[8:11], v[92:95], v[72:75]
    v_mfma_f32_16x16x32_bf16 v[76:79], a[12:15], v[92:95], v[76:79]
    ds_read_b128 v[88:91], v19 offset:0
    ds_read_b128 v[92:95], v19 offset:16384
    s_waitcnt lgkmcnt(2)
    v_mfma_f32_16x16x32_bf16 v[64:67], a[16:19], v[80:83], v[64:67]
    v_mfma_f32_16x16x32_bf16 v[68:71], a[20:23], v[80:83], v[68:71]
    v_mfma_f32_16x16x32_bf16 v[72:75], a[16:19], v[84:87], v[72:75]
    v_mfma_f32_16x16x32_bf16 v[76:79], a[20:23], v[84:87], v[76:79]
    ds_read_b128 v[80:83], v16 offset:256
    ds_read_b128 v[84:87], v16 offset:16640
    s_waitcnt lgkmcnt(2)
    v_mfma_f32_16x16x32_bf16 v[64:67], a[24:27], v[88:91], v[64:67]
    v_mfma_f32_16x16x32_bf16 v[68:71], a[28:31], v[88:91], v[68:71]
    v_mfma_f32_16x16x32_bf16 v[72:75], a[24:27], v[92:95], v[72:75]
    v_mfma_f32_16x16x32_bf16 v[76:79], a[28:31], v[92:95], v[76:79]
    ds_read_b128 v[88:91], v17 offset:256
    ds_read_b128 v[92:95], v17 offset:16640
    s_waitcnt lgkmcnt(2)
    v_mfma_f32_16x16x32_bf16 v[64:67], a[32:35], v[80:83], v[64:67]
    v_mfma_f32_16x16x32_bf16 v[68:71], a[36:39], v[80:83], v[68:71]
    v_mfma_f32_16x16x32_bf16 v[72:75], a[32:35], v[84:87], v[72:75]
    v_mfma_f32_16x16x32_bf16 v[76:79], a[36:39], v[84:87], v[76:79]
    ds_read_b128 v[80:83], v18 offset:256
    ds_read_b128 v[84:87], v18 offset:16640
    s_waitcnt lgkmcnt(2)
    v_mfma_f32_16x16x32_bf16 v[64:67], a[40:43], v[88:91], v[64:67]
    v_mfma_f32_16x16x32_bf16 v[68:71], a[44:47], v[88:91], v[68:71]
    v_mfma_f32_16x16x32_bf16 v[72:75], a[40:43], v[92:95], v[72:75]
    v_mfma_f32_16x16x32_bf16 v[76:79], a[44:47], v[92:95], v[76:79]
    ds_read_b128 v[88:91], v19 offset:256
    ds_read_b128 v[92:95], v19 offset:16640
    s_waitcnt lgkmcnt(2)
    v_mfma_f32_16x16x32_bf16 v[64:67], a[48:51], v[80:83], v[64:67]
    v_mfma_f32_16x16x32_bf16 v[68:71], a[52:55], v[80:83], v[68:71]
    v_mfma_f32_16x16x32_bf16 v[72:75], a[48:51], v[84:87], v[72:75]
    v_mfma_f32_16x16x32_bf16 v[76:79], a[52:55], v[84:87], v[76:79]
    ds_read_b128 v[80:83], v16 offset:512
    ds_read_b128 v[84:87], v16 offset:16896
    s_waitcnt lgkmcnt(2)
    v_mfma_f32_16x16x32_bf16 v[64:67], a[56:59], v[88:91], v[64:67]
    v_mfma_f32_16x16x32_bf16 v[68:71], a[60:63], v[88:91], v[68:71]
    v_mfma_f32_16x16x32_bf16 v[72:75], a[56:59], v[92:95], v[72:75]
    v_mfma_f32_16x16x32_bf16 v[76:79], a[60:63], v[92:95], v[76:79]
    ds_read_b128 v[88:91], v17 offset:512
    ds_read_b128 v[92:95], v17 offset:16896
    s_waitcnt lgkmcnt(2)
    v_mfma_f32_16x16x32_bf16 v[64:67], a[64:67], v[80:83], v[64:67]
    v_mfma_f32_16x16x32_bf16 v[68:71], a[68:71], v[80:83], v[68:71]
    v_mfma_f32_16x16x32_bf16 v[72:75], a[64:67], v[84:87], v[72:75]
    v_mfma_f32_16x16x32_bf16 v[76:79], a[68:71], v[84:87], v[76:79]
    ds_read_b128 v[80:83], v18 offset:512
    ds_read_b128 v[84:87], v18 offset:16896
    s_waitcnt lgkmcnt(2)
    v_mfma_f32_16x16x32_bf16 v[64:67], a[72:75], v[88:91], v[64:67]
    v_mfma_f32_16x16x32_bf16 v[68:71], a[76:79], v[88:91], v[68:71]
    v_mfma_f32_16x16x32_bf16 v[72:75], a[72:75], v[92:95], v[72:75]
    v_mfma_f32_16x16x32_bf16 v[76:79], a[76:79], v[92:95], v[76:79]
    ds_read_b128 v[88:91], v19 offset:512
    ds_read_b128 v[92:95], v19 offset:16896
    s_waitcnt lgkmcnt(2)
    v_mfma_f32_16x16x32_bf16 v[64:67], a[80:83], v[80:83], v[64:67]
    v_mfma_f32_16x16x32_bf16 v[68:71], a[84:87], v[80:83], v[68:71]
    v_mfma_f32_16x16x32_bf16 v[72:75], a[80:83], v[84:87], v[72:75]
    v_mfma_f32_16x16x32_bf16 v[76:79], a[84:87], v[84:87], v[76:79]
    ds_read_b128 v[80:83], v16 offset:768
    ds_read_b128 v[84:87], v16 offset:17152
    s_waitcnt lgkmcnt(2)
    v_mfma_f32_16x16x32_bf16 v[64:67], a[88:91], v[88:91], v[64:67]
    v_mfma_f32_16x16x32_bf16 v[68:71], a[92:95], v[88:91], v[68:71]
    v_mfma_f32_16x16x32_bf16 v[72:75], a[88:91], v[92:95], v[72:75]
    v_mfma_f32_16x16x32_bf16 v[76:79], a[92:95], v[92:95], v[76:79]
    ds_read_b128 v[88:91], v17 offset:768
    ds_read_b128 v[92:95], v17 offset:17152
    s_waitcnt lgkmcnt(2)
    v_mfma_f32_16x16x32_bf16 v[64:67], a[96:99], v[80:83], v[64:67]
    v_mfma_f32_16x16x32_bf16 v[68:71], a[100:103], v[80:83], v[68:71]
    v_mfma_f32_16x16x32_bf16 v[72:75], a[96:99], v[84:87], v[72:75]
    v_mfma_f32_16x16x32_bf16 v[76:79], a[100:103], v[84:87], v[76:79]
    ds_read_b128 v[80:83], v18 offset:768
    ds_read_b128 v[84:87], v18 offset:17152
    s_waitcnt lgkmcnt(2)
    v_mfma_f32_16x16x32_bf16 v[64:67], a[104:107], v[88:91], v[64:67]
    v_mfma_f32_16x16x32_bf16 v[68:71], a[108:111], v[88:91], v[68:71]
    v_mfma_f32_16x16x32_bf16 v[72:75], a[104:107], v[92:95], v[72:75]
    v_mfma_f32_16x16x32_bf16 v[76:79], a[108:111], v[92:95], v[76:79]
    ds_read_b128 v[88:91], v19 offset:768
    ds_read_b128 v[92:95], v19 offset:17152
    s_waitcnt lgkmcnt(2)
    v_mfma_f32_16x16x32_bf16 v[64:67], a[112:115], v[80:83], v[64:67]
    v_mfma_f32_16x16x32_bf16 v[68:71], a[116:119], v[80:83], v[68:71]
    v_mfma_f32_16x16x32_bf16 v[72:75], a[112:115], v[84:87], v[72:75]
    v_mfma_f32_16x16x32_bf16 v[76:79], a[116:119], v[84:87], v[76:79]
    s_waitcnt lgkmcnt(0)
    v_mfma_f32_16x16x32_bf16 v[64:67], a[120:123], v[88:91], v[64:67]
    v_mfma_f32_16x16x32_bf16 v[68:71], a[124:127], v[88:91], v[68:71]
    v_mfma_f32_16x16x32_bf16 v[72:75], a[120:123], v[92:95], v[72:75]
    v_mfma_f32_16x16x32_bf16 v[76:79], a[124:127], v[92:95], v[76:79]
    s_nop 7
    s_lshl_b32 s43, s34, 13
    v_cvt_pk_bf16_f32 v24, v64, v65
    v_cvt_pk_bf16_f32 v25, v66, v67
    v_cvt_pk_bf16_f32 v26, v68, v69
    v_cvt_pk_bf16_f32 v27, v70, v71
    buffer_store_dwordx4 v[24:27], v32, s[4:7], s43 offen sc1
    v_cvt_pk_bf16_f32 v28, v72, v73
    v_cvt_pk_bf16_f32 v29, v74, v75
    v_cvt_pk_bf16_f32 v30, v76, v77
    v_cvt_pk_bf16_f32 v31, v78, v79
    s_add_u32 s43, s43, 4096
    buffer_store_dwordx4 v[28:31], v32, s[4:7], s43 offen sc1
    s_add_u32 s34, s34, 2
    s_cmp_lg_u32 s41, 0
    s_cbranch_scc1 L_qkv_eg_68
    s_waitcnt vmcnt(0)
    s_barrier
    s_cmp_lg_u32 s14, 0
    s_cbranch_scc1 L_qkv_eg_68
    v_mov_b32 v6, 1
    s_mov_b64 exec, 1
    buffer_store_byte v6, v7, s[4:7], 0 offen sc1
    s_mov_b64 exec, -1
L_qkv_eg_68:
    s_waitcnt vmcnt(22)
    s_barrier
    s_cmp_lg_u32 s14, 0
    s_cbranch_scc1 L_qkv_np_69
    s_cmp_lt_i32 s74, 3
    s_cbranch_scc1 L_qkv_np_69
    v_mov_b32 v6, s74
    s_mov_b64 exec, 1
    buffer_store_byte v6, v7, s[4:7], 0 offen sc1
    s_mov_b64 exec, -1
L_qkv_np_69:
    s_add_u32 s74, s74, 1
    s_add_u32 s42, s34, 6
    s_min_u32 s42, s42, 63
    s_lshl_b32 s35, s42, 15
    s_add_u32 s35, s35, s36
    s_add_u32 m0, s36, 0
    s_add_u32 s37, s35, 0
    buffer_load_dwordx4 v8, s[16:19], s37 offen lds
    s_add_u32 m0, s36, 1024
    s_add_u32 s37, s35, 1024
    buffer_load_dwordx4 v9, s[16:19], s37 offen lds
    s_add_u32 m0, s36, 2048
    s_add_u32 s37, s35, 2048
    buffer_load_dwordx4 v10, s[16:19], s37 offen lds
    s_add_u32 m0, s36, 3072
    s_add_u32 s37, s35, 3072
    buffer_load_dwordx4 v11, s[16:19], s37 offen lds
    s_add_u32 m0, s36, 4096
    s_add_u32 s37, s35, 4096
    buffer_load_dwordx4 v12, s[16:19], s37 offen lds
    s_add_u32 m0, s36, 5120
    s_add_u32 s37, s35, 5120
    buffer_load_dwordx4 v13, s[16:19], s37 offen lds
    s_add_u32 m0, s36, 6144
    s_add_u32 s37, s35, 6144
    buffer_load_dwordx4 v14, s[16:19], s37 offen lds
    s_add_u32 m0, s36, 7168
    s_add_u32 s37, s35, 7168
    buffer_load_dwordx4 v15, s[16:19], s37 offen lds
    ds_read_b128 v[80:83], v16 offset:32768
    ds_read_b128 v[84:87], v16 offset:49152
    ds_read_b128 v[88:91], v17 offset:32768
    ds_read_b128 v[92:95], v17 offset:49152
    s_waitcnt lgkmcnt(2)
    v_mfma_f32_16x16x32_bf16 v[64:67], a[0:3], v[80:83], 0
    v_mfma_f32_16x16x32_bf16 v[68:71], a[4:7], v[80:83], 0
    v_mfma_f32_16x16x32_bf16 v[72:75], a[0:3], v[84:87], 0
    v_mfma_f32_16x16x32_bf16 v[76:79], a[4:7], v[84:87], 0
    ds_read_b128 v[80:83], v18 offset:32768
    ds_read_b128 v[84:87], v18 offset:49152
    s_waitcnt lgkmcnt(2)
    v_mfma_f32_16x16x32_bf16 v[64:67], a[8:11], v[88:91], v[64:67]
    v_mfma_f32_16x16x32_bf16 v[68:71], a[12:15], v[88:91], v[68:71]
    v_mfma_f32_16x16x32_bf16 v[72:75], a[8:11], v[92:95], v[72:75]
    v_mfma_f32_16x16x32_bf16 v[76:79], a[12:15], v[92:95], v[76:79]
    ds_read_b128 v[88:91], v19 offset:32768
    ds_read_b128 v[92:95], v19 offset:49152
    s_waitcnt lgkmcnt(2)
    v_mfma_f32_16x16x32_bf16 v[64:67], a[16:19], v[80:83], v[64:67]
    v_mfma_f32_16x16x32_bf16 v[68:71], a[20:23], v[80:83], v[68:71]
    v_mfma_f32_16x16x32_bf16 v[72:75], a[16:19], v[84:87], v[72:75]
    v_mfma_f32_16x16x32_bf16 v[76:79], a[20:23], v[84:87], v[76:79]
    ds_read_b128 v[80:83], v16 offset:33024
    ds_read_b128 v[84:87], v16 offset:49408
    s_waitcnt lgkmcnt(2)
    v_mfma_f32_16x16x32_bf16 v[64:67], a[24:27], v[88:91], v[64:67]
    v_mfma_f32_16x16x32_bf16 v[68:71], a[28:31], v[88:91], v[68:71]
    v_mfma_f32_16x16x32_bf16 v[72:75], a[24:27], v[92:95], v[72:75]
    v_mfma_f32_16x16x32_bf16 v[76:79], a[28:31], v[92:95], v[76:79]
    ds_read_b128 v[88:91], v17 offset:33024
    ds_read_b128 v[92:95], v17 offset:49408
    s_waitcnt lgkmcnt(2)
    v_mfma_f32_16x16x32_bf16 v[64:67], a[32:35], v[80:83], v[64:67]
    v_mfma_f32_16x16x32_bf16 v[68:71], a[36:39], v[80:83], v[68:71]
    v_mfma_f32_16x16x32_bf16 v[72:75], a[32:35], v[84:87], v[72:75]
    v_mfma_f32_16x16x32_bf16 v[76:79], a[36:39], v[84:87], v[76:79]
    ds_read_b128 v[80:83], v18 offset:33024
    ds_read_b128 v[84:87], v18 offset:49408
    s_waitcnt lgkmcnt(2)
    v_mfma_f32_16x16x32_bf16 v[64:67], a[40:43], v[88:91], v[64:67]
    v_mfma_f32_16x16x32_bf16 v[68:71], a[44:47], v[88:91], v[68:71]
    v_mfma_f32_16x16x32_bf16 v[72:75], a[40:43], v[92:95], v[72:75]
    v_mfma_f32_16x16x32_bf16 v[76:79], a[44:47], v[92:95], v[76:79]
    ds_read_b128 v[88:91], v19 offset:33024
    ds_read_b128 v[92:95], v19 offset:49408
    s_waitcnt lgkmcnt(2)
    v_mfma_f32_16x16x32_bf16 v[64:67], a[48:51], v[80:83], v[64:67]
    v_mfma_f32_16x16x32_bf16 v[68:71], a[52:55], v[80:83], v[68:71]
    v_mfma_f32_16x16x32_bf16 v[72:75], a[48:51], v[84:87], v[72:75]
    v_mfma_f32_16x16x32_bf16 v[76:79], a[52:55], v[84:87], v[76:79]
    ds_read_b128 v[80:83], v16 offset:33280
    ds_read_b128 v[84:87], v16 offset:49664
    s_waitcnt lgkmcnt(2)
    v_mfma_f32_16x16x32_bf16 v[64:67], a[56:59], v[88:91], v[64:67]
    v_mfma_f32_16x16x32_bf16 v[68:71], a[60:63], v[88:91], v[68:71]
    v_mfma_f32_16x16x32_bf16 v[72:75], a[56:59], v[92:95], v[72:75]
    v_mfma_f32_16x16x32_bf16 v[76:79], a[60:63], v[92:95], v[76:79]
    ds_read_b128 v[88:91], v17 offset:33280
    ds_read_b128 v[92:95], v17 offset:49664
    s_waitcnt lgkmcnt(2)
    v_mfma_f32_16x16x32_bf16 v[64:67], a[64:67], v[80:83], v[64:67]
    v_mfma_f32_16x16x32_bf16 v[68:71], a[68:71], v[80:83], v[68:71]
    v_mfma_f32_16x16x32_bf16 v[72:75], a[64:67], v[84:87], v[72:75]
    v_mfma_f32_16x16x32_bf16 v[76:79], a[68:71], v[84:87], v[76:79]
    ds_read_b128 v[80:83], v18 offset:33280
    ds_read_b128 v[84:87], v18 offset:49664
    s_waitcnt lgkmcnt(2)
    v_mfma_f32_16x16x32_bf16 v[64:67], a[72:75], v[88:91], v[64:67]
    v_mfma_f32_16x16x32_bf16 v[68:71], a[76:79], v[88:91], v[68:71]
    v_mfma_f32_16x16x32_bf16 v[72:75], a[72:75], v[92:95], v[72:75]
    v_mfma_f32_16x16x32_bf16 v[76:79], a[76:79], v[92:95], v[76:79]
    ds_read_b128 v[88:91], v19 offset:33280
    ds_read_b128 v[92:95], v19 offset:49664
    s_waitcnt lgkmcnt(2)
    v_mfma_f32_16x16x32_bf16 v[64:67], a[80:83], v[80:83], v[64:67]
    v_mfma_f32_16x16x32_bf16 v[68:71], a[84:87], v[80:83], v[68:71]
    v_mfma_f32_16x16x32_bf16 v[72:75], a[80:83], v[84:87], v[72:75]
    v_mfma_f32_16x16x32_bf16 v[76:79], a[84:87], v[84:87], v[76:79]
    ds_read_b128 v[80:83], v16 offset:33536
    ds_read_b128 v[84:87], v16 offset:49920
    s_waitcnt lgkmcnt(2)
    v_mfma_f32_16x16x32_bf16 v[64:67], a[88:91], v[88:91], v[64:67]
    v_mfma_f32_16x16x32_bf16 v[68:71], a[92:95], v[88:91], v[68:71]
    v_mfma_f32_16x16x32_bf16 v[72:75], a[88:91], v[92:95], v[72:75]
    v_mfma_f32_16x16x32_bf16 v[76:79], a[92:95], v[92:95], v[76:79]
    ds_read_b128 v[88:91], v17 offset:33536
    ds_read_b128 v[92:95], v17 offset:49920
    s_waitcnt lgkmcnt(2)
    v_mfma_f32_16x16x32_bf16 v[64:67], a[96:99], v[80:83], v[64:67]
    v_mfma_f32_16x16x32_bf16 v[68:71], a[100:103], v[80:83], v[68:71]
    v_mfma_f32_16x16x32_bf16 v[72:75], a[96:99], v[84:87], v[72:75]
    v_mfma_f32_16x16x32_bf16 v[76:79], a[100:103], v[84:87], v[76:79]
    ds_read_b128 v[80:83], v18 offset:33536
    ds_read_b128 v[84:87], v18 offset:49920
    s_waitcnt lgkmcnt(2)
    v_mfma_f32_16x16x32_bf16 v[64:67], a[104:107], v[88:91], v[64:67]
    v_mfma_f32_16x16x32_bf16 v[68:71], a[108:111], v[88:91], v[68:71]
    v_mfma_f32_16x16x32_bf16 v[72:75], a[104:107], v[92:95], v[72:75]
    v_mfma_f32_16x16x32_bf16 v[76:79], a[108:111], v[92:95], v[76:79]
    ds_read_b128 v[88:91], v19 offset:33536
    ds_read_b128 v[92:95], v19 offset:49920
    s_waitcnt lgkmcnt(2)
    v_mfma_f32_16x16x32_bf16 v[64:67], a[112:115], v[80:83], v[64:67]
    v_mfma_f32_16x16x32_bf16 v[68:71], a[116:119], v[80:83], v[68:71]
    v_mfma_f32_16x16x32_bf16 v[72:75], a[112:115], v[84:87], v[72:75]
    v_mfma_f32_16x16x32_bf16 v[76:79], a[116:119], v[84:87], v[76:79]
    s_waitcnt lgkmcnt(0)
    v_mfma_f32_16x16x32_bf16 v[64:67], a[120:123], v[88:91], v[64:67]
    v_mfma_f32_16x16x32_bf16 v[68:71], a[124:127], v[88:91], v[68:71]
    v_mfma_f32_16x16x32_bf16 v[72:75], a[120:123], v[92:95], v[72:75]
    v_mfma_f32_16x16x32_bf16 v[76:79], a[124:127], v[92:95], v[76:79]
    s_nop 7
    s_lshl_b32 s43, s34, 13
    v_cvt_pk_bf16_f32 v24, v64, v65
    v_cvt_pk_bf16_f32 v25, v66, v67
    v_cvt_pk_bf16_f32 v26, v68, v69
    v_cvt_pk_bf16_f32 v27, v70, v71
    buffer_store_dwordx4 v[24:27], v32, s[4:7], s43 offen sc1
    v_cvt_pk_bf16_f32 v28, v72, v73
    v_cvt_pk_bf16_f32 v29, v74, v75
    v_cvt_pk_bf16_f32 v30, v76, v77
    v_cvt_pk_bf16_f32 v31, v78, v79
    s_add_u32 s43, s43, 4096
    buffer_store_dwordx4 v[28:31], v32, s[4:7], s43 offen sc1
    s_add_u32 s34, s34, 2
    s_cmp_lg_u32 s41, 0
    s_cbranch_scc1 L_qkv_eg_70
    s_waitcnt vmcnt(0)
    s_barrier
    s_cmp_lg_u32 s14, 0
    s_cbranch_scc1 L_qkv_eg_70
    v_mov_b32 v6, 2
    s_mov_b64 exec, 1
    buffer_store_byte v6, v7, s[4:7], 0 offen sc1
    s_mov_b64 exec, -1
L_qkv_eg_70:
    s_waitcnt vmcnt(22)
    s_barrier
    s_cmp_lg_u32 s14, 0
    s_cbranch_scc1 L_qkv_np_71
    s_cmp_lt_i32 s74, 3
    s_cbranch_scc1 L_qkv_np_71
    v_mov_b32 v6, s74
    s_mov_b64 exec, 1
    buffer_store_byte v6, v7, s[4:7], 0 offen sc1
    s_mov_b64 exec, -1
L_qkv_np_71:
    s_add_u32 s74, s74, 1
    s_add_u32 s42, s34, 6
    s_min_u32 s42, s42, 63
    s_lshl_b32 s35, s42, 15
    s_add_u32 s35, s35, s36
    s_add_u32 m0, s36, 32768
    s_add_u32 s37, s35, 0
    buffer_load_dwordx4 v8, s[16:19], s37 offen lds
    s_add_u32 m0, s36, 33792
    s_add_u32 s37, s35, 1024
    buffer_load_dwordx4 v9, s[16:19], s37 offen lds
    s_add_u32 m0, s36, 34816
    s_add_u32 s37, s35, 2048
    buffer_load_dwordx4 v10, s[16:19], s37 offen lds
    s_add_u32 m0, s36, 35840
    s_add_u32 s37, s35, 3072
    buffer_load_dwordx4 v11, s[16:19], s37 offen lds
    s_add_u32 m0, s36, 36864
    s_add_u32 s37, s35, 4096
    buffer_load_dwordx4 v12, s[16:19], s37 offen lds
    s_add_u32 m0, s36, 37888
    s_add_u32 s37, s35, 5120
    buffer_load_dwordx4 v13, s[16:19], s37 offen lds
    s_add_u32 m0, s36, 38912
    s_add_u32 s37, s35, 6144
    buffer_load_dwordx4 v14, s[16:19], s37 offen lds
    s_add_u32 m0, s36, 39936
    s_add_u32 s37, s35, 7168
    buffer_load_dwordx4 v15, s[16:19], s37 offen lds
    ds_read_b128 v[80:83], v20 offset:0
    ds_read_b128 v[84:87], v20 offset:16384
    ds_read_b128 v[88:91], v21 offset:0
    ds_read_b128 v[92:95], v21 offset:16384
    s_waitcnt lgkmcnt(2)
    v_mfma_f32_16x16x32_bf16 v[64:67], a[0:3], v[80:83], 0
    v_mfma_f32_16x16x32_bf16 v[68:71], a[4:7], v[80:83], 0
    v_mfma_f32_16x16x32_bf16 v[72:75], a[0:3], v[84:87], 0
    v_mfma_f32_16x16x32_bf16 v[76:79], a[4:7], v[84:87], 0
    ds_read_b128 v[80:83], v22 offset:0
    ds_read_b128 v[84:87], v22 offset:16384
    s_waitcnt lgkmcnt(2)
    v_mfma_f32_16x16x32_bf16 v[64:67], a[8:11], v[88:91], v[64:67]
    v_mfma_f32_16x16x32_bf16 v[68:71], a[12:15], v[88:91], v[68:71]
    v_mfma_f32_16x16x32_bf16 v[72:75], a[8:11], v[92:95], v[72:75]
    v_mfma_f32_16x16x32_bf16 v[76:79], a[12:15], v[92:95], v[76:79]
    ds_read_b128 v[88:91], v23 offset:0
    ds_read_b128 v[92:95], v23 offset:16384
    s_waitcnt lgkmcnt(2)
    v_mfma_f32_16x16x32_bf16 v[64:67], a[16:19], v[80:83], v[64:67]
    v_mfma_f32_16x16x32_bf16 v[68:71], a[20:23], v[80:83], v[68:71]
    v_mfma_f32_16x16x32_bf16 v[72:75], a[16:19], v[84:87], v[72:75]
    v_mfma_f32_16x16x32_bf16 v[76:79], a[20:23], v[84:87], v[76:79]
    ds_read_b128 v[80:83], v20 offset:256
    ds_read_b128 v[84:87], v20 offset:16640
    s_waitcnt lgkmcnt(2)
    v_mfma_f32_16x16x32_bf16 v[64:67], a[24:27], v[88:91], v[64:67]
    v_mfma_f32_16x16x32_bf16 v[68:71], a[28:31], v[88:91], v[68:71]
    v_mfma_f32_16x16x32_bf16 v[72:75], a[24:27], v[92:95], v[72:75]
    v_mfma_f32_16x16x32_bf16 v[76:79], a[28:31], v[92:95], v[76:79]
    ds_read_b128 v[88:91], v21 offset:256
    ds_read_b128 v[92:95], v21 offset:16640
    s_waitcnt lgkmcnt(2)
    v_mfma_f32_16x16x32_bf16 v[64:67], a[32:35], v[80:83], v[64:67]
    v_mfma_f32_16x16x32_bf16 v[68:71], a[36:39], v[80:83], v[68:71]
    v_mfma_f32_16x16x32_bf16 v[72:75], a[32:35], v[84:87], v[72:75]
    v_mfma_f32_16x16x32_bf16 v[76:79], a[36:39], v[84:87], v[76:79]
    ds_read_b128 v[80:83], v22 offset:256
    ds_read_b128 v[84:87], v22 offset:16640
    s_waitcnt lgkmcnt(2)
    v_mfma_f32_16x16x32_bf16 v[64:67], a[40:43], v[88:91], v[64:67]
    v_mfma_f32_16x16x32_bf16 v[68:71], a[44:47], v[88:91], v[68:71]
    v_mfma_f32_16x16x32_bf16 v[72:75], a[40:43], v[92:95], v[72:75]
    v_mfma_f32_16x16x32_bf16 v[76:79], a[44:47], v[92:95], v[76:79]
    ds_read_b128 v[88:91], v23 offset:256
    ds_read_b128 v[92:95], v23 offset:16640
    s_waitcnt lgkmcnt(2)
    v_mfma_f32_16x16x32_bf16 v[64:67], a[48:51], v[80:83], v[64:67]
    v_mfma_f32_16x16x32_bf16 v[68:71], a[52:55], v[80:83], v[68:71]
    v_mfma_f32_16x16x32_bf16 v[72:75], a[48:51], v[84:87], v[72:75]
    v_mfma_f32_16x16x32_bf16 v[76:79], a[52:55], v[84:87], v[76:79]
    ds_read_b128 v[80:83], v20 offset:512
    ds_read_b128 v[84:87], v20 offset:16896
    s_waitcnt lgkmcnt(2)
    v_mfma_f32_16x16x32_bf16 v[64:67], a[56:59], v[88:91], v[64:67]
    v_mfma_f32_16x16x32_bf16 v[68:71], a[60:63], v[88:91], v[68:71]
    v_mfma_f32_16x16x32_bf16 v[72:75], a[56:59], v[92:95], v[72:75]
    v_mfma_f32_16x16x32_bf16 v[76:79], a[60:63], v[92:95], v[76:79]
    ds_read_b128 v[88:91], v21 offset:512
    ds_read_b128 v[92:95], v21 offset:16896
    s_waitcnt lgkmcnt(2)
    v_mfma_f32_16x16x32_bf16 v[64:67], a[64:67], v[80:83], v[64:67]
    v_mfma_f32_16x16x32_bf16 v[68:71], a[68:71], v[80:83], v[68:71]
    v_mfma_f32_16x16x32_bf16 v[72:75], a[64:67], v[84:87], v[72:75]
    v_mfma_f32_16x16x32_bf16 v[76:79], a[68:71], v[84:87], v[76:79]
    ds_read_b128 v[80:83], v22 offset:512
    ds_read_b128 v[84:87], v22 offset:16896
    s_waitcnt lgkmcnt(2)
    v_mfma_f32_16x16x32_bf16 v[64:67], a[72:75], v[88:91], v[64:67]
    v_mfma_f32_16x16x32_bf16 v[68:71], a[76:79], v[88:91], v[68:71]
    v_mfma_f32_16x16x32_bf16 v[72:75], a[72:75], v[92:95], v[72:75]
    v_mfma_f32_16x16x32_bf16 v[76:79], a[76:79], v[92:95], v[76:79]
    ds_read_b128 v[88:91], v23 offset:512
    ds_read_b128 v[92:95], v23 offset:16896
    s_waitcnt lgkmcnt(2)
    v_mfma_f32_16x16x32_bf16 v[64:67], a[80:83], v[80:83], v[64:67]
    v_mfma_f32_16x16x32_bf16 v[68:71], a[84:87], v[80:83], v[68:71]
    v_mfma_f32_16x16x32_bf16 v[72:75], a[80:83], v[84:87], v[72:75]
    v_mfma_f32_16x16x32_bf16 v[76:79], a[84:87], v[84:87], v[76:79]
    ds_read_b128 v[80:83], v20 offset:768
    ds_read_b128 v[84:87], v20 offset:17152
    s_waitcnt lgkmcnt(2)
    v_mfma_f32_16x16x32_bf16 v[64:67], a[88:91], v[88:91], v[64:67]
    v_mfma_f32_16x16x32_bf16 v[68:71], a[92:95], v[88:91], v[68:71]
    v_mfma_f32_16x16x32_bf16 v[72:75], a[88:91], v[92:95], v[72:75]
    v_mfma_f32_16x16x32_bf16 v[76:79], a[92:95], v[92:95], v[76:79]
    ds_read_b128 v[88:91], v21 offset:768
    ds_read_b128 v[92:95], v21 offset:17152
    s_waitcnt lgkmcnt(2)
    v_mfma_f32_16x16x32_bf16 v[64:67], a[96:99], v[80:83], v[64:67]
    v_mfma_f32_16x16x32_bf16 v[68:71], a[100:103], v[80:83], v[68:71]
    v_mfma_f32_16x16x32_bf16 v[72:75], a[96:99], v[84:87], v[72:75]
    v_mfma_f32_16x16x32_bf16 v[76:79], a[100:103], v[84:87], v[76:79]
    ds_read_b128 v[80:83], v22 offset:768
    ds_read_b128 v[84:87], v22 offset:17152
    s_waitcnt lgkmcnt(2)
    v_mfma_f32_16x16x32_bf16 v[64:67], a[104:107], v[88:91], v[64:67]
    v_mfma_f32_16x16x32_bf16 v[68:71], a[108:111], v[88:91], v[68:71]
    v_mfma_f32_16x16x32_bf16 v[72:75], a[104:107], v[92:95], v[72:75]
    v_mfma_f32_16x16x32_bf16 v[76:79], a[108:111], v[92:95], v[76:79]
    ds_read_b128 v[88:91], v23 offset:768
    ds_read_b128 v[92:95], v23 offset:17152
    s_waitcnt lgkmcnt(2)
    v_mfma_f32_16x16x32_bf16 v[64:67], a[112:115], v[80:83], v[64:67]
    v_mfma_f32_16x16x32_bf16 v[68:71], a[116:119], v[80:83], v[68:71]
    v_mfma_f32_16x16x32_bf16 v[72:75], a[112:115], v[84:87], v[72:75]
    v_mfma_f32_16x16x32_bf16 v[76:79], a[116:119], v[84:87], v[76:79]
    s_waitcnt lgkmcnt(0)
    v_mfma_f32_16x16x32_bf16 v[64:67], a[120:123], v[88:91], v[64:67]
    v_mfma_f32_16x16x32_bf16 v[68:71], a[124:127], v[88:91], v[68:71]
    v_mfma_f32_16x16x32_bf16 v[72:75], a[120:123], v[92:95], v[72:75]
    v_mfma_f32_16x16x32_bf16 v[76:79], a[124:127], v[92:95], v[76:79]
    s_nop 7
    s_lshl_b32 s43, s34, 13
    v_cvt_pk_bf16_f32 v24, v64, v65
    v_cvt_pk_bf16_f32 v25, v66, v67
    v_cvt_pk_bf16_f32 v26, v68, v69
    v_cvt_pk_bf16_f32 v27, v70, v71
    buffer_store_dwordx4 v[24:27], v32, s[4:7], s43 offen sc1
    v_cvt_pk_bf16_f32 v28, v72, v73
    v_cvt_pk_bf16_f32 v29, v74, v75
    v_cvt_pk_bf16_f32 v30, v76, v77
    v_cvt_pk_bf16_f32 v31, v78, v79
    s_add_u32 s43, s43, 4096
    buffer_store_dwordx4 v[28:31], v32, s[4:7], s43 offen sc1
    s_add_u32 s34, s34, 2
    s_waitcnt vmcnt(22)
    s_barrier
    s_cmp_lg_u32 s14, 0
    s_cbranch_scc1 L_qkv_np_72
    s_cmp_lt_i32 s74, 3
    s_cbranch_scc1 L_qkv_np_72
    v_mov_b32 v6, s74
    s_mov_b64 exec, 1
    buffer_store_byte v6, v7, s[4:7], 0 offen sc1
    s_mov_b64 exec, -1
L_qkv_np_72:
    s_add_u32 s74, s74, 1
    s_add_u32 s42, s34, 6
    s_min_u32 s42, s42, 63
    s_lshl_b32 s35, s42, 15
    s_add_u32 s35, s35, s36
    s_add_u32 m0, s36, 65536
    s_add_u32 s37, s35, 0
    buffer_load_dwordx4 v8, s[16:19], s37 offen lds
    s_add_u32 m0, s36, 66560
    s_add_u32 s37, s35, 1024
    buffer_load_dwordx4 v9, s[16:19], s37 offen lds
    s_add_u32 m0, s36, 67584
    s_add_u32 s37, s35, 2048
    buffer_load_dwordx4 v10, s[16:19], s37 offen lds
    s_add_u32 m0, s36, 68608
    s_add_u32 s37, s35, 3072
    buffer_load_dwordx4 v11, s[16:19], s37 offen lds
    s_add_u32 m0, s36, 69632
    s_add_u32 s37, s35, 4096
    buffer_load_dwordx4 v12, s[16:19], s37 offen lds
    s_add_u32 m0, s36, 70656
    s_add_u32 s37, s35, 5120
    buffer_load_dwordx4 v13, s[16:19], s37 offen lds
    s_add_u32 m0, s36, 71680
    s_add_u32 s37, s35, 6144
    buffer_load_dwordx4 v14, s[16:19], s37 offen lds
    s_add_u32 m0, s36, 72704
    s_add_u32 s37, s35, 7168
    buffer_load_dwordx4 v15, s[16:19], s37 offen lds
    ds_read_b128 v[80:83], v20 offset:32768
    ds_read_b128 v[84:87], v20 offset:49152
    ds_read_b128 v[88:91], v21 offset:32768
    ds_read_b128 v[92:95], v21 offset:49152
    s_waitcnt lgkmcnt(2)
    v_mfma_f32_16x16x32_bf16 v[64:67], a[0:3], v[80:83], 0
    v_mfma_f32_16x16x32_bf16 v[68:71], a[4:7], v[80:83], 0
    v_mfma_f32_16x16x32_bf16 v[72:75], a[0:3], v[84:87], 0
    v_mfma_f32_16x16x32_bf16 v[76:79], a[4:7], v[84:87], 0
    ds_read_b128 v[80:83], v22 offset:32768
    ds_read_b128 v[84:87], v22 offset:49152
    s_waitcnt lgkmcnt(2)
    v_mfma_f32_16x16x32_bf16 v[64:67], a[8:11], v[88:91], v[64:67]
    v_mfma_f32_16x16x32_bf16 v[68:71], a[12:15], v[88:91], v[68:71]
    v_mfma_f32_16x16x32_bf16 v[72:75], a[8:11], v[92:95], v[72:75]
    v_mfma_f32_16x16x32_bf16 v[76:79], a[12:15], v[92:95], v[76:79]
    ds_read_b128 v[88:91], v23 offset:32768
    ds_read_b128 v[92:95], v23 offset:49152
    s_waitcnt lgkmcnt(2)
    v_mfma_f32_16x16x32_bf16 v[64:67], a[16:19], v[80:83], v[64:67]
    v_mfma_f32_16x16x32_bf16 v[68:71], a[20:23], v[80:83], v[68:71]
    v_mfma_f32_16x16x32_bf16 v[72:75], a[16:19], v[84:87], v[72:75]
    v_mfma_f32_16x16x32_bf16 v[76:79], a[20:23], v[84:87], v[76:79]
    ds_read_b128 v[80:83], v20 offset:33024
    ds_read_b128 v[84:87], v20 offset:49408
    s_waitcnt lgkmcnt(2)
    v_mfma_f32_16x16x32_bf16 v[64:67], a[24:27], v[88:91], v[64:67]
    v_mfma_f32_16x16x32_bf16 v[68:71], a[28:31], v[88:91], v[68:71]
    v_mfma_f32_16x16x32_bf16 v[72:75], a[24:27], v[92:95], v[72:75]
    v_mfma_f32_16x16x32_bf16 v[76:79], a[28:31], v[92:95], v[76:79]
    ds_read_b128 v[88:91], v21 offset:33024
    ds_read_b128 v[92:95], v21 offset:49408
    s_waitcnt lgkmcnt(2)
    v_mfma_f32_16x16x32_bf16 v[64:67], a[32:35], v[80:83], v[64:67]
    v_mfma_f32_16x16x32_bf16 v[68:71], a[36:39], v[80:83], v[68:71]
    v_mfma_f32_16x16x32_bf16 v[72:75], a[32:35], v[84:87], v[72:75]
    v_mfma_f32_16x16x32_bf16 v[76:79], a[36:39], v[84:87], v[76:79]
    ds_read_b128 v[80:83], v22 offset:33024
    ds_read_b128 v[84:87], v22 offset:49408
    s_waitcnt lgkmcnt(2)
    v_mfma_f32_16x16x32_bf16 v[64:67], a[40:43], v[88:91], v[64:67]
    v_mfma_f32_16x16x32_bf16 v[68:71], a[44:47], v[88:91], v[68:71]
    v_mfma_f32_16x16x32_bf16 v[72:75], a[40:43], v[92:95], v[72:75]
    v_mfma_f32_16x16x32_bf16 v[76:79], a[44:47], v[92:95], v[76:79]
    ds_read_b128 v[88:91], v23 offset:33024
    ds_read_b128 v[92:95], v23 offset:49408
    s_waitcnt lgkmcnt(2)
    v_mfma_f32_16x16x32_bf16 v[64:67], a[48:51], v[80:83], v[64:67]
    v_mfma_f32_16x16x32_bf16 v[68:71], a[52:55], v[80:83], v[68:71]
    v_mfma_f32_16x16x32_bf16 v[72:75], a[48:51], v[84:87], v[72:75]
    v_mfma_f32_16x16x32_bf16 v[76:79], a[52:55], v[84:87], v[76:79]
    ds_read_b128 v[80:83], v20 offset:33280
    ds_read_b128 v[84:87], v20 offset:49664
    s_waitcnt lgkmcnt(2)
    v_mfma_f32_16x16x32_bf16 v[64:67], a[56:59], v[88:91], v[64:67]
    v_mfma_f32_16x16x32_bf16 v[68:71], a[60:63], v[88:91], v[68:71]
    v_mfma_f32_16x16x32_bf16 v[72:75], a[56:59], v[92:95], v[72:75]
    v_mfma_f32_16x16x32_bf16 v[76:79], a[60:63], v[92:95], v[76:79]
    ds_read_b128 v[88:91], v21 offset:33280
    ds_read_b128 v[92:95], v21 offset:49664
    s_waitcnt lgkmcnt(2)
    v_mfma_f32_16x16x32_bf16 v[64:67], a[64:67], v[80:83], v[64:67]
    v_mfma_f32_16x16x32_bf16 v[68:71], a[68:71], v[80:83], v[68:71]
    v_mfma_f32_16x16x32_bf16 v[72:75], a[64:67], v[84:87], v[72:75]
    v_mfma_f32_16x16x32_bf16 v[76:79], a[68:71], v[84:87], v[76:79]
    ds_read_b128 v[80:83], v22 offset:33280
    ds_read_b128 v[84:87], v22 offset:49664
    s_waitcnt lgkmcnt(2)
    v_mfma_f32_16x16x32_bf16 v[64:67], a[72:75], v[88:91], v[64:67]
    v_mfma_f32_16x16x32_bf16 v[68:71], a[76:79], v[88:91], v[68:71]
    v_mfma_f32_16x16x32_bf16 v[72:75], a[72:75], v[92:95], v[72:75]
    v_mfma_f32_16x16x32_bf16 v[76:79], a[76:79], v[92:95], v[76:79]
    ds_read_b128 v[88:91], v23 offset:33280
    ds_read_b128 v[92:95], v23 offset:49664
    s_waitcnt lgkmcnt(2)
    v_mfma_f32_16x16x32_bf16 v[64:67], a[80:83], v[80:83], v[64:67]
    v_mfma_f32_16x16x32_bf16 v[68:71], a[84:87], v[80:83], v[68:71]
    v_mfma_f32_16x16x32_bf16 v[72:75], a[80:83], v[84:87], v[72:75]
    v_mfma_f32_16x16x32_bf16 v[76:79], a[84:87], v[84:87], v[76:79]
    ds_read_b128 v[80:83], v20 offset:33536
    ds_read_b128 v[84:87], v20 offset:49920
    s_waitcnt lgkmcnt(2)
    v_mfma_f32_16x16x32_bf16 v[64:67], a[88:91], v[88:91], v[64:67]
    v_mfma_f32_16x16x32_bf16 v[68:71], a[92:95], v[88:91], v[68:71]
    v_mfma_f32_16x16x32_bf16 v[72:75], a[88:91], v[92:95], v[72:75]
    v_mfma_f32_16x16x32_bf16 v[76:79], a[92:95], v[92:95], v[76:79]
    ds_read_b128 v[88:91], v21 offset:33536
    ds_read_b128 v[92:95], v21 offset:49920
    s_waitcnt lgkmcnt(2)
    v_mfma_f32_16x16x32_bf16 v[64:67], a[96:99], v[80:83], v[64:67]
    v_mfma_f32_16x16x32_bf16 v[68:71], a[100:103], v[80:83], v[68:71]
    v_mfma_f32_16x16x32_bf16 v[72:75], a[96:99], v[84:87], v[72:75]
    v_mfma_f32_16x16x32_bf16 v[76:79], a[100:103], v[84:87], v[76:79]
    ds_read_b128 v[80:83], v22 offset:33536
    ds_read_b128 v[84:87], v22 offset:49920
    s_waitcnt lgkmcnt(2)
    v_mfma_f32_16x16x32_bf16 v[64:67], a[104:107], v[88:91], v[64:67]
    v_mfma_f32_16x16x32_bf16 v[68:71], a[108:111], v[88:91], v[68:71]
    v_mfma_f32_16x16x32_bf16 v[72:75], a[104:107], v[92:95], v[72:75]
    v_mfma_f32_16x16x32_bf16 v[76:79], a[108:111], v[92:95], v[76:79]
    ds_read_b128 v[88:91], v23 offset:33536
    ds_read_b128 v[92:95], v23 offset:49920
    s_waitcnt lgkmcnt(2)
    v_mfma_f32_16x16x32_bf16 v[64:67], a[112:115], v[80:83], v[64:67]
    v_mfma_f32_16x16x32_bf16 v[68:71], a[116:119], v[80:83], v[68:71]
    v_mfma_f32_16x16x32_bf16 v[72:75], a[112:115], v[84:87], v[72:75]
    v_mfma_f32_16x16x32_bf16 v[76:79], a[116:119], v[84:87], v[76:79]
    s_waitcnt lgkmcnt(0)
    v_mfma_f32_16x16x32_bf16 v[64:67], a[120:123], v[88:91], v[64:67]
    v_mfma_f32_16x16x32_bf16 v[68:71], a[124:127], v[88:91], v[68:71]
    v_mfma_f32_16x16x32_bf16 v[72:75], a[120:123], v[92:95], v[72:75]
    v_mfma_f32_16x16x32_bf16 v[76:79], a[124:127], v[92:95], v[76:79]
    s_nop 7
    s_lshl_b32 s43, s34, 13
    v_cvt_pk_bf16_f32 v24, v64, v65
    v_cvt_pk_bf16_f32 v25, v66, v67
    v_cvt_pk_bf16_f32 v26, v68, v69
    v_cvt_pk_bf16_f32 v27, v70, v71
    buffer_store_dwordx4 v[24:27], v32, s[4:7], s43 offen sc1
    v_cvt_pk_bf16_f32 v28, v72, v73
    v_cvt_pk_bf16_f32 v29, v74, v75
    v_cvt_pk_bf16_f32 v30, v76, v77
    v_cvt_pk_bf16_f32 v31, v78, v79
    s_add_u32 s43, s43, 4096
    buffer_store_dwordx4 v[28:31], v32, s[4:7], s43 offen sc1
    s_add_u32 s34, s34, 2
    s_add_u32 s41, s41, 1
    s_cmp_lt_u32 s41, 8
    s_cbranch_scc1 L_qkv_loop_66
    s_branch L_qkv_done_65
L_qkv_v_64:
    s_lshl_b32 s39, s71, 13
    s_lshl_b32 s40, s14, 11
    s_add_u32 s39, s39, s40
    s_add_u32 s39, s39, 0x2000000
    v_lshrrev_b32 v32, 2, v3
    v_lshlrev_b32 v32, 3, v32
    v_and_b32 v34, 3, v3
    v_add_u32 v32, v32, v34
    v_lshlrev_b32 v32, 6, v32
    v_lshl_add_u32 v32, v4, 4, v32
    v_add_u32 v32, s39, v32
    s_mov_b32 s41, 0
    s_mov_b32 s74, -3
L_qkv_loop_73:
    s_waitcnt vmcnt(22)
    s_barrier
    s_cmp_lg_u32 s14, 0
    s_cbranch_scc1 L_qkv_np_74
    s_cmp_lt_i32 s74, 3
    s_cbranch_scc1 L_qkv_np_74
    v_mov_b32 v6, s74
    s_mov_b64 exec, 1
    buffer_store_byte v6, v7, s[4:7], 0 offen sc1
    s_mov_b64 exec, -1
L_qkv_np_74:
    s_add_u32 s74, s74, 1
    s_add_u32 s42, s34, 6
    s_min_u32 s42, s42, 63
    s_lshl_b32 s35, s42, 15
    s_add_u32 s35, s35, s36
    s_add_u32 m0, s36, 98304
    s_add_u32 s37, s35, 0
    buffer_load_dwordx4 v8, s[16:19], s37 offen lds
    s_add_u32 m0, s36, 99328
    s_add_u32 s37, s35, 1024
    buffer_load_dwordx4 v9, s[16:19], s37 offen lds
    s_add_u32 m0, s36, 100352
    s_add_u32 s37, s35, 2048
    buffer_load_dwordx4 v10, s[16:19], s37 offen lds
    s_add_u32 m0, s36, 101376
    s_add_u32 s37, s35, 3072
    buffer_load_dwordx4 v11, s[16:19], s37 offen lds
    s_add_u32 m0, s36, 102400
    s_add_u32 s37, s35, 4096
    buffer_load_dwordx4 v12, s[16:19], s37 offen lds
    s_add_u32 m0, s36, 103424
    s_add_u32 s37, s35, 5120
    buffer_load_dwordx4 v13, s[16:19], s37 offen lds
    s_add_u32 m0, s36, 104448
    s_add_u32 s37, s35, 6144
    buffer_load_dwordx4 v14, s[16:19], s37 offen lds
    s_add_u32 m0, s36, 105472
    s_add_u32 s37, s35, 7168
    buffer_load_dwordx4 v15, s[16:19], s37 offen lds
    ds_read_b128 v[80:83], v16 offset:0
    ds_read_b128 v[84:87], v16 offset:16384
    ds_read_b128 v[88:91], v17 offset:0
    ds_read_b128 v[92:95], v17 offset:16384
    s_waitcnt lgkmcnt(2)
    v_mfma_f32_16x16x32_bf16 v[64:67], v[80:83], a[0:3], 0
    v_mfma_f32_16x16x32_bf16 v[68:71], v[80:83], a[4:7], 0
    v_mfma_f32_16x16x32_bf16 v[72:75], v[84:87], a[0:3], 0
    v_mfma_f32_16x16x32_bf16 v[76:79], v[84:87], a[4:7], 0
    ds_read_b128 v[80:83], v18 offset:0
    ds_read_b128 v[84:87], v18 offset:16384
    s_waitcnt lgkmcnt(2)
    v_mfma_f32_16x16x32_bf16 v[64:67], v[88:91], a[8:11], v[64:67]
    v_mfma_f32_16x16x32_bf16 v[68:71], v[88:91], a[12:15], v[68:71]
    v_mfma_f32_16x16x32_bf16 v[72:75], v[92:95], a[8:11], v[72:75]
    v_mfma_f32_16x16x32_bf16 v[76:79], v[92:95], a[12:15], v[76:79]
    ds_read_b128 v[88:91], v19 offset:0
    ds_read_b128 v[92:95], v19 offset:16384
    s_waitcnt lgkmcnt(2)
    v_mfma_f32_16x16x32_bf16 v[64:67], v[80:83], a[16:19], v[64:67]
    v_mfma_f32_16x16x32_bf16 v[68:71], v[80:83], a[20:23], v[68:71]
    v_mfma_f32_16x16x32_bf16 v[72:75], v[84:87], a[16:19], v[72:75]
    v_mfma_f32_16x16x32_bf16 v[76:79], v[84:87], a[20:23], v[76:79]
    ds_read_b128 v[80:83], v16 offset:256
    ds_read_b128 v[84:87], v16 offset:16640
    s_waitcnt lgkmcnt(2)
    v_mfma_f32_16x16x32_bf16 v[64:67], v[88:91], a[24:27], v[64:67]
    v_mfma_f32_16x16x32_bf16 v[68:71], v[88:91], a[28:31], v[68:71]
    v_mfma_f32_16x16x32_bf16 v[72:75], v[92:95], a[24:27], v[72:75]
    v_mfma_f32_16x16x32_bf16 v[76:79], v[92:95], a[28:31], v[76:79]
    ds_read_b128 v[88:91], v17 offset:256
    ds_read_b128 v[92:95], v17 offset:16640
    s_waitcnt lgkmcnt(2)
    v_mfma_f32_16x16x32_bf16 v[64:67], v[80:83], a[32:35], v[64:67]
    v_mfma_f32_16x16x32_bf16 v[68:71], v[80:83], a[36:39], v[68:71]
    v_mfma_f32_16x16x32_bf16 v[72:75], v[84:87], a[32:35], v[72:75]
    v_mfma_f32_16x16x32_bf16 v[76:79], v[84:87], a[36:39], v[76:79]
    ds_read_b128 v[80:83], v18 offset:256
    ds_read_b128 v[84:87], v18 offset:16640
    s_waitcnt lgkmcnt(2)
    v_mfma_f32_16x16x32_bf16 v[64:67], v[88:91], a[40:43], v[64:67]
    v_mfma_f32_16x16x32_bf16 v[68:71], v[88:91], a[44:47], v[68:71]
    v_mfma_f32_16x16x32_bf16 v[72:75], v[92:95], a[40:43], v[72:75]
    v_mfma_f32_16x16x32_bf16 v[76:79], v[92:95], a[44:47], v[76:79]
    ds_read_b128 v[88:91], v19 offset:256
    ds_read_b128 v[92:95], v19 offset:16640
    s_waitcnt lgkmcnt(2)
    v_mfma_f32_16x16x32_bf16 v[64:67], v[80:83], a[48:51], v[64:67]
    v_mfma_f32_16x16x32_bf16 v[68:71], v[80:83], a[52:55], v[68:71]
    v_mfma_f32_16x16x32_bf16 v[72:75], v[84:87], a[48:51], v[72:75]
    v_mfma_f32_16x16x32_bf16 v[76:79], v[84:87], a[52:55], v[76:79]
    ds_read_b128 v[80:83], v16 offset:512
    ds_read_b128 v[84:87], v16 offset:16896
    s_waitcnt lgkmcnt(2)
    v_mfma_f32_16x16x32_bf16 v[64:67], v[88:91], a[56:59], v[64:67]
    v_mfma_f32_16x16x32_bf16 v[68:71], v[88:91], a[60:63], v[68:71]
    v_mfma_f32_16x16x32_bf16 v[72:75], v[92:95], a[56:59], v[72:75]
    v_mfma_f32_16x16x32_bf16 v[76:79], v[92:95], a[60:63], v[76:79]
    ds_read_b128 v[88:91], v17 offset:512
    ds_read_b128 v[92:95], v17 offset:16896
    s_waitcnt lgkmcnt(2)
    v_mfma_f32_16x16x32_bf16 v[64:67], v[80:83], a[64:67], v[64:67]
    v_mfma_f32_16x16x32_bf16 v[68:71], v[80:83], a[68:71], v[68:71]
    v_mfma_f32_16x16x32_bf16 v[72:75], v[84:87], a[64:67], v[72:75]
    v_mfma_f32_16x16x32_bf16 v[76:79], v[84:87], a[68:71], v[76:79]
    ds_read_b128 v[80:83], v18 offset:512
    ds_read_b128 v[84:87], v18 offset:16896
    s_waitcnt lgkmcnt(2)
    v_mfma_f32_16x16x32_bf16 v[64:67], v[88:91], a[72:75], v[64:67]
    v_mfma_f32_16x16x32_bf16 v[68:71], v[88:91], a[76:79], v[68:71]
    v_mfma_f32_16x16x32_bf16 v[72:75], v[92:95], a[72:75], v[72:75]
    v_mfma_f32_16x16x32_bf16 v[76:79], v[92:95], a[76:79], v[76:79]
    ds_read_b128 v[88:91], v19 offset:512
    ds_read_b128 v[92:95], v19 offset:16896
    s_waitcnt lgkmcnt(2)
    v_mfma_f32_16x16x32_bf16 v[64:67], v[80:83], a[80:83], v[64:67]
    v_mfma_f32_16x16x32_bf16 v[68:71], v[80:83], a[84:87], v[68:71]
    v_mfma_f32_16x16x32_bf16 v[72:75], v[84:87], a[80:83], v[72:75]
    v_mfma_f32_16x16x32_bf16 v[76:79], v[84:87], a[84:87], v[76:79]
    ds_read_b128 v[80:83], v16 offset:768
    ds_read_b128 v[84:87], v16 offset:17152
    s_waitcnt lgkmcnt(2)
    v_mfma_f32_16x16x32_bf16 v[64:67], v[88:91], a[88:91], v[64:67]
    v_mfma_f32_16x16x32_bf16 v[68:71], v[88:91], a[92:95], v[68:71]
    v_mfma_f32_16x16x32_bf16 v[72:75], v[92:95], a[88:91], v[72:75]
    v_mfma_f32_16x16x32_bf16 v[76:79], v[92:95], a[92:95], v[76:79]
    ds_read_b128 v[88:91], v17 offset:768
    ds_read_b128 v[92:95], v17 offset:17152
    s_waitcnt lgkmcnt(2)
    v_mfma_f32_16x16x32_bf16 v[64:67], v[80:83], a[96:99], v[64:67]
    v_mfma_f32_16x16x32_bf16 v[68:71], v[80:83], a[100:103], v[68:71]
    v_mfma_f32_16x16x32_bf16 v[72:75], v[84:87], a[96:99], v[72:75]
    v_mfma_f32_16x16x32_bf16 v[76:79], v[84:87], a[100:103], v[76:79]
    ds_read_b128 v[80:83], v18 offset:768
    ds_read_b128 v[84:87], v18 offset:17152
    s_waitcnt lgkmcnt(2)
    v_mfma_f32_16x16x32_bf16 v[64:67], v[88:91], a[104:107], v[64:67]
    v_mfma_f32_16x16x32_bf16 v[68:71], v[88:91], a[108:111], v[68:71]
    v_mfma_f32_16x16x32_bf16 v[72:75], v[92:95], a[104:107], v[72:75]
    v_mfma_f32_16x16x32_bf16 v[76:79], v[92:95], a[108:111], v[76:79]
    ds_read_b128 v[88:91], v19 offset:768
    ds_read_b128 v[92:95], v19 offset:17152
    s_waitcnt lgkmcnt(2)
    v_mfma_f32_16x16x32_bf16 v[64:67], v[80:83], a[112:115], v[64:67]
    v_mfma_f32_16x16x32_bf16 v[68:71], v[80:83], a[116:119], v[68:71]
    v_mfma_f32_16x16x32_bf16 v[72:75], v[84:87], a[112:115], v[72:75]
    v_mfma_f32_16x16x32_bf16 v[76:79], v[84:87], a[116:119], v[76:79]
    s_waitcnt lgkmcnt(0)
    v_mfma_f32_16x16x32_bf16 v[64:67], v[88:91], a[120:123], v[64:67]
    v_mfma_f32_16x16x32_bf16 v[68:71], v[88:91], a[124:127], v[68:71]
    v_mfma_f32_16x16x32_bf16 v[72:75], v[92:95], a[120:123], v[72:75]
    v_mfma_f32_16x16x32_bf16 v[76:79], v[92:95], a[124:127], v[76:79]
    s_nop 7
    s_lshl_b32 s43, s34, 18
    v_cvt_pk_bf16_f32 v24, v64, v65
    v_cvt_pk_bf16_f32 v25, v66, v67
    v_cvt_pk_bf16_f32 v26, v72, v73
    v_cvt_pk_bf16_f32 v27, v74, v75
    buffer_store_dwordx4 v[24:27], v32, s[4:7], s43 offen offset:0 sc1
    v_cvt_pk_bf16_f32 v28, v68, v69
    v_cvt_pk_bf16_f32 v29, v70, v71
    v_cvt_pk_bf16_f32 v30, v76, v77
    v_cvt_pk_bf16_f32 v31, v78, v79
    buffer_store_dwordx4 v[28:31], v32, s[4:7], s43 offen offset:256 sc1
    s_add_u32 s34, s34, 2
    s_cmp_lg_u32 s41, 0
    s_cbranch_scc1 L_qkv_eg_75
    s_waitcnt vmcnt(0)
    s_barrier
    s_cmp_lg_u32 s14, 0
    s_cbranch_scc1 L_qkv_eg_75
    v_mov_b32 v6, 1
    s_mov_b64 exec, 1
    buffer_store_byte v6, v7, s[4:7], 0 offen sc1
    s_mov_b64 exec, -1
L_qkv_eg_75:
    s_waitcnt vmcnt(22)
    s_barrier
    s_cmp_lg_u32 s14, 0
    s_cbranch_scc1 L_qkv_np_76
    s_cmp_lt_i32 s74, 3
    s_cbranch_scc1 L_qkv_np_76
    v_mov_b32 v6, s74
    s_mov_b64 exec, 1
    buffer_store_byte v6, v7, s[4:7], 0 offen sc1
    s_mov_b64 exec, -1
L_qkv_np_76:
    s_add_u32 s74, s74, 1
    s_add_u32 s42, s34, 6
    s_min_u32 s42, s42, 63
    s_lshl_b32 s35, s42, 15
    s_add_u32 s35, s35, s36
    s_add_u32 m0, s36, 0
    s_add_u32 s37, s35, 0
    buffer_load_dwordx4 v8, s[16:19], s37 offen lds
    s_add_u32 m0, s36, 1024
    s_add_u32 s37, s35, 1024
    buffer_load_dwordx4 v9, s[16:19], s37 offen lds
    s_add_u32 m0, s36, 2048
    s_add_u32 s37, s35, 2048
    buffer_load_dwordx4 v10, s[16:19], s37 offen lds
    s_add_u32 m0, s36, 3072
    s_add_u32 s37, s35, 3072
    buffer_load_dwordx4 v11, s[16:19], s37 offen lds
    s_add_u32 m0, s36, 4096
    s_add_u32 s37, s35, 4096
    buffer_load_dwordx4 v12, s[16:19], s37 offen lds
    s_add_u32 m0, s36, 5120
    s_add_u32 s37, s35, 5120
    buffer_load_dwordx4 v13, s[16:19], s37 offen lds
    s_add_u32 m0, s36, 6144
    s_add_u32 s37, s35, 6144
    buffer_load_dwordx4 v14, s[16:19], s37 offen lds
    s_add_u32 m0, s36, 7168
    s_add_u32 s37, s35, 7168
    buffer_load_dwordx4 v15, s[16:19], s37 offen lds
    ds_read_b128 v[80:83], v16 offset:32768
    ds_read_b128 v[84:87], v16 offset:49152
    ds_read_b128 v[88:91], v17 offset:32768
    ds_read_b128 v[92:95], v17 offset:49152
    s_waitcnt lgkmcnt(2)
    v_mfma_f32_16x16x32_bf16 v[64:67], v[80:83], a[0:3], 0
    v_mfma_f32_16x16x32_bf16 v[68:71], v[80:83], a[4:7], 0
    v_mfma_f32_16x16x32_bf16 v[72:75], v[84:87], a[0:3], 0
    v_mfma_f32_16x16x32_bf16 v[76:79], v[84:87], a[4:7], 0
    ds_read_b128 v[80:83], v18 offset:32768
    ds_read_b128 v[84:87], v18 offset:49152
    s_waitcnt lgkmcnt(2)
    v_mfma_f32_16x16x32_bf16 v[64:67], v[88:91], a[8:11], v[64:67]
    v_mfma_f32_16x16x32_bf16 v[68:71], v[88:91], a[12:15], v[68:71]
    v_mfma_f32_16x16x32_bf16 v[72:75], v[92:95], a[8:11], v[72:75]
    v_mfma_f32_16x16x32_bf16 v[76:79], v[92:95], a[12:15], v[76:79]
    ds_read_b128 v[88:91], v19 offset:32768
    ds_read_b128 v[92:95], v19 offset:49152
    s_waitcnt lgkmcnt(2)
    v_mfma_f32_16x16x32_bf16 v[64:67], v[80:83], a[16:19], v[64:67]
    v_mfma_f32_16x16x32_bf16 v[68:71], v[80:83], a[20:23], v[68:71]
    v_mfma_f32_16x16x32_bf16 v[72:75], v[84:87], a[16:19], v[72:75]
    v_mfma_f32_16x16x32_bf16 v[76:79], v[84:87], a[20:23], v[76:79]
    ds_read_b128 v[80:83], v16 offset:33024
    ds_read_b128 v[84:87], v16 offset:49408
    s_waitcnt lgkmcnt(2)
    v_mfma_f32_16x16x32_bf16 v[64:67], v[88:91], a[24:27], v[64:67]
    v_mfma_f32_16x16x32_bf16 v[68:71], v[88:91], a[28:31], v[68:71]
    v_mfma_f32_16x16x32_bf16 v[72:75], v[92:95], a[24:27], v[72:75]
    v_mfma_f32_16x16x32_bf16 v[76:79], v[92:95], a[28:31], v[76:79]
    ds_read_b128 v[88:91], v17 offset:33024
    ds_read_b128 v[92:95], v17 offset:49408
    s_waitcnt lgkmcnt(2)
    v_mfma_f32_16x16x32_bf16 v[64:67], v[80:83], a[32:35], v[64:67]
    v_mfma_f32_16x16x32_bf16 v[68:71], v[80:83], a[36:39], v[68:71]
    v_mfma_f32_16x16x32_bf16 v[72:75], v[84:87], a[32:35], v[72:75]
    v_mfma_f32_16x16x32_bf16 v[76:79], v[84:87], a[36:39], v[76:79]
    ds_read_b128 v[80:83], v18 offset:33024
    ds_read_b128 v[84:87], v18 offset:49408
    s_waitcnt lgkmcnt(2)
    v_mfma_f32_16x16x32_bf16 v[64:67], v[88:91], a[40:43], v[64:67]
    v_mfma_f32_16x16x32_bf16 v[68:71], v[88:91], a[44:47], v[68:71]
    v_mfma_f32_16x16x32_bf16 v[72:75], v[92:95], a[40:43], v[72:75]
    v_mfma_f32_16x16x32_bf16 v[76:79], v[92:95], a[44:47], v[76:79]
    ds_read_b128 v[88:91], v19 offset:33024
    ds_read_b128 v[92:95], v19 offset:49408
    s_waitcnt lgkmcnt(2)
    v_mfma_f32_16x16x32_bf16 v[64:67], v[80:83], a[48:51], v[64:67]
    v_mfma_f32_16x16x32_bf16 v[68:71], v[80:83], a[52:55], v[68:71]
    v_mfma_f32_16x16x32_bf16 v[72:75], v[84:87], a[48:51], v[72:75]
    v_mfma_f32_16x16x32_bf16 v[76:79], v[84:87], a[52:55], v[76:79]
    ds_read_b128 v[80:83], v16 offset:33280
    ds_read_b128 v[84:87], v16 offset:49664
    s_waitcnt lgkmcnt(2)
    v_mfma_f32_16x16x32_bf16 v[64:67], v[88:91], a[56:59], v[64:67]
    v_mfma_f32_16x16x32_bf16 v[68:71], v[88:91], a[60:63], v[68:71]
    v_mfma_f32_16x16x32_bf16 v[72:75], v[92:95], a[56:59], v[72:75]
    v_mfma_f32_16x16x32_bf16 v[76:79], v[92:95], a[60:63], v[76:79]
    ds_read_b128 v[88:91], v17 offset:33280
    ds_read_b128 v[92:95], v17 offset:49664
    s_waitcnt lgkmcnt(2)
    v_mfma_f32_16x16x32_bf16 v[64:67], v[80:83], a[64:67], v[64:67]
    v_mfma_f32_16x16x32_bf16 v[68:71], v[80:83], a[68:71], v[68:71]
    v_mfma_f32_16x16x32_bf16 v[72:75], v[84:87], a[64:67], v[72:75]
    v_mfma_f32_16x16x32_bf16 v[76:79], v[84:87], a[68:71], v[76:79]
    ds_read_b128 v[80:83], v18 offset:33280
    ds_read_b128 v[84:87], v18 offset:49664
    s_waitcnt lgkmcnt(2)
    v_mfma_f32_16x16x32_bf16 v[64:67], v[88:91], a[72:75], v[64:67]
    v_mfma_f32_16x16x32_bf16 v[68:71], v[88:91], a[76:79], v[68:71]
    v_mfma_f32_16x16x32_bf16 v[72:75], v[92:95], a[72:75], v[72:75]
    v_mfma_f32_16x16x32_bf16 v[76:79], v[92:95], a[76:79], v[76:79]
    ds_read_b128 v[88:91], v19 offset:33280
    ds_read_b128 v[92:95], v19 offset:49664
    s_waitcnt lgkmcnt(2)
    v_mfma_f32_16x16x32_bf16 v[64:67], v[80:83], a[80:83], v[64:67]
    v_mfma_f32_16x16x32_bf16 v[68:71], v[80:83], a[84:87], v[68:71]
    v_mfma_f32_16x16x32_bf16 v[72:75], v[84:87], a[80:83], v[72:75]
    v_mfma_f32_16x16x32_bf16 v[76:79], v[84:87], a[84:87], v[76:79]
    ds_read_b128 v[80:83], v16 offset:33536
    ds_read_b128 v[84:87], v16 offset:49920
    s_waitcnt lgkmcnt(2)
    v_mfma_f32_16x16x32_bf16 v[64:67], v[88:91], a[88:91], v[64:67]
    v_mfma_f32_16x16x32_bf16 v[68:71], v[88:91], a[92:95], v[68:71]
    v_mfma_f32_16x16x32_bf16 v[72:75], v[92:95], a[88:91], v[72:75]
    v_mfma_f32_16x16x32_bf16 v[76:79], v[92:95], a[92:95], v[76:79]
    ds_read_b128 v[88:91], v17 offset:33536
    ds_read_b128 v[92:95], v17 offset:49920
    s_waitcnt lgkmcnt(2)
    v_mfma_f32_16x16x32_bf16 v[64:67], v[80:83], a[96:99], v[64:67]
    v_mfma_f32_16x16x32_bf16 v[68:71], v[80:83], a[100:103], v[68:71]
    v_mfma_f32_16x16x32_bf16 v[72:75], v[84:87], a[96:99], v[72:75]
    v_mfma_f32_16x16x32_bf16 v[76:79], v[84:87], a[100:103], v[76:79]
    ds_read_b128 v[80:83], v18 offset:33536
    ds_read_b128 v[84:87], v18 offset:49920
    s_waitcnt lgkmcnt(2)
    v_mfma_f32_16x16x32_bf16 v[64:67], v[88:91], a[104:107], v[64:67]
    v_mfma_f32_16x16x32_bf16 v[68:71], v[88:91], a[108:111], v[68:71]
    v_mfma_f32_16x16x32_bf16 v[72:75], v[92:95], a[104:107], v[72:75]
    v_mfma_f32_16x16x32_bf16 v[76:79], v[92:95], a[108:111], v[76:79]
    ds_read_b128 v[88:91], v19 offset:33536
    ds_read_b128 v[92:95], v19 offset:49920
    s_waitcnt lgkmcnt(2)
    v_mfma_f32_16x16x32_bf16 v[64:67], v[80:83], a[112:115], v[64:67]
    v_mfma_f32_16x16x32_bf16 v[68:71], v[80:83], a[116:119], v[68:71]
    v_mfma_f32_16x16x32_bf16 v[72:75], v[84:87], a[112:115], v[72:75]
    v_mfma_f32_16x16x32_bf16 v[76:79], v[84:87], a[116:119], v[76:79]
    s_waitcnt lgkmcnt(0)
    v_mfma_f32_16x16x32_bf16 v[64:67], v[88:91], a[120:123], v[64:67]
    v_mfma_f32_16x16x32_bf16 v[68:71], v[88:91], a[124:127], v[68:71]
    v_mfma_f32_16x16x32_bf16 v[72:75], v[92:95], a[120:123], v[72:75]
    v_mfma_f32_16x16x32_bf16 v[76:79], v[92:95], a[124:127], v[76:79]
    s_nop 7
    s_lshl_b32 s43, s34, 18
    v_cvt_pk_bf16_f32 v24, v64, v65
    v_cvt_pk_bf16_f32 v25, v66, v67
    v_cvt_pk_bf16_f32 v26, v72, v73
    v_cvt_pk_bf16_f32 v27, v74, v75
    buffer_store_dwordx4 v[24:27], v32, s[4:7], s43 offen offset:0 sc1
    v_cvt_pk_bf16_f32 v28, v68, v69
    v_cvt_pk_bf16_f32 v29, v70, v71
    v_cvt_pk_bf16_f32 v30, v76, v77
    v_cvt_pk_bf16_f32 v31, v78, v79
    buffer_store_dwordx4 v[28:31], v32, s[4:7], s43 offen offset:256 sc1
    s_add_u32 s34, s34, 2
    s_cmp_lg_u32 s41, 0
    s_cbranch_scc1 L_qkv_eg_77
    s_waitcnt vmcnt(0)
    s_barrier
    s_cmp_lg_u32 s14, 0
    s_cbranch_scc1 L_qkv_eg_77
    v_mov_b32 v6, 2
    s_mov_b64 exec, 1
    buffer_store_byte v6, v7, s[4:7], 0 offen sc1
    s_mov_b64 exec, -1
L_qkv_eg_77:
    s_waitcnt vmcnt(22)
    s_barrier
    s_cmp_lg_u32 s14, 0
    s_cbranch_scc1 L_qkv_np_78
    s_cmp_lt_i32 s74, 3
    s_cbranch_scc1 L_qkv_np_78
    v_mov_b32 v6, s74
    s_mov_b64 exec, 1
    buffer_store_byte v6, v7, s[4:7], 0 offen sc1
    s_mov_b64 exec, -1
L_qkv_np_78:
    s_add_u32 s74, s74, 1
    s_add_u32 s42, s34, 6
    s_min_u32 s42, s42, 63
    s_lshl_b32 s35, s42, 15
    s_add_u32 s35, s35, s36
    s_add_u32 m0, s36, 32768
    s_add_u32 s37, s35, 0
    buffer_load_dwordx4 v8, s[16:19], s37 offen lds
    s_add_u32 m0, s36, 33792
    s_add_u32 s37, s35, 1024
    buffer_load_dwordx4 v9, s[16:19], s37 offen lds
    s_add_u32 m0, s36, 34816
    s_add_u32 s37, s35, 2048
    buffer_load_dwordx4 v10, s[16:19], s37 offen lds
    s_add_u32 m0, s36, 35840
    s_add_u32 s37, s35, 3072
    buffer_load_dwordx4 v11, s[16:19], s37 offen lds
    s_add_u32 m0, s36, 36864
    s_add_u32 s37, s35, 4096
    buffer_load_dwordx4 v12, s[16:19], s37 offen lds
    s_add_u32 m0, s36, 37888
    s_add_u32 s37, s35, 5120
    buffer_load_dwordx4 v13, s[16:19], s37 offen lds
    s_add_u32 m0, s36, 38912
    s_add_u32 s37, s35, 6144
    buffer_load_dwordx4 v14, s[16:19], s37 offen lds
    s_add_u32 m0, s36, 39936
    s_add_u32 s37, s35, 7168
    buffer_load_dwordx4 v15, s[16:19], s37 offen lds
    ds_read_b128 v[80:83], v20 offset:0
    ds_read_b128 v[84:87], v20 offset:16384
    ds_read_b128 v[88:91], v21 offset:0
    ds_read_b128 v[92:95], v21 offset:16384
    s_waitcnt lgkmcnt(2)
    v_mfma_f32_16x16x32_bf16 v[64:67], v[80:83], a[0:3], 0
    v_mfma_f32_16x16x32_bf16 v[68:71], v[80:83], a[4:7], 0
    v_mfma_f32_16x16x32_bf16 v[72:75], v[84:87], a[0:3], 0
    v_mfma_f32_16x16x32_bf16 v[76:79], v[84:87], a[4:7], 0
    ds_read_b128 v[80:83], v22 offset:0
    ds_read_b128 v[84:87], v22 offset:16384
    s_waitcnt lgkmcnt(2)
    v_mfma_f32_16x16x32_bf16 v[64:67], v[88:91], a[8:11], v[64:67]
    v_mfma_f32_16x16x32_bf16 v[68:71], v[88:91], a[12:15], v[68:71]
    v_mfma_f32_16x16x32_bf16 v[72:75], v[92:95], a[8:11], v[72:75]
    v_mfma_f32_16x16x32_bf16 v[76:79], v[92:95], a[12:15], v[76:79]
    ds_read_b128 v[88:91], v23 offset:0
    ds_read_b128 v[92:95], v23 offset:16384
    s_waitcnt lgkmcnt(2)
    v_mfma_f32_16x16x32_bf16 v[64:67], v[80:83], a[16:19], v[64:67]
    v_mfma_f32_16x16x32_bf16 v[68:71], v[80:83], a[20:23], v[68:71]
    v_mfma_f32_16x16x32_bf16 v[72:75], v[84:87], a[16:19], v[72:75]
    v_mfma_f32_16x16x32_bf16 v[76:79], v[84:87], a[20:23], v[76:79]
    ds_read_b128 v[80:83], v20 offset:256
    ds_read_b128 v[84:87], v20 offset:16640
    s_waitcnt lgkmcnt(2)
    v_mfma_f32_16x16x32_bf16 v[64:67], v[88:91], a[24:27], v[64:67]
    v_mfma_f32_16x16x32_bf16 v[68:71], v[88:91], a[28:31], v[68:71]
    v_mfma_f32_16x16x32_bf16 v[72:75], v[92:95], a[24:27], v[72:75]
    v_mfma_f32_16x16x32_bf16 v[76:79], v[92:95], a[28:31], v[76:79]
    ds_read_b128 v[88:91], v21 offset:256
    ds_read_b128 v[92:95], v21 offset:16640
    s_waitcnt lgkmcnt(2)
    v_mfma_f32_16x16x32_bf16 v[64:67], v[80:83], a[32:35], v[64:67]
    v_mfma_f32_16x16x32_bf16 v[68:71], v[80:83], a[36:39], v[68:71]
    v_mfma_f32_16x16x32_bf16 v[72:75], v[84:87], a[32:35], v[72:75]
    v_mfma_f32_16x16x32_bf16 v[76:79], v[84:87], a[36:39], v[76:79]
    ds_read_b128 v[80:83], v22 offset:256
    ds_read_b128 v[84:87], v22 offset:16640
    s_waitcnt lgkmcnt(2)
    v_mfma_f32_16x16x32_bf16 v[64:67], v[88:91], a[40:43], v[64:67]
    v_mfma_f32_16x16x32_bf16 v[68:71], v[88:91], a[44:47], v[68:71]
    v_mfma_f32_16x16x32_bf16 v[72:75], v[92:95], a[40:43], v[72:75]
    v_mfma_f32_16x16x32_bf16 v[76:79], v[92:95], a[44:47], v[76:79]
    ds_read_b128 v[88:91], v23 offset:256
    ds_read_b128 v[92:95], v23 offset:16640
    s_waitcnt lgkmcnt(2)
    v_mfma_f32_16x16x32_bf16 v[64:67], v[80:83], a[48:51], v[64:67]
    v_mfma_f32_16x16x32_bf16 v[68:71], v[80:83], a[52:55], v[68:71]
    v_mfma_f32_16x16x32_bf16 v[72:75], v[84:87], a[48:51], v[72:75]
    v_mfma_f32_16x16x32_bf16 v[76:79], v[84:87], a[52:55], v[76:79]
    ds_read_b128 v[80:83], v20 offset:512
    ds_read_b128 v[84:87], v20 offset:16896
    s_waitcnt lgkmcnt(2)
    v_mfma_f32_16x16x32_bf16 v[64:67], v[88:91], a[56:59], v[64:67]
    v_mfma_f32_16x16x32_bf16 v[68:71], v[88:91], a[60:63], v[68:71]
    v_mfma_f32_16x16x32_bf16 v[72:75], v[92:95], a[56:59], v[72:75]
    v_mfma_f32_16x16x32_bf16 v[76:79], v[92:95], a[60:63], v[76:79]
    ds_read_b128 v[88:91], v21 offset:512
    ds_read_b128 v[92:95], v21 offset:16896
    s_waitcnt lgkmcnt(2)
    v_mfma_f32_16x16x32_bf16 v[64:67], v[80:83], a[64:67], v[64:67]
    v_mfma_f32_16x16x32_bf16 v[68:71], v[80:83], a[68:71], v[68:71]
    v_mfma_f32_16x16x32_bf16 v[72:75], v[84:87], a[64:67], v[72:75]
    v_mfma_f32_16x16x32_bf16 v[76:79], v[84:87], a[68:71], v[76:79]
    ds_read_b128 v[80:83], v22 offset:512
    ds_read_b128 v[84:87], v22 offset:16896
    s_waitcnt lgkmcnt(2)
    v_mfma_f32_16x16x32_bf16 v[64:67], v[88:91], a[72:75], v[64:67]
    v_mfma_f32_16x16x32_bf16 v[68:71], v[88:91], a[76:79], v[68:71]
    v_mfma_f32_16x16x32_bf16 v[72:75], v[92:95], a[72:75], v[72:75]
    v_mfma_f32_16x16x32_bf16 v[76:79], v[92:95], a[76:79], v[76:79]
    ds_read_b128 v[88:91], v23 offset:512
    ds_read_b128 v[92:95], v23 offset:16896
    s_waitcnt lgkmcnt(2)
    v_mfma_f32_16x16x32_bf16 v[64:67], v[80:83], a[80:83], v[64:67]
    v_mfma_f32_16x16x32_bf16 v[68:71], v[80:83], a[84:87], v[68:71]
    v_mfma_f32_16x16x32_bf16 v[72:75], v[84:87], a[80:83], v[72:75]
    v_mfma_f32_16x16x32_bf16 v[76:79], v[84:87], a[84:87], v[76:79]
    ds_read_b128 v[80:83], v20 offset:768
    ds_read_b128 v[84:87], v20 offset:17152
    s_waitcnt lgkmcnt(2)
    v_mfma_f32_16x16x32_bf16 v[64:67], v[88:91], a[88:91], v[64:67]
    v_mfma_f32_16x16x32_bf16 v[68:71], v[88:91], a[92:95], v[68:71]
    v_mfma_f32_16x16x32_bf16 v[72:75], v[92:95], a[88:91], v[72:75]
    v_mfma_f32_16x16x32_bf16 v[76:79], v[92:95], a[92:95], v[76:79]
    ds_read_b128 v[88:91], v21 offset:768
    ds_read_b128 v[92:95], v21 offset:17152
    s_waitcnt lgkmcnt(2)
    v_mfma_f32_16x16x32_bf16 v[64:67], v[80:83], a[96:99], v[64:67]
    v_mfma_f32_16x16x32_bf16 v[68:71], v[80:83], a[100:103], v[68:71]
    v_mfma_f32_16x16x32_bf16 v[72:75], v[84:87], a[96:99], v[72:75]
    v_mfma_f32_16x16x32_bf16 v[76:79], v[84:87], a[100:103], v[76:79]
    ds_read_b128 v[80:83], v22 offset:768
    ds_read_b128 v[84:87], v22 offset:17152
    s_waitcnt lgkmcnt(2)
    v_mfma_f32_16x16x32_bf16 v[64:67], v[88:91], a[104:107], v[64:67]
    v_mfma_f32_16x16x32_bf16 v[68:71], v[88:91], a[108:111], v[68:71]
    v_mfma_f32_16x16x32_bf16 v[72:75], v[92:95], a[104:107], v[72:75]
    v_mfma_f32_16x16x32_bf16 v[76:79], v[92:95], a[108:111], v[76:79]
    ds_read_b128 v[88:91], v23 offset:768
    ds_read_b128 v[92:95], v23 offset:17152
    s_waitcnt lgkmcnt(2)
    v_mfma_f32_16x16x32_bf16 v[64:67], v[80:83], a[112:115], v[64:67]
    v_mfma_f32_16x16x32_bf16 v[68:71], v[80:83], a[116:119], v[68:71]
    v_mfma_f32_16x16x32_bf16 v[72:75], v[84:87], a[112:115], v[72:75]
    v_mfma_f32_16x16x32_bf16 v[76:79], v[84:87], a[116:119], v[76:79]
    s_waitcnt lgkmcnt(0)
    v_mfma_f32_16x16x32_bf16 v[64:67], v[88:91], a[120:123], v[64:67]
    v_mfma_f32_16x16x32_bf16 v[68:71], v[88:91], a[124:127], v[68:71]
    v_mfma_f32_16x16x32_bf16 v[72:75], v[92:95], a[120:123], v[72:75]
    v_mfma_f32_16x16x32_bf16 v[76:79], v[92:95], a[124:127], v[76:79]
    s_nop 7
    s_lshl_b32 s43, s34, 18
    v_cvt_pk_bf16_f32 v24, v64, v65
    v_cvt_pk_bf16_f32 v25, v66, v67
    v_cvt_pk_bf16_f32 v26, v72, v73
    v_cvt_pk_bf16_f32 v27, v74, v75
    buffer_store_dwordx4 v[24:27], v32, s[4:7], s43 offen offset:0 sc1
    v_cvt_pk_bf16_f32 v28, v68, v69
    v_cvt_pk_bf16_f32 v29, v70, v71
    v_cvt_pk_bf16_f32 v30, v76, v77
    v_cvt_pk_bf16_f32 v31, v78, v79
    buffer_store_dwordx4 v[28:31], v32, s[4:7], s43 offen offset:256 sc1
    s_add_u32 s34, s34, 2
    s_waitcnt vmcnt(22)
    s_barrier
    s_cmp_lg_u32 s14, 0
    s_cbranch_scc1 L_qkv_np_79
    s_cmp_lt_i32 s74, 3
    s_cbranch_scc1 L_qkv_np_79
    v_mov_b32 v6, s74
    s_mov_b64 exec, 1
    buffer_store_byte v6, v7, s[4:7], 0 offen sc1
    s_mov_b64 exec, -1
L_qkv_np_79:
    s_add_u32 s74, s74, 1
    s_add_u32 s42, s34, 6
    s_min_u32 s42, s42, 63
    s_lshl_b32 s35, s42, 15
    s_add_u32 s35, s35, s36
    s_add_u32 m0, s36, 65536
    s_add_u32 s37, s35, 0
    buffer_load_dwordx4 v8, s[16:19], s37 offen lds
    s_add_u32 m0, s36, 66560
    s_add_u32 s37, s35, 1024
    buffer_load_dwordx4 v9, s[16:19], s37 offen lds
    s_add_u32 m0, s36, 67584
    s_add_u32 s37, s35, 2048
    buffer_load_dwordx4 v10, s[16:19], s37 offen lds
    s_add_u32 m0, s36, 68608
    s_add_u32 s37, s35, 3072
    buffer_load_dwordx4 v11, s[16:19], s37 offen lds
    s_add_u32 m0, s36, 69632
    s_add_u32 s37, s35, 4096
    buffer_load_dwordx4 v12, s[16:19], s37 offen lds
    s_add_u32 m0, s36, 70656
    s_add_u32 s37, s35, 5120
    buffer_load_dwordx4 v13, s[16:19], s37 offen lds
    s_add_u32 m0, s36, 71680
    s_add_u32 s37, s35, 6144
    buffer_load_dwordx4 v14, s[16:19], s37 offen lds
    s_add_u32 m0, s36, 72704
    s_add_u32 s37, s35, 7168
    buffer_load_dwordx4 v15, s[16:19], s37 offen lds
    ds_read_b128 v[80:83], v20 offset:32768
    ds_read_b128 v[84:87], v20 offset:49152
    ds_read_b128 v[88:91], v21 offset:32768
    ds_read_b128 v[92:95], v21 offset:49152
    s_waitcnt lgkmcnt(2)
    v_mfma_f32_16x16x32_bf16 v[64:67], v[80:83], a[0:3], 0
    v_mfma_f32_16x16x32_bf16 v[68:71], v[80:83], a[4:7], 0
    v_mfma_f32_16x16x32_bf16 v[72:75], v[84:87], a[0:3], 0
    v_mfma_f32_16x16x32_bf16 v[76:79], v[84:87], a[4:7], 0
    ds_read_b128 v[80:83], v22 offset:32768
    ds_read_b128 v[84:87], v22 offset:49152
    s_waitcnt lgkmcnt(2)
    v_mfma_f32_16x16x32_bf16 v[64:67], v[88:91], a[8:11], v[64:67]
    v_mfma_f32_16x16x32_bf16 v[68:71], v[88:91], a[12:15], v[68:71]
    v_mfma_f32_16x16x32_bf16 v[72:75], v[92:95], a[8:11], v[72:75]
    v_mfma_f32_16x16x32_bf16 v[76:79], v[92:95], a[12:15], v[76:79]
    ds_read_b128 v[88:91], v23 offset:32768
    ds_read_b128 v[92:95], v23 offset:49152
    s_waitcnt lgkmcnt(2)
    v_mfma_f32_16x16x32_bf16 v[64:67], v[80:83], a[16:19], v[64:67]
    v_mfma_f32_16x16x32_bf16 v[68:71], v[80:83], a[20:23], v[68:71]
    v_mfma_f32_16x16x32_bf16 v[72:75], v[84:87], a[16:19], v[72:75]
    v_mfma_f32_16x16x32_bf16 v[76:79], v[84:87], a[20:23], v[76:79]
    ds_read_b128 v[80:83], v20 offset:33024
    ds_read_b128 v[84:87], v20 offset:49408
    s_waitcnt lgkmcnt(2)
    v_mfma_f32_16x16x32_bf16 v[64:67], v[88:91], a[24:27], v[64:67]
    v_mfma_f32_16x16x32_bf16 v[68:71], v[88:91], a[28:31], v[68:71]
    v_mfma_f32_16x16x32_bf16 v[72:75], v[92:95], a[24:27], v[72:75]
    v_mfma_f32_16x16x32_bf16 v[76:79], v[92:95], a[28:31], v[76:79]
    ds_read_b128 v[88:91], v21 offset:33024
    ds_read_b128 v[92:95], v21 offset:49408
    s_waitcnt lgkmcnt(2)
    v_mfma_f32_16x16x32_bf16 v[64:67], v[80:83], a[32:35], v[64:67]
    v_mfma_f32_16x16x32_bf16 v[68:71], v[80:83], a[36:39], v[68:71]
    v_mfma_f32_16x16x32_bf16 v[72:75], v[84:87], a[32:35], v[72:75]
    v_mfma_f32_16x16x32_bf16 v[76:79], v[84:87], a[36:39], v[76:79]
    ds_read_b128 v[80:83], v22 offset:33024
    ds_read_b128 v[84:87], v22 offset:49408
    s_waitcnt lgkmcnt(2)
    v_mfma_f32_16x16x32_bf16 v[64:67], v[88:91], a[40:43], v[64:67]
    v_mfma_f32_16x16x32_bf16 v[68:71], v[88:91], a[44:47], v[68:71]
    v_mfma_f32_16x16x32_bf16 v[72:75], v[92:95], a[40:43], v[72:75]
    v_mfma_f32_16x16x32_bf16 v[76:79], v[92:95], a[44:47], v[76:79]
    ds_read_b128 v[88:91], v23 offset:33024
    ds_read_b128 v[92:95], v23 offset:49408
    s_waitcnt lgkmcnt(2)
    v_mfma_f32_16x16x32_bf16 v[64:67], v[80:83], a[48:51], v[64:67]
    v_mfma_f32_16x16x32_bf16 v[68:71], v[80:83], a[52:55], v[68:71]
    v_mfma_f32_16x16x32_bf16 v[72:75], v[84:87], a[48:51], v[72:75]
    v_mfma_f32_16x16x32_bf16 v[76:79], v[84:87], a[52:55], v[76:79]
    ds_read_b128 v[80:83], v20 offset:33280
    ds_read_b128 v[84:87], v20 offset:49664
    s_waitcnt lgkmcnt(2)
    v_mfma_f32_16x16x32_bf16 v[64:67], v[88:91], a[56:59], v[64:67]
    v_mfma_f32_16x16x32_bf16 v[68:71], v[88:91], a[60:63], v[68:71]
    v_mfma_f32_16x16x32_bf16 v[72:75], v[92:95], a[56:59], v[72:75]
    v_mfma_f32_16x16x32_bf16 v[76:79], v[92:95], a[60:63], v[76:79]
    ds_read_b128 v[88:91], v21 offset:33280
    ds_read_b128 v[92:95], v21 offset:49664
    s_waitcnt lgkmcnt(2)
    v_mfma_f32_16x16x32_bf16 v[64:67], v[80:83], a[64:67], v[64:67]
    v_mfma_f32_16x16x32_bf16 v[68:71], v[80:83], a[68:71], v[68:71]
    v_mfma_f32_16x16x32_bf16 v[72:75], v[84:87], a[64:67], v[72:75]
    v_mfma_f32_16x16x32_bf16 v[76:79], v[84:87], a[68:71], v[76:79]
    ds_read_b128 v[80:83], v22 offset:33280
    ds_read_b128 v[84:87], v22 offset:49664
    s_waitcnt lgkmcnt(2)
    v_mfma_f32_16x16x32_bf16 v[64:67], v[88:91], a[72:75], v[64:67]
    v_mfma_f32_16x16x32_bf16 v[68:71], v[88:91], a[76:79], v[68:71]
    v_mfma_f32_16x16x32_bf16 v[72:75], v[92:95], a[72:75], v[72:75]
    v_mfma_f32_16x16x32_bf16 v[76:79], v[92:95], a[76:79], v[76:79]
    ds_read_b128 v[88:91], v23 offset:33280
    ds_read_b128 v[92:95], v23 offset:49664
    s_waitcnt lgkmcnt(2)
    v_mfma_f32_16x16x32_bf16 v[64:67], v[80:83], a[80:83], v[64:67]
    v_mfma_f32_16x16x32_bf16 v[68:71], v[80:83], a[84:87], v[68:71]
    v_mfma_f32_16x16x32_bf16 v[72:75], v[84:87], a[80:83], v[72:75]
    v_mfma_f32_16x16x32_bf16 v[76:79], v[84:87], a[84:87], v[76:79]
    ds_read_b128 v[80:83], v20 offset:33536
    ds_read_b128 v[84:87], v20 offset:49920
    s_waitcnt lgkmcnt(2)
    v_mfma_f32_16x16x32_bf16 v[64:67], v[88:91], a[88:91], v[64:67]
    v_mfma_f32_16x16x32_bf16 v[68:71], v[88:91], a[92:95], v[68:71]
    v_mfma_f32_16x16x32_bf16 v[72:75], v[92:95], a[88:91], v[72:75]
    v_mfma_f32_16x16x32_bf16 v[76:79], v[92:95], a[92:95], v[76:79]
    ds_read_b128 v[88:91], v21 offset:33536
    ds_read_b128 v[92:95], v21 offset:49920
    s_waitcnt lgkmcnt(2)
    v_mfma_f32_16x16x32_bf16 v[64:67], v[80:83], a[96:99], v[64:67]
    v_mfma_f32_16x16x32_bf16 v[68:71], v[80:83], a[100:103], v[68:71]
    v_mfma_f32_16x16x32_bf16 v[72:75], v[84:87], a[96:99], v[72:75]
    v_mfma_f32_16x16x32_bf16 v[76:79], v[84:87], a[100:103], v[76:79]
    ds_read_b128 v[80:83], v22 offset:33536
    ds_read_b128 v[84:87], v22 offset:49920
    s_waitcnt lgkmcnt(2)
    v_mfma_f32_16x16x32_bf16 v[64:67], v[88:91], a[104:107], v[64:67]
    v_mfma_f32_16x16x32_bf16 v[68:71], v[88:91], a[108:111], v[68:71]
    v_mfma_f32_16x16x32_bf16 v[72:75], v[92:95], a[104:107], v[72:75]
    v_mfma_f32_16x16x32_bf16 v[76:79], v[92:95], a[108:111], v[76:79]
    ds_read_b128 v[88:91], v23 offset:33536
    ds_read_b128 v[92:95], v23 offset:49920
    s_waitcnt lgkmcnt(2)
    v_mfma_f32_16x16x32_bf16 v[64:67], v[80:83], a[112:115], v[64:67]
    v_mfma_f32_16x16x32_bf16 v[68:71], v[80:83], a[116:119], v[68:71]
    v_mfma_f32_16x16x32_bf16 v[72:75], v[84:87], a[112:115], v[72:75]
    v_mfma_f32_16x16x32_bf16 v[76:79], v[84:87], a[116:119], v[76:79]
    s_waitcnt lgkmcnt(0)
    v_mfma_f32_16x16x32_bf16 v[64:67], v[88:91], a[120:123], v[64:67]
    v_mfma_f32_16x16x32_bf16 v[68:71], v[88:91], a[124:127], v[68:71]
    v_mfma_f32_16x16x32_bf16 v[72:75], v[92:95], a[120:123], v[72:75]
    v_mfma_f32_16x16x32_bf16 v[76:79], v[92:95], a[124:127], v[76:79]
    s_nop 7
    s_lshl_b32 s43, s34, 18
    v_cvt_pk_bf16_f32 v24, v64, v65
    v_cvt_pk_bf16_f32 v25, v66, v67
    v_cvt_pk_bf16_f32 v26, v72, v73
    v_cvt_pk_bf16_f32 v27, v74, v75
    buffer_store_dwordx4 v[24:27], v32, s[4:7], s43 offen offset:0 sc1
    v_cvt_pk_bf16_f32 v28, v68, v69
    v_cvt_pk_bf16_f32 v29, v70, v71
    v_cvt_pk_bf16_f32 v30, v76, v77
    v_cvt_pk_bf16_f32 v31, v78, v79
    buffer_store_dwordx4 v[28:31], v32, s[4:7], s43 offen offset:256 sc1
    s_add_u32 s34, s34, 2
    s_add_u32 s41, s41, 1
    s_cmp_lt_u32 s41, 8
    s_cbranch_scc1 L_qkv_loop_73
L_qkv_done_65:
    s_waitcnt vmcnt(0)
    s_barrier
    s_cmp_lg_u32 s14, 0
    s_cbranch_scc1 L_qkv_np_80
    v_mov_b32 v6, 32
    s_mov_b64 exec, 1
    buffer_store_byte v6, v7, s[4:7], 0 offen sc1
    s_mov_b64 exec, -1
L_qkv_np_80:
    s_cmp_ge_u32 s90, 64
    s_cbranch_scc1 L_mg_tail_61
    s_add_u32 s91, s90, 64
    s_mov_b32 s92, 1
    s_branch L_mg_ssm_60
L_mg_ssm0_59:
    s_sub_u32 s91, s90, 192
    s_lshl_b32 s91, s91, 1
    s_mov_b32 s92, 2
L_mg_ssm_60:
    s_mov_b32 s15, s91
    s_load_dwordx2 s[24:25], s[0:1], 0
    s_load_dwordx4 s[28:31], s[0:1], 64
    s_load_dwordx4 s[32:35], s[0:1], 80
    s_load_dwordx4 s[36:39], s[0:1], 96
    s_load_dwordx2 s[40:41], s[0:1], 112
    v_and_b32 v1, 63, v0
    v_and_b32 v2, 15, v1
    v_lshrrev_b32 v3, 4, v1
    s_lshl_b32 s16, s14, 15
    s_lshl_b32 s17, s15, 2
    s_add_u32 s17, s17, s14
    s_waitcnt lgkmcnt(0)
    s_mov_b32 s8, s24
    s_and_b32 s9, s25, 0xffff
    s_mov_b32 s10, 0x200000
    s_mov_b32 s11, 0x00020000
    v_lshlrev_b32 v4, 10, v0
    s_lshl_b32 s18, s15, 3
    s_add_u32 s19, s18, 0
    buffer_load_dwordx2 v[16:17], v4, s[8:11], s19 offen
    s_add_u32 s19, s18, 262144
    buffer_load_dwordx2 v[18:19], v4, s[8:11], s19 offen
    s_add_u32 s19, s18, 524288
    buffer_load_dwordx2 v[20:21], v4, s[8:11], s19 offen
    s_add_u32 s19, s18, 786432
    buffer_load_dwordx2 v[22:23], v4, s[8:11], s19 offen
    s_add_u32 s19, s18, 1048576
    buffer_load_dwordx2 v[24:25], v4, s[8:11], s19 offen
    s_add_u32 s19, s18, 1310720
    buffer_load_dwordx2 v[26:27], v4, s[8:11], s19 offen
    s_add_u32 s19, s18, 1572864
    buffer_load_dwordx2 v[28:29], v4, s[8:11], s19 offen
    s_add_u32 s19, s18, 1835008
    buffer_load_dwordx2 v[30:31], v4, s[8:11], s19 offen
    s_lshl_b32 s19, s17, 8
    v_lshlrev_b32 v5, 2, v1
    v_add_u32 v5, s19, v5
    global_load_dword v32, v5, s[28:29]
    global_load_dword v33, v5, s[30:31]
    global_load_dword v34, v5, s[32:33]
    global_load_dword v35, v5, s[34:35]
    global_load_dword v36, v5, s[36:37]
    global_load_dword v37, v5, s[38:39]
    s_lshl_b32 s19, s17, 1
    v_mov_b32 v6, s19
    global_load_ushort v38, v6, s[40:41]
    v_mov_b32 v7, 0
    v_lshlrev_b32 v8, 2, v1
    v_add_u32 v8, s16, v8
    ds_write_b32 v8, v7 offset:0
    ds_write_b32 v8, v7 offset:256
    ds_write_b32 v8, v7 offset:512
    ds_write_b32 v8, v7 offset:768
    ds_write_b32 v8, v7 offset:1024
    ds_write_b32 v8, v7 offset:1280
    ds_write_b32 v8, v7 offset:1536
    ds_write_b32 v8, v7 offset:1792
    ds_write_b32 v8, v7 offset:2048
    ds_write_b32 v8, v7 offset:2304
    v_lshrrev_b32 v8, 5, v0
    v_mul_u32_u24 v8, 80, v8
    v_and_b32 v9, 31, v0
    v_lshl_add_u32 v8, v9, 1, v8
    v_add_u32 v8, 2560, v8
    v_add_u32 v9, 65536, v8
    s_waitcnt vmcnt(7)
    ds_write_b16 v8, v16 offset:0
    ds_write_b16_d16_hi v8, v16 offset:32768
    ds_write_b16 v9, v17 offset:0
    ds_write_b16_d16_hi v9, v17 offset:32768
    ds_write_b16 v8, v18 offset:640
    ds_write_b16_d16_hi v8, v18 offset:33408
    ds_write_b16 v9, v19 offset:640
    ds_write_b16_d16_hi v9, v19 offset:33408
    ds_write_b16 v8, v20 offset:1280
    ds_write_b16_d16_hi v8, v20 offset:34048
    ds_write_b16 v9, v21 offset:1280
    ds_write_b16_d16_hi v9, v21 offset:34048
    ds_write_b16 v8, v22 offset:1920
    ds_write_b16_d16_hi v8, v22 offset:34688
    ds_write_b16 v9, v23 offset:1920
    ds_write_b16_d16_hi v9, v23 offset:34688
    ds_write_b16 v8, v24 offset:2560
    ds_write_b16_d16_hi v8, v24 offset:35328
    ds_write_b16 v9, v25 offset:2560
    ds_write_b16_d16_hi v9, v25 offset:35328
    ds_write_b16 v8, v26 offset:3200
    ds_write_b16_d16_hi v8, v26 offset:35968
    ds_write_b16 v9, v27 offset:3200
    ds_write_b16_d16_hi v9, v27 offset:35968
    ds_write_b16 v8, v28 offset:3840
    ds_write_b16_d16_hi v8, v28 offset:36608
    ds_write_b16 v9, v29 offset:3840
    ds_write_b16_d16_hi v9, v29 offset:36608
    ds_write_b16 v8, v30 offset:4480
    ds_write_b16_d16_hi v8, v30 offset:37248
    ds_write_b16 v9, v31 offset:4480
    ds_write_b16_d16_hi v9, v31 offset:37248
    s_waitcnt vmcnt(0)
    v_lshlrev_b32 v38, 16, v38
    v_mul_f32 v38, 0x3fb8aa3b, v38
    v_exp_f32 v38, v38
    s_nop 0
    v_cvt_pk_bf16_f32 v38, v38, v38
    v_lshlrev_b32 v38, 16, v38
    v_lshlrev_b32 v8, 6, v1
    v_add_u32 v8, s16, v8
    v_lshlrev_b32 v40, 16, v32
    v_lshlrev_b32 v41, 16, v33
    v_lshlrev_b32 v42, 16, v34
    v_lshlrev_b32 v43, 16, v35
    v_lshlrev_b32 v44, 16, v36
    v_lshlrev_b32 v45, 16, v37
    v_mul_f32 v40, v38, v40
    v_mul_f32 v41, v38, v41
    v_mul_f32 v42, v38, v42
    v_mul_f32 v43, v38, v43
    v_mul_f32 v48, 0x3fb8aa3b, v40
    v_mul_f32 v49, 0.15915494, v41
    v_mul_f32 v46, v44, v42
    v_fma_f32 v46, -v45, v43, v46
    v_mul_f32 v47, v44, v43
    v_fma_f32 v47, v45, v42, v47
    v_mov_b32 v50, v46
    v_sub_f32 v51, 0, v47
    v_mov_b32 v52, v48
    v_mov_b32 v53, v49
    v_sub_f32 v54, 0, v47
    v_sub_f32 v55, 0, v46
    ds_write_b128 v8, v[48:51] offset:7680
    ds_write_b128 v8, v[52:55] offset:7696
    s_waitcnt lgkmcnt(0)
    v_and_b32 v40, 0xffff0000, v32
    v_and_b32 v41, 0xffff0000, v33
    v_and_b32 v42, 0xffff0000, v34
    v_and_b32 v43, 0xffff0000, v35
    v_and_b32 v44, 0xffff0000, v36
    v_and_b32 v45, 0xffff0000, v37
    v_mul_f32 v40, v38, v40
    v_mul_f32 v41, v38, v41
    v_mul_f32 v42, v38, v42
    v_mul_f32 v43, v38, v43
    v_mul_f32 v48, 0x3fb8aa3b, v40
    v_mul_f32 v49, 0.15915494, v41
    v_mul_f32 v46, v44, v42
    v_fma_f32 v46, -v45, v43, v46
    v_mul_f32 v47, v44, v43
    v_fma_f32 v47, v45, v42, v47
    v_mov_b32 v50, v46
    v_sub_f32 v51, 0, v47
    v_mov_b32 v52, v48
    v_mov_b32 v53, v49
    v_sub_f32 v54, 0, v47
    v_sub_f32 v55, 0, v46
    ds_write_b128 v8, v[48:51] offset:7712
    ds_write_b128 v8, v[52:55] offset:7728
    s_waitcnt lgkmcnt(0)
    v_lshlrev_b32 v10, 3, v2
    v_cvt_f32_u32 v10, v10
    v_and_b32 v11, 1, v3
    v_cvt_f32_u32 v11, v11
    v_mul_f32 v11, 0xbe800000, v11
    v_lshrrev_b32 v12, 3, v2
    v_lshlrev_b32 v12, 7, v12
    v_and_b32 v13, 7, v2
    v_add_u32 v12, v12, v13
    v_bfe_u32 v13, v2, 2, 1
    v_lshlrev_b32 v13, 7, v13
    v_and_b32 v14, 3, v2
    v_lshl_add_u32 v13, v14, 1, v13
    v_add_u32 v13, 256, v13
    v_bfe_u32 v14, v2, 1, 2
    v_lshlrev_b32 v14, 7, v14
    v_and_b32 v15, 1, v2
    v_lshl_add_u32 v14, v15, 2, v14
    v_add_u32 v14, 0x200, v14
    v_cmp_gt_u32 vcc, 8, v2
    s_nop 1
    v_cndmask_b32 v13, v14, v13, vcc
    v_lshlrev_b32 v14, 7, v2
    v_add_u32 v14, 0x400, v14
    v_cmp_gt_u32 vcc, 9, v2
    s_nop 1
    v_cndmask_b32 v14, 0, v14, vcc
    v_cvt_f32_u32 v16, v12
    v_cvt_f32_u32 v17, v13
    v_cvt_f32_u32 v18, v14
    v_lshlrev_b32 v8, 4, v3
    v_add_u32 v8, s16, v8
    s_mov_b32 s20, 0
    v_mov_b32 v64, 0
    v_mov_b32 v65, 0
    v_mov_b32 v66, 0
    v_mov_b32 v67, 0
    v_mov_b32 v68, 0
    v_mov_b32 v69, 0
    v_mov_b32 v70, 0
    v_mov_b32 v71, 0
    v_mov_b32 v72, 0
    v_mov_b32 v73, 0
    v_mov_b32 v74, 0
    v_mov_b32 v75, 0
    ds_read_b128 v[40:43], v8 offset:7680
L_ss_kgen_81:
    s_waitcnt lgkmcnt(0)
    v_mov_b64 v[20:21], v[40:41]
    v_mov_b64 v[22:23], v[42:43]
    v_add_u32 v8, 64, v8
    ds_read_b128 v[40:43], v8 offset:7680
    v_mul_f32 v24, v20, v10
    v_fma_f32 v25, v21, v10, v11
    v_exp_f32 v24, v24
    v_fract_f32 v25, v25
    v_cos_f32 v25, v25
    v_mul_f32 v26, v20, v16
    v_mul_f32 v27, v21, v16
    v_exp_f32 v26, v26
    v_fract_f32 v27, v27
    v_cos_f32 v28, v27
    v_sin_f32 v27, v27
    v_mul_f32 v30, v20, v17
    v_mul_f32 v31, v21, v17
    v_exp_f32 v30, v30
    v_fract_f32 v31, v31
    v_cos_f32 v32, v31
    v_sin_f32 v31, v31
    v_mul_f32 v34, v20, v18
    v_mul_f32 v35, v21, v18
    v_exp_f32 v34, v34
    v_fract_f32 v35, v35
    v_cos_f32 v36, v35
    v_sin_f32 v35, v35
    v_mul_f32 v24, v24, v25
    v_mul_f32 v28, v22, v28
    v_fma_f32 v28, v23, v27, v28
    v_mul_f32 v28, v26, v28
    v_mul_f32 v32, v22, v32
    v_fma_f32 v32, v23, v31, v32
    v_mul_f32 v32, v30, v32
    v_mul_f32 v36, v22, v36
    v_fma_f32 v36, v23, v35, v36
    v_mul_f32 v36, v34, v36
    s_add_u32 s20, s20, 1
    s_cmp_lt_u32 s20, 64
    v_mfma_f32_16x16x4_f32 v[64:67], v28, v24, v[64:67]
    v_mfma_f32_16x16x4_f32 v[68:71], v32, v24, v[68:71]
    v_mfma_f32_16x16x4_f32 v[72:75], v36, v24, v[72:75]
    s_cbranch_scc1 L_ss_kgen_81
    s_nop 7
    s_nop 7
    s_waitcnt lgkmcnt(0)
    v_lshlrev_b32 v20, 4, v3
    v_lshlrev_b32 v21, 5, v2
    v_add_u32 v21, s16, v21
    v_add_u32 v22, 0, v20
    ds_bpermute_b32 v23, v22, v12
    s_waitcnt lgkmcnt(0)
    v_lshl_add_u32 v23, v23, 2, v21
    ds_write_b32 v23, v64 offset:7680
    v_add_u32 v22, 4, v20
    ds_bpermute_b32 v23, v22, v12
    s_waitcnt lgkmcnt(0)
    v_lshl_add_u32 v23, v23, 2, v21
    ds_write_b32 v23, v65 offset:7680
    v_add_u32 v22, 8, v20
    ds_bpermute_b32 v23, v22, v12
    s_waitcnt lgkmcnt(0)
    v_lshl_add_u32 v23, v23, 2, v21
    ds_write_b32 v23, v66 offset:7680
    v_add_u32 v22, 12, v20
    ds_bpermute_b32 v23, v22, v12
    s_waitcnt lgkmcnt(0)
    v_lshl_add_u32 v23, v23, 2, v21
    ds_write_b32 v23, v67 offset:7680
    v_add_u32 v22, 0, v20
    ds_bpermute_b32 v23, v22, v13
    s_waitcnt lgkmcnt(0)
    v_lshl_add_u32 v23, v23, 2, v21
    ds_write_b32 v23, v68 offset:7680
    v_add_u32 v22, 4, v20
    ds_bpermute_b32 v23, v22, v13
    s_waitcnt lgkmcnt(0)
    v_lshl_add_u32 v23, v23, 2, v21
    ds_write_b32 v23, v69 offset:7680
    v_add_u32 v22, 8, v20
    ds_bpermute_b32 v23, v22, v13
    s_waitcnt lgkmcnt(0)
    v_lshl_add_u32 v23, v23, 2, v21
    ds_write_b32 v23, v70 offset:7680
    v_add_u32 v22, 12, v20
    ds_bpermute_b32 v23, v22, v13
    s_waitcnt lgkmcnt(0)
    v_lshl_add_u32 v23, v23, 2, v21
    ds_write_b32 v23, v71 offset:7680
    v_add_u32 v22, 0, v20
    ds_bpermute_b32 v23, v22, v14
    s_waitcnt lgkmcnt(0)
    v_lshl_add_u32 v23, v23, 2, v21
    v_lshlrev_b32 v24, 2, v3
    v_add_u32 v24, 0, v24
    v_lshl_add_u32 v25, v24, 4, v2
    v_cmp_gt_u32 vcc, 129, v25
    s_and_saveexec_b64 s[44:45], vcc
    ds_write_b32 v23, v72 offset:7680
    s_mov_b64 exec, s[44:45]
    v_add_u32 v22, 4, v20
    ds_bpermute_b32 v23, v22, v14
    s_waitcnt lgkmcnt(0)
    v_lshl_add_u32 v23, v23, 2, v21
    v_lshlrev_b32 v24, 2, v3
    v_add_u32 v24, 1, v24
    v_lshl_add_u32 v25, v24, 4, v2
    v_cmp_gt_u32 vcc, 129, v25
    s_and_saveexec_b64 s[44:45], vcc
    ds_write_b32 v23, v73 offset:7680
    s_mov_b64 exec, s[44:45]
    v_add_u32 v22, 8, v20
    ds_bpermute_b32 v23, v22, v14
    s_waitcnt lgkmcnt(0)
    v_lshl_add_u32 v23, v23, 2, v21
    v_lshlrev_b32 v24, 2, v3
    v_add_u32 v24, 2, v24
    v_lshl_add_u32 v25, v24, 4, v2
    v_cmp_gt_u32 vcc, 129, v25
    s_and_saveexec_b64 s[44:45], vcc
    ds_write_b32 v23, v74 offset:7680
    s_mov_b64 exec, s[44:45]
    v_add_u32 v22, 12, v20
    ds_bpermute_b32 v23, v22, v14
    s_waitcnt lgkmcnt(0)
    v_lshl_add_u32 v23, v23, 2, v21
    v_lshlrev_b32 v24, 2, v3
    v_add_u32 v24, 3, v24
    v_lshl_add_u32 v25, v24, 4, v2
    v_cmp_gt_u32 vcc, 129, v25
    s_and_saveexec_b64 s[44:45], vcc
    ds_write_b32 v23, v75 offset:7680
    s_mov_b64 exec, s[44:45]
    s_waitcnt lgkmcnt(0)
    v_mov_b32 v20, v1
    s_mov_b32 s20, 0
L_ss_exp_82:
    v_lshlrev_b32 v21, 1, v20
    v_sub_u32 v21, 0x7ff, v21
    v_subrev_u32 v22, 0, v21
    v_max_i32 v23, 0, v22
    v_cvt_f32_u32 v23, v23
    v_cvt_pk_bf16_f32 v23, v23, v23
    v_lshlrev_b32 v23, 16, v23
    v_cvt_u32_f32 v23, v23
    v_lshlrev_b32 v23, 2, v23
    v_add_u32 v23, s16, v23
    ds_read_b32 v24, v23 offset:7680
    v_cmp_le_i32 s[46:47], 0, v22
    v_subrev_u32 v22, 1, v21
    v_max_i32 v23, 0, v22
    v_cvt_f32_u32 v23, v23
    v_cvt_pk_bf16_f32 v23, v23, v23
    v_lshlrev_b32 v23, 16, v23
    v_cvt_u32_f32 v23, v23
    v_lshlrev_b32 v23, 2, v23
    v_add_u32 v23, s16, v23
    ds_read_b32 v25, v23 offset:7680
    v_cmp_le_i32 s[48:49], 0, v22
    v_subrev_u32 v22, 2, v21
    v_max_i32 v23, 0, v22
    v_cvt_f32_u32 v23, v23
    v_cvt_pk_bf16_f32 v23, v23, v23
    v_lshlrev_b32 v23, 16, v23
    v_cvt_u32_f32 v23, v23
    v_lshlrev_b32 v23, 2, v23
    v_add_u32 v23, s16, v23
    ds_read_b32 v26, v23 offset:7680
    v_cmp_le_i32 s[50:51], 0, v22
    s_waitcnt lgkmcnt(0)
    v_cndmask_b32 v24, 0, v24, s[46:47]
    v_cndmask_b32 v25, 0, v25, s[48:49]
    v_cndmask_b32 v26, 0, v26, s[50:51]
    v_cvt_pk_bf16_f32 v28, v24, v25
    v_cvt_pk_bf16_f32 v29, v25, v26
    v_lshlrev_b32 v30, 16, v28
    v_and_b32 v31, 0xffff0000, v28
    v_and_b32 v32, 0xffff0000, v29
    v_sub_f32 v24, v24, v30
    v_sub_f32 v25, v25, v31
    v_sub_f32 v26, v26, v32
    v_cvt_pk_bf16_f32 v30, v24, v25
    v_cvt_pk_bf16_f32 v31, v25, v26
    v_lshlrev_b32 v23, 2, v20
    v_add_u32 v23, s16, v23
    v_cmp_gt_u32 vcc, 1040, v20
    s_and_saveexec_b64 s[44:45], vcc
    ds_write_b32 v23, v28 offset:16128
    ds_write_b32 v23, v29 offset:20288
    ds_write_b32 v23, v30 offset:24448
    ds_write_b32 v23, v31 offset:28608
    s_mov_b64 exec, s[44:45]
    v_add_u32 v20, 64, v20
    s_add_u32 s20, s20, 1
    s_cmp_lt_u32 s20, 17
    s_cbranch_scc1 L_ss_exp_82
    s_waitcnt lgkmcnt(0)
    s_barrier
    v_and_b32 v20, 31, v1
    v_lshrrev_b32 v21, 5, v1
    v_lshlrev_b32 v22, 3, v21
    v_sub_u32 v22, v22, v20
    v_add_u32 v22, 0x7ff, v22
    v_and_b32 v23, 1, v22
    v_mul_u32_u24 v23, 4160, v23
    v_lshrrev_b32 v22, 1, v22
    v_lshl_add_u32 v22, v22, 2, v23
    v_add_u32 v22, s16, v22
    v_add_u32 v22, 16128, v22
    v_add_u32 v23, 8320, v22
    v_mul_u32_u24 v24, 80, v20
    v_lshl_add_u32 v24, v21, 4, v24
    v_add_u32 v24, s16, v24
    v_add_u32 v24, 2560, v24
    v_add_u32 v25, 2560, v24
    s_mov_b32 s20, 0
    v_mov_b32 v64, 0
    v_mov_b32 v65, 0
    v_mov_b32 v66, 0
    v_mov_b32 v67, 0
    v_mov_b32 v68, 0
    v_mov_b32 v69, 0
    v_mov_b32 v70, 0
    v_mov_b32 v71, 0
    v_mov_b32 v72, 0
    v_mov_b32 v73, 0
    v_mov_b32 v74, 0
    v_mov_b32 v75, 0
    v_mov_b32 v76, 0
    v_mov_b32 v77, 0
    v_mov_b32 v78, 0
    v_mov_b32 v79, 0
    v_mov_b32 v80, 0
    v_mov_b32 v81, 0
    v_mov_b32 v82, 0
    v_mov_b32 v83, 0
    v_mov_b32 v84, 0
    v_mov_b32 v85, 0
    v_mov_b32 v86, 0
    v_mov_b32 v87, 0
    v_mov_b32 v88, 0
    v_mov_b32 v89, 0
    v_mov_b32 v90, 0
    v_mov_b32 v91, 0
    v_mov_b32 v92, 0
    v_mov_b32 v93, 0
    v_mov_b32 v94, 0
    v_mov_b32 v95, 0
    ds_read2_b32 v[28:29], v22 offset0:0 offset1:1
    ds_read2_b32 v[30:31], v22 offset0:2 offset1:3
    ds_read2_b32 v[32:33], v23 offset0:0 offset1:1
    ds_read2_b32 v[34:35], v23 offset0:2 offset1:3
    ds_read_b128 v[44:47], v25 offset:0
    ds_read_b128 v[52:55], v24 offset:0
    ds_read2_b32 v[36:37], v22 offset0:8 offset1:9
    ds_read2_b32 v[38:39], v22 offset0:10 offset1:11
    ds_read2_b32 v[40:41], v23 offset0:8 offset1:9
    ds_read2_b32 v[42:43], v23 offset0:10 offset1:11
    ds_read_b128 v[48:51], v25 offset:32
    ds_read_b128 v[56:59], v24 offset:32
    v_subrev_u32 v22, 64, v22
    v_subrev_u32 v23, 64, v23
    v_subrev_u32 v25, 80, v25
    v_subrev_u32 v24, 80, v24
L_ss_c1_83:
    ds_read2_b32 v[96:97], v22 offset0:0 offset1:1
    ds_read2_b32 v[98:99], v22 offset0:2 offset1:3
    ds_read2_b32 v[100:101], v23 offset0:0 offset1:1
    ds_read2_b32 v[102:103], v23 offset0:2 offset1:3
    ds_read_b128 v[112:115], v25 offset:0
    ds_read_b128 v[120:123], v24 offset:0
    ds_read2_b32 v[104:105], v22 offset0:8 offset1:9
    ds_read2_b32 v[106:107], v22 offset0:10 offset1:11
    ds_read2_b32 v[108:109], v23 offset0:8 offset1:9
    ds_read2_b32 v[110:111], v23 offset0:10 offset1:11
    ds_read_b128 v[116:119], v25 offset:32
    ds_read_b128 v[124:127], v24 offset:32
    v_subrev_u32 v22, 64, v22
    v_subrev_u32 v23, 64, v23
    v_subrev_u32 v25, 80, v25
    v_subrev_u32 v24, 80, v24
    s_waitcnt lgkmcnt(12)
    v_mfma_f32_32x32x16_bf16 v[80:95], v[28:31], v[44:47], v[80:95]
    v_mfma_f32_32x32x16_bf16 v[64:79], v[28:31], v[52:55], v[64:79]
    v_mfma_f32_32x32x16_bf16 v[80:95], v[32:35], v[44:47], v[80:95]
    v_mfma_f32_32x32x16_bf16 v[64:79], v[32:35], v[52:55], v[64:79]
    v_mfma_f32_32x32x16_bf16 v[80:95], v[36:39], v[48:51], v[80:95]
    v_mfma_f32_32x32x16_bf16 v[64:79], v[36:39], v[56:59], v[64:79]
    v_mfma_f32_32x32x16_bf16 v[80:95], v[40:43], v[48:51], v[80:95]
    v_mfma_f32_32x32x16_bf16 v[64:79], v[40:43], v[56:59], v[64:79]
    s_add_u32 s20, s20, 2
    s_cmp_lt_u32 s20, 32
    s_cbranch_scc0 L_ss_x_85
    ds_read2_b32 v[28:29], v22 offset0:0 offset1:1
    ds_read2_b32 v[30:31], v22 offset0:2 offset1:3
    ds_read2_b32 v[32:33], v23 offset0:0 offset1:1
    ds_read2_b32 v[34:35], v23 offset0:2 offset1:3
    ds_read_b128 v[44:47], v25 offset:0
    ds_read_b128 v[52:55], v24 offset:0
    ds_read2_b32 v[36:37], v22 offset0:8 offset1:9
    ds_read2_b32 v[38:39], v22 offset0:10 offset1:11
    ds_read2_b32 v[40:41], v23 offset0:8 offset1:9
    ds_read2_b32 v[42:43], v23 offset0:10 offset1:11
    ds_read_b128 v[48:51], v25 offset:32
    ds_read_b128 v[56:59], v24 offset:32
    v_subrev_u32 v22, 64, v22
    v_subrev_u32 v23, 64, v23
    v_subrev_u32 v25, 80, v25
    v_subrev_u32 v24, 80, v24
    s_waitcnt lgkmcnt(12)
    v_mfma_f32_32x32x16_bf16 v[80:95], v[96:99], v[112:115], v[80:95]
    v_mfma_f32_32x32x16_bf16 v[64:79], v[96:99], v[120:123], v[64:79]
    v_mfma_f32_32x32x16_bf16 v[80:95], v[100:103], v[112:115], v[80:95]
    v_mfma_f32_32x32x16_bf16 v[64:79], v[100:103], v[120:123], v[64:79]
    v_mfma_f32_32x32x16_bf16 v[80:95], v[104:107], v[116:119], v[80:95]
    v_mfma_f32_32x32x16_bf16 v[64:79], v[104:107], v[124:127], v[64:79]
    v_mfma_f32_32x32x16_bf16 v[80:95], v[108:111], v[116:119], v[80:95]
    v_mfma_f32_32x32x16_bf16 v[64:79], v[108:111], v[124:127], v[64:79]
    s_branch L_ss_c1_83
L_ss_x_85:
    ds_read2_b32 v[28:29], v22 offset0:0 offset1:1
    ds_read2_b32 v[30:31], v22 offset0:2 offset1:3
    ds_read2_b32 v[32:33], v23 offset0:0 offset1:1
    ds_read2_b32 v[34:35], v23 offset0:2 offset1:3
    ds_read_b128 v[44:47], v25 offset:0
    ds_read2_b32 v[36:37], v22 offset0:8 offset1:9
    ds_read2_b32 v[38:39], v22 offset0:10 offset1:11
    ds_read2_b32 v[40:41], v23 offset0:8 offset1:9
    ds_read2_b32 v[42:43], v23 offset0:10 offset1:11
    ds_read_b128 v[48:51], v25 offset:32
    v_subrev_u32 v22, 64, v22
    v_subrev_u32 v23, 64, v23
    v_subrev_u32 v25, 80, v25
    s_waitcnt lgkmcnt(10)
    v_mfma_f32_32x32x16_bf16 v[80:95], v[96:99], v[112:115], v[80:95]
    v_mfma_f32_32x32x16_bf16 v[64:79], v[96:99], v[120:123], v[64:79]
    v_mfma_f32_32x32x16_bf16 v[80:95], v[100:103], v[112:115], v[80:95]
    v_mfma_f32_32x32x16_bf16 v[64:79], v[100:103], v[120:123], v[64:79]
    v_mfma_f32_32x32x16_bf16 v[80:95], v[104:107], v[116:119], v[80:95]
    v_mfma_f32_32x32x16_bf16 v[64:79], v[104:107], v[124:127], v[64:79]
    v_mfma_f32_32x32x16_bf16 v[80:95], v[108:111], v[116:119], v[80:95]
    v_mfma_f32_32x32x16_bf16 v[64:79], v[108:111], v[124:127], v[64:79]
L_ss_c2_84:
    ds_read2_b32 v[96:97], v22 offset0:0 offset1:1
    ds_read2_b32 v[98:99], v22 offset0:2 offset1:3
    ds_read2_b32 v[100:101], v23 offset0:0 offset1:1
    ds_read2_b32 v[102:103], v23 offset0:2 offset1:3
    ds_read_b128 v[112:115], v25 offset:0
    ds_read2_b32 v[104:105], v22 offset0:8 offset1:9
    ds_read2_b32 v[106:107], v22 offset0:10 offset1:11
    ds_read2_b32 v[108:109], v23 offset0:8 offset1:9
    ds_read2_b32 v[110:111], v23 offset0:10 offset1:11
    ds_read_b128 v[116:119], v25 offset:32
    v_subrev_u32 v22, 64, v22
    v_subrev_u32 v23, 64, v23
    v_subrev_u32 v25, 80, v25
    s_waitcnt lgkmcnt(10)
    v_mfma_f32_32x32x16_bf16 v[80:95], v[28:31], v[44:47], v[80:95]
    v_mfma_f32_32x32x16_bf16 v[80:95], v[32:35], v[44:47], v[80:95]
    v_mfma_f32_32x32x16_bf16 v[80:95], v[36:39], v[48:51], v[80:95]
    v_mfma_f32_32x32x16_bf16 v[80:95], v[40:43], v[48:51], v[80:95]
    s_add_u32 s20, s20, 2
    s_cmp_lt_u32 s20, 64
    s_cbranch_scc0 L_ss_y_86
    ds_read2_b32 v[28:29], v22 offset0:0 offset1:1
    ds_read2_b32 v[30:31], v22 offset0:2 offset1:3
    ds_read2_b32 v[32:33], v23 offset0:0 offset1:1
    ds_read2_b32 v[34:35], v23 offset0:2 offset1:3
    ds_read_b128 v[44:47], v25 offset:0
    ds_read2_b32 v[36:37], v22 offset0:8 offset1:9
    ds_read2_b32 v[38:39], v22 offset0:10 offset1:11
    ds_read2_b32 v[40:41], v23 offset0:8 offset1:9
    ds_read2_b32 v[42:43], v23 offset0:10 offset1:11
    ds_read_b128 v[48:51], v25 offset:32
    v_subrev_u32 v22, 64, v22
    v_subrev_u32 v23, 64, v23
    v_subrev_u32 v25, 80, v25
    s_waitcnt lgkmcnt(10)
    v_mfma_f32_32x32x16_bf16 v[80:95], v[96:99], v[112:115], v[80:95]
    v_mfma_f32_32x32x16_bf16 v[80:95], v[100:103], v[112:115], v[80:95]
    v_mfma_f32_32x32x16_bf16 v[80:95], v[104:107], v[116:119], v[80:95]
    v_mfma_f32_32x32x16_bf16 v[80:95], v[108:111], v[116:119], v[80:95]
    s_branch L_ss_c2_84
L_ss_y_86:
    s_waitcnt lgkmcnt(0)
    v_mfma_f32_32x32x16_bf16 v[80:95], v[96:99], v[112:115], v[80:95]
    v_mfma_f32_32x32x16_bf16 v[80:95], v[100:103], v[112:115], v[80:95]
    v_mfma_f32_32x32x16_bf16 v[80:95], v[104:107], v[116:119], v[80:95]
    v_mfma_f32_32x32x16_bf16 v[80:95], v[108:111], v[116:119], v[80:95]
    s_nop 15
    v_lshlrev_b32 v22, 8, v20
    v_lshl_add_u32 v22, v21, 5, v22
    s_lshl_b32 s20, s14, 1
    s_add_u32 s20, s20, 131072
    v_add_u32 v22, s20, v22
    v_cvt_pk_bf16_f32 v24, v64, v65
    ds_write_b16 v22, v24 offset:0
    ds_write_b16_d16_hi v22, v24 offset:8
    v_cvt_pk_bf16_f32 v24, v66, v67
    ds_write_b16 v22, v24 offset:16
    ds_write_b16_d16_hi v22, v24 offset:24
    v_cvt_pk_bf16_f32 v24, v68, v69
    ds_write_b16 v22, v24 offset:64
    ds_write_b16_d16_hi v22, v24 offset:72
    v_cvt_pk_bf16_f32 v24, v70, v71
    ds_write_b16 v22, v24 offset:80
    ds_write_b16_d16_hi v22, v24 offset:88
    v_cvt_pk_bf16_f32 v24, v72, v73
    ds_write_b16 v22, v24 offset:128
    ds_write_b16_d16_hi v22, v24 offset:136
    v_cvt_pk_bf16_f32 v24, v74, v75
    ds_write_b16 v22, v24 offset:144
    ds_write_b16_d16_hi v22, v24 offset:152
    v_cvt_pk_bf16_f32 v24, v76, v77
    ds_write_b16 v22, v24 offset:192
    ds_write_b16_d16_hi v22, v24 offset:200
    v_cvt_pk_bf16_f32 v24, v78, v79
    ds_write_b16 v22, v24 offset:208
    ds_write_b16_d16_hi v22, v24 offset:216
    v_cvt_pk_bf16_f32 v24, v80, v81
    ds_write_b16 v22, v24 offset:8192
    ds_write_b16_d16_hi v22, v24 offset:8200
    v_cvt_pk_bf16_f32 v24, v82, v83
    ds_write_b16 v22, v24 offset:8208
    ds_write_b16_d16_hi v22, v24 offset:8216
    v_cvt_pk_bf16_f32 v24, v84, v85
    ds_write_b16 v22, v24 offset:8256
    ds_write_b16_d16_hi v22, v24 offset:8264
    v_cvt_pk_bf16_f32 v24, v86, v87
    ds_write_b16 v22, v24 offset:8272
    ds_write_b16_d16_hi v22, v24 offset:8280
    v_cvt_pk_bf16_f32 v24, v88, v89
    ds_write_b16 v22, v24 offset:8320
    ds_write_b16_d16_hi v22, v24 offset:8328
    v_cvt_pk_bf16_f32 v24, v90, v91
    ds_write_b16 v22, v24 offset:8336
    ds_write_b16_d16_hi v22, v24 offset:8344
    v_cvt_pk_bf16_f32 v24, v92, v93
    ds_write_b16 v22, v24 offset:8384
    ds_write_b16_d16_hi v22, v24 offset:8392
    v_cvt_pk_bf16_f32 v24, v94, v95
    ds_write_b16 v22, v24 offset:8400
    ds_write_b16_d16_hi v22, v24 offset:8408
    s_waitcnt lgkmcnt(0)
    s_barrier
    v_lshlrev_b32 v23, 4, v0
    v_add_u32 v22, 131072, v23
    s_lshl_b32 s18, s15, 14
    s_add_u32 s18, s18, 0x5000000
    ds_read_b128 v[24:27], v22 offset:0
    ds_read_b128 v[28:31], v22 offset:4096
    ds_read_b128 v[32:35], v22 offset:8192
    ds_read_b128 v[36:39], v22 offset:12288
    s_waitcnt lgkmcnt(3)
    s_add_u32 s19, s18, 0
    buffer_store_dwordx4 v[24:27], v23, s[4:7], s19 offen sc1
    s_waitcnt lgkmcnt(2)
    s_add_u32 s19, s18, 4096
    buffer_store_dwordx4 v[28:31], v23, s[4:7], s19 offen sc1
    s_waitcnt lgkmcnt(1)
    s_add_u32 s19, s18, 8192
    buffer_store_dwordx4 v[32:35], v23, s[4:7], s19 offen sc1
    s_waitcnt lgkmcnt(0)
    s_add_u32 s19, s18, 12288
    buffer_store_dwordx4 v[36:39], v23, s[4:7], s19 offen sc1
    s_waitcnt vmcnt(0)
    s_barrier
    s_cmp_lg_u32 s14, 0
    s_cbranch_scc1 L_mg_sd_87
    s_mov_b64 exec, 1
    v_mov_b32 v20, 1
    v_mov_b32 v21, 44
    global_atomic_add v21, v20, s[12:13]
    s_mov_b64 exec, -1
L_mg_sd_87:
    s_add_u32 s91, s91, 1
    s_sub_u32 s92, s92, 1
    s_cmp_lg_u32 s92, 0
    s_cbranch_scc1 L_mg_ssm_60
L_mg_tail_61:
    s_lshr_b32 s15, s90, 5
    s_lshl_b32 s15, s15, 2
    s_lshr_b32 s15, 0x3456021, s15
    s_and_b32 s15, s15, 7
    s_lshl_b32 s15, s15, 5
    s_and_b32 s91, s90, 31
    s_add_u32 s15, s15, s91
    s_lshr_b32 s16, s15, 5
    s_and_b32 s17, s15, 31
    s_load_dwordx2 s[24:25], s[0:1], 40
    s_load_dwordx2 s[26:27], s[0:1], 0
    s_load_dwordx2 s[28:29], s[0:1], 128
    s_load_dwordx2 s[32:33], s[0:1], 120
    s_load_dwordx2 s[34:35], s[0:1], 136
    v_and_b32 v1, 63, v0
    v_and_b32 v2, 15, v1
    v_lshrrev_b32 v3, 4, v1
    s_mov_b32 s30, 0x05040100
    s_mov_b32 s31, 0x07060302
    s_waitcnt lgkmcnt(0)
    s_mov_b32 s8, s24
    s_and_b32 s9, s25, 0xffff
    s_mov_b32 s10, 0x400000
    s_mov_b32 s11, 0x00020000
    s_mov_b32 s36, s26
    s_and_b32 s37, s27, 0xffff
    s_mov_b32 s38, 0x200000
    s_mov_b32 s39, 0x00020000
    s_mov_b32 s40, s34
    s_and_b32 s41, s35, 0xffff
    s_mov_b32 s42, 0x200000
    s_mov_b32 s43, 0x00020000
    s_mov_b32 s44, s28
    s_and_b32 s45, s29, 0xffff
    s_mov_b32 s46, 0x400
    s_mov_b32 s47, 0x00020000
    s_mov_b32 s48, s32
    s_and_b32 s49, s33, 0xffff
    s_mov_b32 s50, 0x400
    s_mov_b32 s51, 0x00020000
    v_lshlrev_b32 v4, 13, v3
    v_lshl_add_u32 v4, v2, 4, v4
    s_lshl_b32 s18, s17, 17
    s_lshl_b32 s19, s14, 8
    s_add_u32 s18, s18, s19
    v_add_u32 v4, s18, v4
    s_mov_b32 s18, 0
    buffer_load_dwordx4 v[16:19], v4, s[8:11], s18 offen
    s_mov_b32 s18, 1024
    buffer_load_dwordx4 v[20:23], v4, s[8:11], s18 offen
    s_mov_b32 s18, 2048
    buffer_load_dwordx4 v[24:27], v4, s[8:11], s18 offen
    s_mov_b32 s18, 3072
    buffer_load_dwordx4 v[28:31], v4, s[8:11], s18 offen
    s_mov_b32 s18, 4096
    buffer_load_dwordx4 v[32:35], v4, s[8:11], s18 offen
    s_mov_b32 s18, 5120
    buffer_load_dwordx4 v[36:39], v4, s[8:11], s18 offen
    s_mov_b32 s18, 6144
    buffer_load_dwordx4 v[40:43], v4, s[8:11], s18 offen
    s_mov_b32 s18, 7168
    buffer_load_dwordx4 v[44:47], v4, s[8:11], s18 offen
    s_waitcnt vmcnt(0)
    v_perm_b32 v60, v20, v16, s30
    v_accvgpr_write_b32 a0, v60
    v_perm_b32 v60, v28, v24, s30
    v_accvgpr_write_b32 a1, v60
    v_perm_b32 v60, v36, v32, s30
    v_accvgpr_write_b32 a2, v60
    v_perm_b32 v60, v44, v40, s30
    v_accvgpr_write_b32 a3, v60
    v_perm_b32 v60, v20, v16, s31
    v_accvgpr_write_b32 a16, v60
    v_perm_b32 v60, v28, v24, s31
    v_accvgpr_write_b32 a17, v60
    v_perm_b32 v60, v36, v32, s31
    v_accvgpr_write_b32 a18, v60
    v_perm_b32 v60, v44, v40, s31
    v_accvgpr_write_b32 a19, v60
    v_perm_b32 v60, v21, v17, s30
    v_accvgpr_write_b32 a32, v60
    v_perm_b32 v60, v29, v25, s30
    v_accvgpr_write_b32 a33, v60
    v_perm_b32 v60, v37, v33, s30
    v_accvgpr_write_b32 a34, v60
    v_perm_b32 v60, v45, v41, s30
    v_accvgpr_write_b32 a35, v60
    v_perm_b32 v60, v21, v17, s31
    v_accvgpr_write_b32 a48, v60
    v_perm_b32 v60, v29, v25, s31
    v_accvgpr_write_b32 a49, v60
    v_perm_b32 v60, v37, v33, s31
    v_accvgpr_write_b32 a50, v60
    v_perm_b32 v60, v45, v41, s31
    v_accvgpr_write_b32 a51, v60
    v_perm_b32 v60, v22, v18, s30
    v_accvgpr_write_b32 a64, v60
    v_perm_b32 v60, v30, v26, s30
    v_accvgpr_write_b32 a65, v60
    v_perm_b32 v60, v38, v34, s30
    v_accvgpr_write_b32 a66, v60
    v_perm_b32 v60, v46, v42, s30
    v_accvgpr_write_b32 a67, v60
    v_perm_b32 v60, v22, v18, s31
    v_accvgpr_write_b32 a80, v60
    v_perm_b32 v60, v30, v26, s31
    v_accvgpr_write_b32 a81, v60
    v_perm_b32 v60, v38, v34, s31
    v_accvgpr_write_b32 a82, v60
    v_perm_b32 v60, v46, v42, s31
    v_accvgpr_write_b32 a83, v60
    v_perm_b32 v60, v23, v19, s30
    v_accvgpr_write_b32 a96, v60
    v_perm_b32 v60, v31, v27, s30
    v_accvgpr_write_b32 a97, v60
    v_perm_b32 v60, v39, v35, s30
    v_accvgpr_write_b32 a98, v60
    v_perm_b32 v60, v47, v43, s30
    v_accvgpr_write_b32 a99, v60
    v_perm_b32 v60, v23, v19, s31
    v_accvgpr_write_b32 a112, v60
    v_perm_b32 v60, v31, v27, s31
    v_accvgpr_write_b32 a113, v60
    v_perm_b32 v60, v39, v35, s31
    v_accvgpr_write_b32 a114, v60
    v_perm_b32 v60, v47, v43, s31
    v_accvgpr_write_b32 a115, v60
    s_mov_b32 s18, 32768
    buffer_load_dwordx4 v[16:19], v4, s[8:11], s18 offen
    s_mov_b32 s18, 33792
    buffer_load_dwordx4 v[20:23], v4, s[8:11], s18 offen
    s_mov_b32 s18, 34816
    buffer_load_dwordx4 v[24:27], v4, s[8:11], s18 offen
    s_mov_b32 s18, 35840
    buffer_load_dwordx4 v[28:31], v4, s[8:11], s18 offen
    s_mov_b32 s18, 36864
    buffer_load_dwordx4 v[32:35], v4, s[8:11], s18 offen
    s_mov_b32 s18, 37888
    buffer_load_dwordx4 v[36:39], v4, s[8:11], s18 offen
    s_mov_b32 s18, 38912
    buffer_load_dwordx4 v[40:43], v4, s[8:11], s18 offen
    s_mov_b32 s18, 39936
    buffer_load_dwordx4 v[44:47], v4, s[8:11], s18 offen
    s_waitcnt vmcnt(0)
    v_perm_b32 v60, v20, v16, s30
    v_accvgpr_write_b32 a4, v60
    v_perm_b32 v60, v28, v24, s30
    v_accvgpr_write_b32 a5, v60
    v_perm_b32 v60, v36, v32, s30
    v_accvgpr_write_b32 a6, v60
    v_perm_b32 v60, v44, v40, s30
    v_accvgpr_write_b32 a7, v60
    v_perm_b32 v60, v20, v16, s31
    v_accvgpr_write_b32 a20, v60
    v_perm_b32 v60, v28, v24, s31
    v_accvgpr_write_b32 a21, v60
    v_perm_b32 v60, v36, v32, s31
    v_accvgpr_write_b32 a22, v60
    v_perm_b32 v60, v44, v40, s31
    v_accvgpr_write_b32 a23, v60
    v_perm_b32 v60, v21, v17, s30
    v_accvgpr_write_b32 a36, v60
    v_perm_b32 v60, v29, v25, s30
    v_accvgpr_write_b32 a37, v60
    v_perm_b32 v60, v37, v33, s30
    v_accvgpr_write_b32 a38, v60
    v_perm_b32 v60, v45, v41, s30
    v_accvgpr_write_b32 a39, v60
    v_perm_b32 v60, v21, v17, s31
    v_accvgpr_write_b32 a52, v60
    v_perm_b32 v60, v29, v25, s31
    v_accvgpr_write_b32 a53, v60
    v_perm_b32 v60, v37, v33, s31
    v_accvgpr_write_b32 a54, v60
    v_perm_b32 v60, v45, v41, s31
    v_accvgpr_write_b32 a55, v60
    v_perm_b32 v60, v22, v18, s30
    v_accvgpr_write_b32 a68, v60
    v_perm_b32 v60, v30, v26, s30
    v_accvgpr_write_b32 a69, v60
    v_perm_b32 v60, v38, v34, s30
    v_accvgpr_write_b32 a70, v60
    v_perm_b32 v60, v46, v42, s30
    v_accvgpr_write_b32 a71, v60
    v_perm_b32 v60, v22, v18, s31
    v_accvgpr_write_b32 a84, v60
    v_perm_b32 v60, v30, v26, s31
    v_accvgpr_write_b32 a85, v60
    v_perm_b32 v60, v38, v34, s31
    v_accvgpr_write_b32 a86, v60
    v_perm_b32 v60, v46, v42, s31
    v_accvgpr_write_b32 a87, v60
    v_perm_b32 v60, v23, v19, s30
    v_accvgpr_write_b32 a100, v60
    v_perm_b32 v60, v31, v27, s30
    v_accvgpr_write_b32 a101, v60
    v_perm_b32 v60, v39, v35, s30
    v_accvgpr_write_b32 a102, v60
    v_perm_b32 v60, v47, v43, s30
    v_accvgpr_write_b32 a103, v60
    v_perm_b32 v60, v23, v19, s31
    v_accvgpr_write_b32 a116, v60
    v_perm_b32 v60, v31, v27, s31
    v_accvgpr_write_b32 a117, v60
    v_perm_b32 v60, v39, v35, s31
    v_accvgpr_write_b32 a118, v60
    v_perm_b32 v60, v47, v43, s31
    v_accvgpr_write_b32 a119, v60
    s_mov_b32 s18, 65536
    buffer_load_dwordx4 v[16:19], v4, s[8:11], s18 offen
    s_mov_b32 s18, 66560
    buffer_load_dwordx4 v[20:23], v4, s[8:11], s18 offen
    s_mov_b32 s18, 67584
    buffer_load_dwordx4 v[24:27], v4, s[8:11], s18 offen
    s_mov_b32 s18, 68608
    buffer_load_dwordx4 v[28:31], v4, s[8:11], s18 offen
    s_mov_b32 s18, 69632
    buffer_load_dwordx4 v[32:35], v4, s[8:11], s18 offen
    s_mov_b32 s18, 70656
    buffer_load_dwordx4 v[36:39], v4, s[8:11], s18 offen
    s_mov_b32 s18, 71680
    buffer_load_dwordx4 v[40:43], v4, s[8:11], s18 offen
    s_mov_b32 s18, 72704
    buffer_load_dwordx4 v[44:47], v4, s[8:11], s18 offen
    s_waitcnt vmcnt(0)
    v_perm_b32 v60, v20, v16, s30
    v_accvgpr_write_b32 a8, v60
    v_perm_b32 v60, v28, v24, s30
    v_accvgpr_write_b32 a9, v60
    v_perm_b32 v60, v36, v32, s30
    v_accvgpr_write_b32 a10, v60
    v_perm_b32 v60, v44, v40, s30
    v_accvgpr_write_b32 a11, v60
    v_perm_b32 v60, v20, v16, s31
    v_accvgpr_write_b32 a24, v60
    v_perm_b32 v60, v28, v24, s31
    v_accvgpr_write_b32 a25, v60
    v_perm_b32 v60, v36, v32, s31
    v_accvgpr_write_b32 a26, v60
    v_perm_b32 v60, v44, v40, s31
    v_accvgpr_write_b32 a27, v60
    v_perm_b32 v60, v21, v17, s30
    v_accvgpr_write_b32 a40, v60
    v_perm_b32 v60, v29, v25, s30
    v_accvgpr_write_b32 a41, v60
    v_perm_b32 v60, v37, v33, s30
    v_accvgpr_write_b32 a42, v60
    v_perm_b32 v60, v45, v41, s30
    v_accvgpr_write_b32 a43, v60
    v_perm_b32 v60, v21, v17, s31
    v_accvgpr_write_b32 a56, v60
    v_perm_b32 v60, v29, v25, s31
    v_accvgpr_write_b32 a57, v60
    v_perm_b32 v60, v37, v33, s31
    v_accvgpr_write_b32 a58, v60
    v_perm_b32 v60, v45, v41, s31
    v_accvgpr_write_b32 a59, v60
    v_perm_b32 v60, v22, v18, s30
    v_accvgpr_write_b32 a72, v60
    v_perm_b32 v60, v30, v26, s30
    v_accvgpr_write_b32 a73, v60
    v_perm_b32 v60, v38, v34, s30
    v_accvgpr_write_b32 a74, v60
    v_perm_b32 v60, v46, v42, s30
    v_accvgpr_write_b32 a75, v60
    v_perm_b32 v60, v22, v18, s31
    v_accvgpr_write_b32 a88, v60
    v_perm_b32 v60, v30, v26, s31
    v_accvgpr_write_b32 a89, v60
    v_perm_b32 v60, v38, v34, s31
    v_accvgpr_write_b32 a90, v60
    v_perm_b32 v60, v46, v42, s31
    v_accvgpr_write_b32 a91, v60
    v_perm_b32 v60, v23, v19, s30
    v_accvgpr_write_b32 a104, v60
    v_perm_b32 v60, v31, v27, s30
    v_accvgpr_write_b32 a105, v60
    v_perm_b32 v60, v39, v35, s30
    v_accvgpr_write_b32 a106, v60
    v_perm_b32 v60, v47, v43, s30
    v_accvgpr_write_b32 a107, v60
    v_perm_b32 v60, v23, v19, s31
    v_accvgpr_write_b32 a120, v60
    v_perm_b32 v60, v31, v27, s31
    v_accvgpr_write_b32 a121, v60
    v_perm_b32 v60, v39, v35, s31
    v_accvgpr_write_b32 a122, v60
    v_perm_b32 v60, v47, v43, s31
    v_accvgpr_write_b32 a123, v60
    s_mov_b32 s18, 98304
    buffer_load_dwordx4 v[16:19], v4, s[8:11], s18 offen
    s_mov_b32 s18, 99328
    buffer_load_dwordx4 v[20:23], v4, s[8:11], s18 offen
    s_mov_b32 s18, 100352
    buffer_load_dwordx4 v[24:27], v4, s[8:11], s18 offen
    s_mov_b32 s18, 101376
    buffer_load_dwordx4 v[28:31], v4, s[8:11], s18 offen
    s_mov_b32 s18, 102400
    buffer_load_dwordx4 v[32:35], v4, s[8:11], s18 offen
    s_mov_b32 s18, 103424
    buffer_load_dwordx4 v[36:39], v4, s[8:11], s18 offen
    s_mov_b32 s18, 104448
    buffer_load_dwordx4 v[40:43], v4, s[8:11], s18 offen
    s_mov_b32 s18, 105472
    buffer_load_dwordx4 v[44:47], v4, s[8:11], s18 offen
    s_waitcnt vmcnt(0)
    v_perm_b32 v60, v20, v16, s30
    v_accvgpr_write_b32 a12, v60
    v_perm_b32 v60, v28, v24, s30
    v_accvgpr_write_b32 a13, v60
    v_perm_b32 v60, v36, v32, s30
    v_accvgpr_write_b32 a14, v60
    v_perm_b32 v60, v44, v40, s30
    v_accvgpr_write_b32 a15, v60
    v_perm_b32 v60, v20, v16, s31
    v_accvgpr_write_b32 a28, v60
    v_perm_b32 v60, v28, v24, s31
    v_accvgpr_write_b32 a29, v60
    v_perm_b32 v60, v36, v32, s31
    v_accvgpr_write_b32 a30, v60
    v_perm_b32 v60, v44, v40, s31
    v_accvgpr_write_b32 a31, v60
    v_perm_b32 v60, v21, v17, s30
    v_accvgpr_write_b32 a44, v60
    v_perm_b32 v60, v29, v25, s30
    v_accvgpr_write_b32 a45, v60
    v_perm_b32 v60, v37, v33, s30
    v_accvgpr_write_b32 a46, v60
    v_perm_b32 v60, v45, v41, s30
    v_accvgpr_write_b32 a47, v60
    v_perm_b32 v60, v21, v17, s31
    v_accvgpr_write_b32 a60, v60
    v_perm_b32 v60, v29, v25, s31
    v_accvgpr_write_b32 a61, v60
    v_perm_b32 v60, v37, v33, s31
    v_accvgpr_write_b32 a62, v60
    v_perm_b32 v60, v45, v41, s31
    v_accvgpr_write_b32 a63, v60
    v_perm_b32 v60, v22, v18, s30
    v_accvgpr_write_b32 a76, v60
    v_perm_b32 v60, v30, v26, s30
    v_accvgpr_write_b32 a77, v60
    v_perm_b32 v60, v38, v34, s30
    v_accvgpr_write_b32 a78, v60
    v_perm_b32 v60, v46, v42, s30
    v_accvgpr_write_b32 a79, v60
    v_perm_b32 v60, v22, v18, s31
    v_accvgpr_write_b32 a92, v60
    v_perm_b32 v60, v30, v26, s31
    v_accvgpr_write_b32 a93, v60
    v_perm_b32 v60, v38, v34, s31
    v_accvgpr_write_b32 a94, v60
    v_perm_b32 v60, v46, v42, s31
    v_accvgpr_write_b32 a95, v60
    v_perm_b32 v60, v23, v19, s30
    v_accvgpr_write_b32 a108, v60
    v_perm_b32 v60, v31, v27, s30
    v_accvgpr_write_b32 a109, v60
    v_perm_b32 v60, v39, v35, s30
    v_accvgpr_write_b32 a110, v60
    v_perm_b32 v60, v47, v43, s30
    v_accvgpr_write_b32 a111, v60
    v_perm_b32 v60, v23, v19, s31
    v_accvgpr_write_b32 a124, v60
    v_perm_b32 v60, v31, v27, s31
    v_accvgpr_write_b32 a125, v60
    v_perm_b32 v60, v39, v35, s31
    v_accvgpr_write_b32 a126, v60
    v_perm_b32 v60, v47, v43, s31
    v_accvgpr_write_b32 a127, v60
    s_and_b32 s18, s14, 1
    s_lshl_b32 s18, s18, 2
    v_add_u32 v4, s18, v3
    v_lshlrev_b32 v4, 1, v4
    v_xor_b32 v4, v4, v2
    v_lshlrev_b32 v4, 4, v4
    v_lshl_add_u32 v4, v3, 8, v4
    s_lshl_b32 s18, s17, 19
    s_lshl_b32 s19, s14, 11
    s_add_u32 s18, s18, s19
    v_add_u32 v4, s18, v4
    v_and_b32 v5, 3, v2
    v_lshrrev_b32 v6, 3, v2
    v_lshl_add_u32 v5, v6, 2, v5
    v_lshlrev_b32 v5, 1, v5
    v_xor_b32 v5, v5, v3
    v_lshlrev_b32 v5, 4, v5
    v_lshl_add_u32 v5, v2, 8, v5
    v_lshlrev_b32 v6, 7, v2
    v_lshl_add_u32 v6, v3, 4, v6
    s_lshl_b32 s18, s17, 13
    s_lshr_b32 s19, s14, 1
    s_lshl_b32 s20, s19, 12
    s_add_u32 s18, s18, s20
    s_add_u32 s18, s18, 0x2000000
    v_add_u32 v6, s18, v6
    v_and_b32 v7, 7, v2
    v_lshlrev_b32 v7, 8, v7
    v_lshl_add_u32 v7, v3, 4, v7
    s_lshl_b32 s18, s17, 11
    s_add_u32 s18, s18, 0x3000000
    v_add_u32 v7, s18, v7
    v_and_b32 v8, 1, v3
    v_lshlrev_b32 v8, 3, v8
    v_lshl_add_u32 v8, v2, 5, v8
    s_lshl_b32 s18, s17, 11
    s_lshl_b32 s20, s19, 10
    s_add_u32 s18, s18, s20
    s_add_u32 s18, s18, 0x3400000
    v_add_u32 v8, s18, v8
    s_and_b32 s20, s14, 1
    s_lshl_b32 s20, s20, 4
    v_add_u32 v9, s20, v2
    v_mul_u32_u24 v9, 272, v9
    v_lshl_add_u32 v9, v3, 4, v9
    s_lshl_b32 s18, s19, 7
    s_add_u32 s18, s18, 32768
    v_add_u32 v9, s18, v9
    v_mul_u32_u24 v10, 272, v2
    v_lshl_add_u32 v10, v3, 4, v10
    v_add_u32 v10, 32768, v10
    v_lshlrev_b32 v11, 17, v3
    v_lshl_add_u32 v11, v2, 4, v11
    s_lshl_b32 s18, s14, 13
    s_lshl_b32 s20, s17, 8
    s_add_u32 s18, s18, s20
    s_add_u32 s18, s18, 0x6000000
    v_add_u32 v11, s18, v11
    s_and_b32 s20, s14, 1
    s_lshl_b32 s20, s20, 4
    v_add_u32 v12, s20, v2
    v_lshlrev_b32 v13, 2, v3
    v_sub_u32 v12, v12, v13
    v_lshlrev_b32 v13, 4, v1
    v_and_b32 v14, 1, v2
    v_lshlrev_b32 v14, 4, v14
    v_mov_b32 v15, 0x3f80
    v_lshlrev_b32 v14, v14, v15
    s_mov_b32 s52, 0x3e02939f
    s_mov_b32 s53, 0xff800000
    s_lshl_b32 s54, s14, 11
    s_and_b32 s55, s14, 1
    s_lshl_b32 s55, s55, 12
    s_sub_u32 s56, 7, s16
    s_cmp_eq_u32 s16, 0
    s_cselect_b32 s56, 0, s56
    s_add_u32 s57, s16, 28
    s_sub_u32 s58, s16, 1
    s_cmp_lt_u32 s58, 3
    s_cselect_b32 s56, s57, s56
    s_mov_b32 s57, 0
    s_mov_b32 s93, 0
    s_cmp_lg_u32 s14, 0
    s_cbranch_scc1 L_tl_wo_89
    v_mov_b32 v56, 56
L_tl_w_88:
    global_load_dword v57, v56, s[12:13] sc1
    s_waitcnt vmcnt(0)
    v_cmp_gt_u32 vcc, 32, v57
    s_add_u32 s93, s93, 1
    s_cmp_lt_u32 s93, 0x80000
    s_cselect_b64 vcc, vcc, 0
    s_cbranch_vccz L_tl_wo_89
    s_sleep 12
    s_branch L_tl_w_88
L_tl_wo_89:
    s_waitcnt vmcnt(0)
    s_barrier
    s_cmp_lg_u32 s14, 0
    s_cbranch_scc1 L_tl_wo_91
    v_min_u32 v56, 5, v1
    s_lshl_b32 s63, s17, 7
    s_add_u32 s63, s63, 0x5810000
L_tl_w_90:
    buffer_load_ubyte v57, v56, s[4:7], s63 offen sc1
    s_waitcnt vmcnt(0)
    v_cmp_ne_u32 vcc, 32, v57
    s_add_u32 s93, s93, 1
    s_cmp_lt_u32 s93, 0x80000
    s_cselect_b64 vcc, vcc, 0
    s_cbranch_vccz L_tl_wo_91
    s_sleep 12
    s_branch L_tl_w_90
L_tl_wo_91:
    s_waitcnt vmcnt(0)
    s_barrier
    v_and_b32 v15, 1, v3
    v_lshlrev_b32 v15, 3, v15
    v_lshl_add_u32 v15, v2, 4, v15
    s_lshl_b32 s66, s14, 8
    v_add_u32 v15, s66, v15
    s_add_u32 s62, s16, 56
    s_cmp_eq_u32 s16, 0
    s_cselect_b32 s62, 63, s62
    s_lshl_b32 s62, s62, 20
    v_mov_b32 v16, -1
    v_mov_b32 v17, -1
    v_mov_b32 v18, -1
    v_mov_b32 v19, -1
    s_add_u32 s63, s62, 0
    buffer_store_dwordx4 v[16:19], v11, s[4:7], s63 offen sc1
    s_add_u32 s63, s62, 32768
    buffer_store_dwordx4 v[16:19], v11, s[4:7], s63 offen sc1
    s_add_u32 s63, s62, 65536
    buffer_store_dwordx4 v[16:19], v11, s[4:7], s63 offen sc1
    s_add_u32 s63, s62, 98304
    buffer_store_dwordx4 v[16:19], v11, s[4:7], s63 offen sc1
    s_add_u32 s63, s62, 524288
    buffer_store_dwordx4 v[16:19], v11, s[4:7], s63 offen sc1
    s_add_u32 s63, s62, 557056
    buffer_store_dwordx4 v[16:19], v11, s[4:7], s63 offen sc1
    s_add_u32 s63, s62, 589824
    buffer_store_dwordx4 v[16:19], v11, s[4:7], s63 offen sc1
    s_add_u32 s63, s62, 622592
    buffer_store_dwordx4 v[16:19], v11, s[4:7], s63 offen sc1
    s_lshl_b32 s58, s56, 13
    s_add_u32 s59, s58, 0x1000000
    s_add_u32 m0, s54, 0
    s_lshl_b32 s60, s56, 18
    buffer_load_dwordx4 v4, s[4:7], s59 offen lds
    buffer_load_dwordx4 v4, s[4:7], s59 offen offset:1024 lds
    s_add_u32 m0, s54, 8192
    s_nop 0
    buffer_load_dwordx4 v4, s[4:7], s58 offen lds
    buffer_load_dwordx4 v4, s[4:7], s58 offen offset:1024 lds
    s_mov_b32 s68, 0
    s_mov_b32 s69, s56
    s_mov_b32 s70, 0
    s_mov_b32 s71, 0
L_tl_loop_92:
    s_add_u32 s72, s56, 1
    s_sub_u32 s63, s56, 1
    s_cmp_ge_u32 s56, 60
    s_cselect_b32 s72, s63, s72
    s_cmp_ge_u32 s70, s72
    s_cbranch_scc1 L_tl_go_95
    s_cmp_lg_u32 s14, 0
    s_cbranch_scc1 L_tl_rf_97
    s_lshl_b32 s63, s17, 7
    s_add_u32 s63, s63, 0x5810000
    v_mov_b32 v56, 8
    buffer_load_ubyte v58, v56, s[4:7], s63 offen sc1
    v_mov_b32 v56, 44
    s_cmp_lg_u32 s71, 0
    s_cbranch_scc1 L_tl_rf_97_s
    global_load_dword v59, v56, s[12:13] sc1
L_tl_rf_97_s:
    v_mov_b32 v56, 41472
    s_waitcnt vmcnt(0)
    ds_write_b64 v56, v[58:59]
    s_waitcnt lgkmcnt(0)
L_tl_rf_97:
    s_waitcnt vmcnt(0)
    s_barrier
    v_mov_b32 v56, 41472
    ds_read_b64 v[58:59], v56
    s_waitcnt lgkmcnt(0)
    v_readfirstlane_b32 s70, v58
    v_readfirstlane_b32 s63, v59
    s_cmp_ge_u32 s63, 128
    s_cselect_b32 s71, 1, s71
    s_barrier
    s_cmp_ge_u32 s70, s72
    s_cbranch_scc1 L_tl_go_95
L_tl_dr_98:
    s_cmp_ge_u32 s68, s57
    s_cbranch_scc1 L_tl_dro_99
    s_cmp_lg_u32 s71, 0
    s_cbranch_scc1 L_tl_drs_100
    s_cmp_lg_u32 s14, 0
    s_cbranch_scc1 L_tl_wo_102
    v_mov_b32 v56, 44
L_tl_w_101:
    global_load_dword v57, v56, s[12:13] sc1
    s_waitcnt vmcnt(0)
    v_cmp_gt_u32 vcc, 128, v57
    s_add_u32 s93, s93, 1
    s_cmp_lt_u32 s93, 0x80000
    s_cselect_b64 vcc, vcc, 0
    s_cbranch_vccz L_tl_wo_102
    s_sleep 12
    s_branch L_tl_w_101
L_tl_wo_102:
    s_waitcnt vmcnt(0)
    s_barrier
    s_mov_b32 s71, 1
L_tl_drs_100:
    s_add_u32 s68, s68, 1
    s_cmp_lg_u32 s14, 0
    s_cbranch_scc1 L_tl_wo_104
    s_lshl_b32 s63, s16, 5
    v_and_b32 v56, 31, v1
    v_add_u32 v56, s63, v56
    s_mov_b32 s63, 0x5800000
L_tl_w_103:
    buffer_load_ubyte v57, v56, s[4:7], s63 offen sc1
    s_waitcnt vmcnt(0)
    v_cmp_gt_u32 vcc, s68, v57
    s_add_u32 s93, s93, 1
    s_cmp_lt_u32 s93, 0x80000
    s_cselect_b64 vcc, vcc, 0
    s_cbranch_vccz L_tl_wo_104
    s_sleep 12
    s_branch L_tl_w_103
L_tl_wo_104:
    s_waitcnt vmcnt(0)
    s_barrier
    s_lshl_b32 s63, s17, 15
    s_lshl_b32 s64, s69, 20
    s_add_u32 s63, s63, s64
    s_lshl_b32 s64, s14, 13
    s_add_u32 s63, s63, s64
    s_add_u32 s63, s63, 0x6000000
    s_add_u32 s64, s63, 4096
    buffer_load_dwordx4 v[64:67], v13, s[4:7], s63 offen offset:0 sc1
    buffer_load_dwordx4 v[68:71], v13, s[4:7], s63 offen offset:1024 sc1
    buffer_load_dwordx4 v[72:75], v13, s[4:7], s63 offen offset:2048 sc1
    buffer_load_dwordx4 v[76:79], v13, s[4:7], s63 offen offset:3072 sc1
    buffer_load_dwordx4 v[80:83], v13, s[4:7], s64 offen offset:0 sc1
    buffer_load_dwordx4 v[84:87], v13, s[4:7], s64 offen offset:1024 sc1
    buffer_load_dwordx4 v[88:91], v13, s[4:7], s64 offen offset:2048 sc1
    buffer_load_dwordx4 v[92:95], v13, s[4:7], s64 offen offset:3072 sc1
    s_lshl_b32 s65, s69, 5
    s_add_u32 s65, s65, s17
    s_lshl_b32 s65, s65, 10
    buffer_load_dwordx4 v[40:43], v13, s[36:39], s65 offen
    buffer_load_dwordx4 v[44:47], v13, s[44:47], 0 offen
    buffer_load_dwordx2 v[48:49], v15, s[36:39], s65 offen
    s_lshr_b32 s66, s65, 7
    s_add_u32 s66, s66, 0x5000000
    v_lshlrev_b32 v56, 11, v15
    buffer_load_dwordx2 v[50:51], v56, s[4:7], s66 offen sc1
    buffer_load_dwordx2 v[52:53], v15, s[48:51], 0 offen
    s_waitcnt vmcnt(0)
    v_lshrrev_b32 v57, 1, v2
    v_cmp_eq_u32 vcc, 0, v57
    s_nop 1
    v_cndmask_b32 v16, 0, v14, vcc
    v_cmp_eq_u32 vcc, 1, v57
    s_nop 1
    v_cndmask_b32 v17, 0, v14, vcc
    v_cmp_eq_u32 vcc, 2, v57
    s_nop 1
    v_cndmask_b32 v18, 0, v14, vcc
    v_cmp_eq_u32 vcc, 3, v57
    s_nop 1
    v_cndmask_b32 v19, 0, v14, vcc
    s_nop 1
    v_mfma_f32_16x16x32_bf16 v[20:23], v[16:19], v[64:67], 0
    v_mfma_f32_16x16x32_bf16 v[20:23], v[16:19], v[68:71], v[20:23]
    v_mfma_f32_16x16x32_bf16 v[20:23], v[16:19], v[72:75], v[20:23]
    v_mfma_f32_16x16x32_bf16 v[20:23], v[16:19], v[76:79], v[20:23]
    v_mfma_f32_16x16x32_bf16 v[20:23], v[16:19], v[80:83], v[20:23]
    v_mfma_f32_16x16x32_bf16 v[20:23], v[16:19], v[84:87], v[20:23]
    v_mfma_f32_16x16x32_bf16 v[20:23], v[16:19], v[88:91], v[20:23]
    v_mfma_f32_16x16x32_bf16 v[20:23], v[16:19], v[92:95], v[20:23]
    v_lshlrev_b32 v24, 16, v40
    v_and_b32 v25, 0xffff0000, v40
    v_lshlrev_b32 v26, 16, v44
    v_and_b32 v27, 0xffff0000, v44
    v_mul_f32 v24, v24, v26
    v_mul_f32 v25, v25, v27
    v_cvt_pk_bf16_f32 v24, v24, v25
    v_lshlrev_b32 v25, 16, v24
    v_and_b32 v24, 0xffff0000, v24
    v_add_f32 v24, v24, v25
    v_mov_b32 v28, v24
    v_lshlrev_b32 v24, 16, v41
    v_and_b32 v25, 0xffff0000, v41
    v_lshlrev_b32 v26, 16, v45
    v_and_b32 v27, 0xffff0000, v45
    v_mul_f32 v24, v24, v26
    v_mul_f32 v25, v25, v27
    v_cvt_pk_bf16_f32 v24, v24, v25
    v_lshlrev_b32 v25, 16, v24
    v_and_b32 v24, 0xffff0000, v24
    v_add_f32 v24, v24, v25
    v_add_f32 v28, v28, v24
    v_lshlrev_b32 v24, 16, v42
    v_and_b32 v25, 0xffff0000, v42
    v_lshlrev_b32 v26, 16, v46
    v_and_b32 v27, 0xffff0000, v46
    v_mul_f32 v24, v24, v26
    v_mul_f32 v25, v25, v27
    v_cvt_pk_bf16_f32 v24, v24, v25
    v_lshlrev_b32 v25, 16, v24
    v_and_b32 v24, 0xffff0000, v24
    v_add_f32 v24, v24, v25
    v_add_f32 v28, v28, v24
    v_lshlrev_b32 v24, 16, v43
    v_and_b32 v25, 0xffff0000, v43
    v_lshlrev_b32 v26, 16, v47
    v_and_b32 v27, 0xffff0000, v47
    v_mul_f32 v24, v24, v26
    v_mul_f32 v25, v25, v27
    v_cvt_pk_bf16_f32 v24, v24, v25
    v_lshlrev_b32 v25, 16, v24
    v_and_b32 v24, 0xffff0000, v24
    v_add_f32 v24, v24, v25
    v_add_f32 v28, v28, v24
    s_nop 1
    v_add_f32_dpp v28, v28, v28 quad_perm:[1,0,3,2] row_mask:0xf bank_mask:0xf
    s_nop 1
    v_add_f32_dpp v28, v28, v28 quad_perm:[2,3,0,1] row_mask:0xf bank_mask:0xf
    s_nop 1
    v_add_f32_dpp v28, v28, v28 row_ror:4 row_mask:0xf bank_mask:0xf
    s_nop 1
    v_add_f32_dpp v28, v28, v28 row_ror:8 row_mask:0xf bank_mask:0xf
    v_mov_b32 v24, v28
    s_nop 1
    v_permlane32_swap_b32 v24, v28
    v_add_f32 v28, v28, v24
    v_mov_b32 v24, v28
    s_nop 1
    v_permlane16_swap_b32 v24, v28
    v_add_f32 v28, v28, v24
    v_cvt_pk_bf16_f32 v28, v28, v28
    v_lshlrev_b32 v28, 16, v28
    v_mul_f32 v28, 0xbfb8aa3b, v28
    v_exp_f32 v28, v28
    s_nop 0
    v_add_f32 v28, 1.0, v28
    v_rcp_f32 v28, v28
    s_nop 0
    v_cvt_pk_bf16_f32 v28, v28, v28
    v_lshlrev_b32 v28, 16, v28
    v_sub_f32 v29, 1.0, v28
    v_cvt_pk_bf16_f32 v29, v29, v29
    v_lshlrev_b32 v29, 16, v29
    v_cvt_pk_bf16_f32 v24, v20, v21
    v_lshlrev_b32 v25, 16, v24
    v_and_b32 v24, 0xffff0000, v24
    v_mul_f32 v25, v28, v25
    v_mul_f32 v24, v28, v24
    v_cvt_pk_bf16_f32 v20, v25, v24
    v_lshlrev_b32 v24, 16, v48
    v_and_b32 v25, 0xffff0000, v48
    v_lshlrev_b32 v26, 16, v52
    v_and_b32 v27, 0xffff0000, v52
    v_mul_f32 v24, v24, v26
    v_mul_f32 v25, v25, v27
    v_cvt_pk_bf16_f32 v24, v24, v25
    v_lshlrev_b32 v25, 16, v24
    v_and_b32 v24, 0xffff0000, v24
    v_lshlrev_b32 v26, 16, v50
    v_and_b32 v27, 0xffff0000, v50
    v_add_f32 v25, v25, v26
    v_add_f32 v24, v24, v27
    v_cvt_pk_bf16_f32 v24, v25, v24
    v_lshlrev_b32 v25, 16, v24
    v_and_b32 v24, 0xffff0000, v24
    v_mul_f32 v25, v29, v25
    v_mul_f32 v24, v29, v24
    v_cvt_pk_bf16_f32 v24, v25, v24
    v_lshlrev_b32 v25, 16, v24
    v_and_b32 v24, 0xffff0000, v24
    v_lshlrev_b32 v26, 16, v20
    v_and_b32 v27, 0xffff0000, v20
    v_add_f32 v25, v25, v26
    v_add_f32 v24, v24, v27
    v_cvt_pk_bf16_f32 v40, v25, v24
    v_cvt_pk_bf16_f32 v24, v22, v23
    v_lshlrev_b32 v25, 16, v24
    v_and_b32 v24, 0xffff0000, v24
    v_mul_f32 v25, v28, v25
    v_mul_f32 v24, v28, v24
    v_cvt_pk_bf16_f32 v22, v25, v24
    v_lshlrev_b32 v24, 16, v49
    v_and_b32 v25, 0xffff0000, v49
    v_lshlrev_b32 v26, 16, v53
    v_and_b32 v27, 0xffff0000, v53
    v_mul_f32 v24, v24, v26
    v_mul_f32 v25, v25, v27
    v_cvt_pk_bf16_f32 v24, v24, v25
    v_lshlrev_b32 v25, 16, v24
    v_and_b32 v24, 0xffff0000, v24
    v_lshlrev_b32 v26, 16, v51
    v_and_b32 v27, 0xffff0000, v51
    v_add_f32 v25, v25, v26
    v_add_f32 v24, v24, v27
    v_cvt_pk_bf16_f32 v24, v25, v24
    v_lshlrev_b32 v25, 16, v24
    v_and_b32 v24, 0xffff0000, v24
    v_mul_f32 v25, v29, v25
    v_mul_f32 v24, v29, v24
    v_cvt_pk_bf16_f32 v24, v25, v24
    v_lshlrev_b32 v25, 16, v24
    v_and_b32 v24, 0xffff0000, v24
    v_lshlrev_b32 v26, 16, v22
    v_and_b32 v27, 0xffff0000, v22
    v_add_f32 v25, v25, v26
    v_add_f32 v24, v24, v27
    v_cvt_pk_bf16_f32 v41, v25, v24
    s_mov_b32 exec_hi, 0
    buffer_store_dwordx2 v[40:41], v15, s[40:43], s65 offen
    s_mov_b32 exec_hi, -1
    s_add_u32 s74, s16, 28
    s_cmp_lt_u32 s69, 24
    s_cselect_b32 s75, 4, 7
    s_add_u32 s75, s69, s75
    s_sub_u32 s76, s69, 24
    s_cmp_lt_u32 s76, 4
    s_cselect_b32 s69, s74, s75
    s_branch L_tl_dr_98
L_tl_dro_99:
L_tl_sp_96:
    s_cmp_lg_u32 s14, 0
    s_cbranch_scc1 L_tl_rf_105
    s_lshl_b32 s63, s17, 7
    s_add_u32 s63, s63, 0x5810000
    v_mov_b32 v56, 8
    buffer_load_ubyte v58, v56, s[4:7], s63 offen sc1
    v_mov_b32 v56, 44
    s_cmp_lg_u32 s71, 0
    s_cbranch_scc1 L_tl_rf_105_s
    global_load_dword v59, v56, s[12:13] sc1
L_tl_rf_105_s:
    v_mov_b32 v56, 41472
    s_waitcnt vmcnt(0)
    ds_write_b64 v56, v[58:59]
    s_waitcnt lgkmcnt(0)
L_tl_rf_105:
    s_waitcnt vmcnt(0)
    s_barrier
    v_mov_b32 v56, 41472
    ds_read_b64 v[58:59], v56
    s_waitcnt lgkmcnt(0)
    v_readfirstlane_b32 s70, v58
    v_readfirstlane_b32 s63, v59
    s_cmp_ge_u32 s63, 128
    s_cselect_b32 s71, 1, s71
    s_barrier
    s_cmp_ge_u32 s70, s72
    s_cbranch_scc1 L_tl_go_95
    s_add_u32 s93, s93, 1
    s_cmp_ge_u32 s93, 0x80000
    s_cbranch_scc1 L_tl_go_95
    s_sleep 12
    s_branch L_tl_sp_96
L_tl_go_95:
    s_lshl_b32 s61, s56, 16
    s_lshl_b32 s60, s56, 18
    buffer_load_dwordx4 v[40:43], v6, s[4:7], s60 offen offset:0
    buffer_load_dwordx4 v[44:47], v6, s[4:7], s60 offen offset:64
    buffer_load_dwordx4 v[48:51], v6, s[4:7], s60 offen offset:2048
    buffer_load_dwordx4 v[52:55], v6, s[4:7], s60 offen offset:2112
L_tl_kl_106:
    buffer_load_dwordx4 v[16:19], v7, s[4:7], s61 offen offset:0 sc1
    buffer_load_dwordx4 v[20:23], v7, s[4:7], s61 offen offset:64 sc1
    buffer_load_dwordx4 v[24:27], v7, s[4:7], s61 offen offset:128 sc1
    buffer_load_dwordx4 v[28:31], v7, s[4:7], s61 offen offset:192 sc1
    buffer_load_dwordx2 v[32:33], v8, s[4:7], s61 offen offset:0 sc1
    buffer_load_dwordx2 v[34:35], v8, s[4:7], s61 offen offset:16 sc1
    buffer_load_dwordx2 v[36:37], v8, s[4:7], s61 offen offset:512 sc1
    buffer_load_dwordx2 v[38:39], v8, s[4:7], s61 offen offset:528 sc1
    s_cmp_lt_u32 s56, 60
    s_cbranch_scc1 L_tl_ko_107
    s_waitcnt vmcnt(0)
    v_max3_u32 v56, v16, v20, v24
    v_max3_u32 v56, v56, v28, v32
    v_max3_u32 v56, v56, v34, v36
    v_max_u32 v56, v56, v38
    v_cmp_eq_u32 vcc, -1, v56
    s_add_u32 s93, s93, 1
    s_cmp_lt_u32 s93, 0x80000
    s_cselect_b64 vcc, vcc, 0
    s_cbranch_vccz L_tl_ko_107
    s_sleep 2
    s_branch L_tl_kl_106
L_tl_ko_107:
    s_waitcnt vmcnt(12)
    s_barrier
    v_add_u32 v56, s55, v5
    ds_read_b128 v[80:83], v56 offset:8192
    ds_read_b128 v[96:99], v5 offset:0
    ds_read_b128 v[112:115], v5 offset:4096
    v_xor_b32 v57, 64, v5
    v_xor_b32 v58, 64, v56
    ds_read_b128 v[84:87], v58 offset:8192
    ds_read_b128 v[100:103], v57 offset:0
    ds_read_b128 v[116:119], v57 offset:4096
    v_xor_b32 v57, 128, v5
    v_xor_b32 v58, 128, v56
    ds_read_b128 v[88:91], v58 offset:8192
    ds_read_b128 v[104:107], v57 offset:0
    ds_read_b128 v[120:123], v57 offset:4096
    v_xor_b32 v57, 192, v5
    v_xor_b32 v58, 192, v56
    ds_read_b128 v[92:95], v58 offset:8192
    ds_read_b128 v[108:111], v57 offset:0
    ds_read_b128 v[124:127], v57 offset:4096
    s_waitcnt lgkmcnt(9)
    v_mfma_f32_16x16x32_bf16 v[68:71], v[96:99], v[80:83], 0
    v_mfma_f32_16x16x32_bf16 v[72:75], v[112:115], v[80:83], 0
    s_waitcnt lgkmcnt(6)
    v_mfma_f32_16x16x32_bf16 v[68:71], v[100:103], v[84:87], v[68:71]
    v_mfma_f32_16x16x32_bf16 v[72:75], v[116:119], v[84:87], v[72:75]
    s_waitcnt lgkmcnt(3)
    v_mfma_f32_16x16x32_bf16 v[68:71], v[104:107], v[88:91], v[68:71]
    v_mfma_f32_16x16x32_bf16 v[72:75], v[120:123], v[88:91], v[72:75]
    s_waitcnt lgkmcnt(0)
    v_mfma_f32_16x16x32_bf16 v[68:71], v[108:111], v[92:95], v[68:71]
    v_mfma_f32_16x16x32_bf16 v[72:75], v[124:127], v[92:95], v[72:75]
    s_waitcnt vmcnt(4)
    v_mfma_f32_16x16x32_bf16 v[64:67], v[16:19], v[80:83], 0
    v_mfma_f32_16x16x32_bf16 v[64:67], v[20:23], v[84:87], v[64:67]
    v_mfma_f32_16x16x32_bf16 v[64:67], v[24:27], v[88:91], v[64:67]
    v_mfma_f32_16x16x32_bf16 v[64:67], v[28:31], v[92:95], v[64:67]
    v_mov_b32 v57, s53
    v_cmp_le_i32 vcc, 0, v12
    s_nop 1
    v_cndmask_b32 v68, v57, v68, vcc
    v_cmp_le_i32 vcc, 1, v12
    s_nop 1
    v_cndmask_b32 v69, v57, v69, vcc
    v_cmp_le_i32 vcc, 2, v12
    s_nop 1
    v_cndmask_b32 v70, v57, v70, vcc
    v_cmp_le_i32 vcc, 3, v12
    s_nop 1
    v_cndmask_b32 v71, v57, v71, vcc
    v_cmp_le_i32 vcc, 16, v12
    s_nop 1
    v_cndmask_b32 v72, v57, v72, vcc
    v_cmp_le_i32 vcc, 17, v12
    s_nop 1
    v_cndmask_b32 v73, v57, v73, vcc
    v_cmp_le_i32 vcc, 18, v12
    s_nop 1
    v_cndmask_b32 v74, v57, v74, vcc
    v_cmp_le_i32 vcc, 19, v12
    s_nop 1
    v_cndmask_b32 v75, v57, v75, vcc
    v_cmp_gt_u32 vcc, 2, v3
    s_nop 1
    v_cndmask_b32 v64, v57, v64, vcc
    v_cndmask_b32 v65, v57, v65, vcc
    v_cndmask_b32 v66, v57, v66, vcc
    v_cndmask_b32 v67, v57, v67, vcc
    v_max3_f32 v76, v64, v65, v66
    v_max3_f32 v77, v67, v68, v69
    v_max3_f32 v76, v76, v70, v71
    v_max3_f32 v77, v77, v72, v73
    v_max3_f32 v76, v76, v74, v75
    v_max_f32 v76, v76, v77
    v_mov_b32 v77, v76
    s_nop 1
    v_permlane32_swap_b32 v77, v76
    v_max_f32 v76, v76, v77
    v_mov_b32 v77, v76
    s_nop 1
    v_permlane16_swap_b32 v77, v76
    v_max_f32 v76, v76, v77
    v_mul_f32 v76, s52, v76
    v_fma_f32 v64, v64, s52, -v76
    v_fma_f32 v65, v65, s52, -v76
    v_fma_f32 v66, v66, s52, -v76
    v_fma_f32 v67, v67, s52, -v76
    v_fma_f32 v68, v68, s52, -v76
    v_fma_f32 v69, v69, s52, -v76
    v_fma_f32 v70, v70, s52, -v76
    v_fma_f32 v71, v71, s52, -v76
    v_fma_f32 v72, v72, s52, -v76
    v_fma_f32 v73, v73, s52, -v76
    v_fma_f32 v74, v74, s52, -v76
    v_fma_f32 v75, v75, s52, -v76
    v_exp_f32 v64, v64
    v_exp_f32 v65, v65
    v_exp_f32 v66, v66
    v_exp_f32 v67, v67
    v_exp_f32 v68, v68
    v_exp_f32 v69, v69
    v_exp_f32 v70, v70
    v_exp_f32 v71, v71
    v_exp_f32 v72, v72
    v_exp_f32 v73, v73
    v_exp_f32 v74, v74
    v_exp_f32 v75, v75
    s_nop 0
    v_add_f32 v78, v64, v65
    v_add_f32 v77, v66, v67
    v_add_f32 v79, v68, v69
    v_add_f32 v76, v70, v71
    v_add_f32 v78, v78, v77
    v_add_f32 v77, v72, v73
    v_add_f32 v79, v79, v76
    v_add_f32 v76, v74, v75
    v_add_f32 v78, v78, v77
    v_add_f32 v79, v79, v76
    v_add_f32 v78, v78, v79
    v_mov_b32 v77, v78
    s_nop 1
    v_permlane32_swap_b32 v77, v78
    v_add_f32 v78, v78, v77
    v_mov_b32 v77, v78
    s_nop 1
    v_permlane16_swap_b32 v77, v78
    v_add_f32 v78, v78, v77
    v_rcp_f32 v78, v78
    s_nop 0
    v_mul_f32 v64, v64, v78
    v_mul_f32 v65, v65, v78
    v_mul_f32 v66, v66, v78
    v_mul_f32 v67, v67, v78
    v_mul_f32 v68, v68, v78
    v_mul_f32 v69, v69, v78
    v_mul_f32 v70, v70, v78
    v_mul_f32 v71, v71, v78
    v_mul_f32 v72, v72, v78
    v_mul_f32 v73, v73, v78
    v_mul_f32 v74, v74, v78
    v_mul_f32 v75, v75, v78
    v_cvt_pk_bf16_f32 v80, v68, v69
    v_cvt_pk_bf16_f32 v81, v70, v71
    v_cvt_pk_bf16_f32 v82, v72, v73
    v_cvt_pk_bf16_f32 v83, v74, v75
    v_cvt_pk_bf16_f32 v84, v64, v65
    v_cvt_pk_bf16_f32 v85, v66, v67
    s_waitcnt vmcnt(0)
    v_mfma_f32_16x16x32_bf16 v[96:99], v[40:43], v[80:83], 0
    v_mfma_f32_16x16x32_bf16 v[100:103], v[44:47], v[80:83], 0
    v_mfma_f32_16x16x32_bf16 v[104:107], v[48:51], v[80:83], 0
    v_mfma_f32_16x16x32_bf16 v[108:111], v[52:55], v[80:83], 0
    v_mfma_f32_16x16x16_bf16 v[96:99], v[32:33], v[84:85], v[96:99]
    v_mfma_f32_16x16x16_bf16 v[100:103], v[34:35], v[84:85], v[100:103]
    v_mfma_f32_16x16x16_bf16 v[104:107], v[36:37], v[84:85], v[104:107]
    v_mfma_f32_16x16x16_bf16 v[108:111], v[38:39], v[84:85], v[108:111]
    s_add_u32 s74, s16, 28
    s_cmp_lt_u32 s56, 24
    s_cselect_b32 s75, 4, 7
    s_add_u32 s75, s56, s75
    s_sub_u32 s76, s56, 24
    s_cmp_lt_u32 s76, 4
    s_cselect_b32 s67, s74, s75
    s_cmp_ge_u32 s67, 64
    s_cbranch_scc1 L_tl_nx_108
    s_lshl_b32 s58, s67, 13
    s_add_u32 s59, s58, 0x1000000
    s_add_u32 m0, s54, 16384
    s_lshl_b32 s60, s67, 18
    buffer_load_dwordx4 v4, s[4:7], s59 offen lds
    buffer_load_dwordx4 v4, s[4:7], s59 offen offset:1024 lds
    s_add_u32 m0, s54, 24576
    s_nop 0
    buffer_load_dwordx4 v4, s[4:7], s58 offen lds
    buffer_load_dwordx4 v4, s[4:7], s58 offen offset:1024 lds
L_tl_nx_108:
    s_nop 4
    v_cvt_pk_bf16_f32 v64, v96, v100
    v_cvt_pk_bf16_f32 v65, v97, v101
    v_cvt_pk_bf16_f32 v66, v98, v102
    v_cvt_pk_bf16_f32 v67, v99, v103
    ds_write_b128 v9, v[64:67] offset:0
    v_cvt_pk_bf16_f32 v68, v104, v108
    v_cvt_pk_bf16_f32 v69, v105, v109
    v_cvt_pk_bf16_f32 v70, v106, v110
    v_cvt_pk_bf16_f32 v71, v107, v111
    ds_write_b128 v9, v[68:71] offset:64
    s_waitcnt lgkmcnt(0)
    s_barrier
    ds_read_b128 v[16:19], v10 offset:0
    ds_read_b128 v[20:23], v10 offset:64
    ds_read_b128 v[24:27], v10 offset:128
    ds_read_b128 v[28:31], v10 offset:192
    ds_read_b128 v[32:35], v10 offset:4352
    ds_read_b128 v[36:39], v10 offset:4416
    ds_read_b128 v[40:43], v10 offset:4480
    ds_read_b128 v[44:47], v10 offset:4544
    s_lshl_b32 s62, s56, 20
    s_waitcnt lgkmcnt(7)
    v_mfma_f32_16x16x32_bf16 v[64:67], v[16:19], a[0:3], 0
    v_mfma_f32_16x16x32_bf16 v[68:71], v[16:19], a[16:19], 0
    v_mfma_f32_16x16x32_bf16 v[72:75], v[16:19], a[32:35], 0
    v_mfma_f32_16x16x32_bf16 v[76:79], v[16:19], a[48:51], 0
    v_mfma_f32_16x16x32_bf16 v[80:83], v[16:19], a[64:67], 0
    v_mfma_f32_16x16x32_bf16 v[84:87], v[16:19], a[80:83], 0
    v_mfma_f32_16x16x32_bf16 v[88:91], v[16:19], a[96:99], 0
    v_mfma_f32_16x16x32_bf16 v[92:95], v[16:19], a[112:115], 0
    s_waitcnt lgkmcnt(6)
    v_mfma_f32_16x16x32_bf16 v[64:67], v[20:23], a[4:7], v[64:67]
    v_mfma_f32_16x16x32_bf16 v[68:71], v[20:23], a[20:23], v[68:71]
    v_mfma_f32_16x16x32_bf16 v[72:75], v[20:23], a[36:39], v[72:75]
    v_mfma_f32_16x16x32_bf16 v[76:79], v[20:23], a[52:55], v[76:79]
    v_mfma_f32_16x16x32_bf16 v[80:83], v[20:23], a[68:71], v[80:83]
    v_mfma_f32_16x16x32_bf16 v[84:87], v[20:23], a[84:87], v[84:87]
    v_mfma_f32_16x16x32_bf16 v[88:91], v[20:23], a[100:103], v[88:91]
    v_mfma_f32_16x16x32_bf16 v[92:95], v[20:23], a[116:119], v[92:95]
    s_waitcnt lgkmcnt(5)
    v_mfma_f32_16x16x32_bf16 v[64:67], v[24:27], a[8:11], v[64:67]
    v_mfma_f32_16x16x32_bf16 v[68:71], v[24:27], a[24:27], v[68:71]
    v_mfma_f32_16x16x32_bf16 v[72:75], v[24:27], a[40:43], v[72:75]
    v_mfma_f32_16x16x32_bf16 v[76:79], v[24:27], a[56:59], v[76:79]
    v_mfma_f32_16x16x32_bf16 v[80:83], v[24:27], a[72:75], v[80:83]
    v_mfma_f32_16x16x32_bf16 v[84:87], v[24:27], a[88:91], v[84:87]
    v_mfma_f32_16x16x32_bf16 v[88:91], v[24:27], a[104:107], v[88:91]
    v_mfma_f32_16x16x32_bf16 v[92:95], v[24:27], a[120:123], v[92:95]
    s_waitcnt lgkmcnt(4)
    v_mfma_f32_16x16x32_bf16 v[64:67], v[28:31], a[12:15], v[64:67]
    v_mfma_f32_16x16x32_bf16 v[68:71], v[28:31], a[28:31], v[68:71]
    v_mfma_f32_16x16x32_bf16 v[72:75], v[28:31], a[44:47], v[72:75]
    v_mfma_f32_16x16x32_bf16 v[76:79], v[28:31], a[60:63], v[76:79]
    v_mfma_f32_16x16x32_bf16 v[80:83], v[28:31], a[76:79], v[80:83]
    v_mfma_f32_16x16x32_bf16 v[84:87], v[28:31], a[92:95], v[84:87]
    v_mfma_f32_16x16x32_bf16 v[88:91], v[28:31], a[108:111], v[88:91]
    v_mfma_f32_16x16x32_bf16 v[92:95], v[28:31], a[124:127], v[92:95]
    s_waitcnt lgkmcnt(3)
    v_mfma_f32_16x16x32_bf16 v[96:99], v[32:35], a[0:3], 0
    v_mfma_f32_16x16x32_bf16 v[100:103], v[32:35], a[16:19], 0
    v_mfma_f32_16x16x32_bf16 v[104:107], v[32:35], a[32:35], 0
    v_mfma_f32_16x16x32_bf16 v[108:111], v[32:35], a[48:51], 0
    v_mfma_f32_16x16x32_bf16 v[112:115], v[32:35], a[64:67], 0
    v_mfma_f32_16x16x32_bf16 v[116:119], v[32:35], a[80:83], 0
    v_mfma_f32_16x16x32_bf16 v[120:123], v[32:35], a[96:99], 0
    v_mfma_f32_16x16x32_bf16 v[124:127], v[32:35], a[112:115], 0
    s_waitcnt lgkmcnt(2)
    v_mfma_f32_16x16x32_bf16 v[96:99], v[36:39], a[4:7], v[96:99]
    v_mfma_f32_16x16x32_bf16 v[100:103], v[36:39], a[20:23], v[100:103]
    v_mfma_f32_16x16x32_bf16 v[104:107], v[36:39], a[36:39], v[104:107]
    v_mfma_f32_16x16x32_bf16 v[108:111], v[36:39], a[52:55], v[108:111]
    v_mfma_f32_16x16x32_bf16 v[112:115], v[36:39], a[68:71], v[112:115]
    v_mfma_f32_16x16x32_bf16 v[116:119], v[36:39], a[84:87], v[116:119]
    v_mfma_f32_16x16x32_bf16 v[120:123], v[36:39], a[100:103], v[120:123]
    v_mfma_f32_16x16x32_bf16 v[124:127], v[36:39], a[116:119], v[124:127]
    s_waitcnt lgkmcnt(1)
    v_mfma_f32_16x16x32_bf16 v[96:99], v[40:43], a[8:11], v[96:99]
    v_mfma_f32_16x16x32_bf16 v[100:103], v[40:43], a[24:27], v[100:103]
    v_mfma_f32_16x16x32_bf16 v[104:107], v[40:43], a[40:43], v[104:107]
    v_mfma_f32_16x16x32_bf16 v[108:111], v[40:43], a[56:59], v[108:111]
    v_mfma_f32_16x16x32_bf16 v[112:115], v[40:43], a[72:75], v[112:115]
    v_mfma_f32_16x16x32_bf16 v[116:119], v[40:43], a[88:91], v[116:119]
    v_mfma_f32_16x16x32_bf16 v[120:123], v[40:43], a[104:107], v[120:123]
    v_mfma_f32_16x16x32_bf16 v[124:127], v[40:43], a[120:123], v[124:127]
    s_waitcnt lgkmcnt(0)
    v_mfma_f32_16x16x32_bf16 v[96:99], v[44:47], a[12:15], v[96:99]
    v_mfma_f32_16x16x32_bf16 v[100:103], v[44:47], a[28:31], v[100:103]
    v_mfma_f32_16x16x32_bf16 v[104:107], v[44:47], a[44:47], v[104:107]
    v_mfma_f32_16x16x32_bf16 v[108:111], v[44:47], a[60:63], v[108:111]
    v_mfma_f32_16x16x32_bf16 v[112:115], v[44:47], a[76:79], v[112:115]
    v_mfma_f32_16x16x32_bf16 v[116:119], v[44:47], a[92:95], v[116:119]
    v_mfma_f32_16x16x32_bf16 v[120:123], v[44:47], a[108:111], v[120:123]
    v_mfma_f32_16x16x32_bf16 v[124:127], v[44:47], a[124:127], v[124:127]
    s_nop 7
    v_cvt_pk_bf16_f32 v16, v64, v68
    v_cvt_pk_bf16_f32 v17, v72, v76
    v_cvt_pk_bf16_f32 v18, v80, v84
    v_cvt_pk_bf16_f32 v19, v88, v92
    s_add_u32 s63, s62, 0
    v_min_u32 v16, -2, v16
    buffer_store_dwordx4 v[16:19], v11, s[4:7], s63 offen sc1
    v_cvt_pk_bf16_f32 v20, v65, v69
    v_cvt_pk_bf16_f32 v21, v73, v77
    v_cvt_pk_bf16_f32 v22, v81, v85
    v_cvt_pk_bf16_f32 v23, v89, v93
    s_add_u32 s63, s62, 32768
    v_min_u32 v20, -2, v20
    buffer_store_dwordx4 v[20:23], v11, s[4:7], s63 offen sc1
    v_cvt_pk_bf16_f32 v24, v66, v70
    v_cvt_pk_bf16_f32 v25, v74, v78
    v_cvt_pk_bf16_f32 v26, v82, v86
    v_cvt_pk_bf16_f32 v27, v90, v94
    s_add_u32 s63, s62, 65536
    v_min_u32 v24, -2, v24
    buffer_store_dwordx4 v[24:27], v11, s[4:7], s63 offen sc1
    v_cvt_pk_bf16_f32 v28, v67, v71
    v_cvt_pk_bf16_f32 v29, v75, v79
    v_cvt_pk_bf16_f32 v30, v83, v87
    v_cvt_pk_bf16_f32 v31, v91, v95
    s_add_u32 s63, s62, 98304
    v_min_u32 v28, -2, v28
    buffer_store_dwordx4 v[28:31], v11, s[4:7], s63 offen sc1
    v_cvt_pk_bf16_f32 v16, v96, v100
    v_cvt_pk_bf16_f32 v17, v104, v108
    v_cvt_pk_bf16_f32 v18, v112, v116
    v_cvt_pk_bf16_f32 v19, v120, v124
    s_add_u32 s63, s62, 524288
    v_min_u32 v16, -2, v16
    buffer_store_dwordx4 v[16:19], v11, s[4:7], s63 offen sc1
    v_cvt_pk_bf16_f32 v20, v97, v101
    v_cvt_pk_bf16_f32 v21, v105, v109
    v_cvt_pk_bf16_f32 v22, v113, v117
    v_cvt_pk_bf16_f32 v23, v121, v125
    s_add_u32 s63, s62, 557056
    v_min_u32 v20, -2, v20
    buffer_store_dwordx4 v[20:23], v11, s[4:7], s63 offen sc1
    v_cvt_pk_bf16_f32 v24, v98, v102
    v_cvt_pk_bf16_f32 v25, v106, v110
    v_cvt_pk_bf16_f32 v26, v114, v118
    v_cvt_pk_bf16_f32 v27, v122, v126
    s_add_u32 s63, s62, 589824
    v_min_u32 v24, -2, v24
    buffer_store_dwordx4 v[24:27], v11, s[4:7], s63 offen sc1
    v_cvt_pk_bf16_f32 v28, v99, v103
    v_cvt_pk_bf16_f32 v29, v107, v111
    v_cvt_pk_bf16_f32 v30, v115, v119
    v_cvt_pk_bf16_f32 v31, v123, v127
    s_add_u32 s63, s62, 622592
    v_min_u32 v28, -2, v28
    buffer_store_dwordx4 v[28:31], v11, s[4:7], s63 offen sc1
    s_sub_u32 s64, s57, s68
    s_add_u32 s57, s57, 1
    s_mov_b32 s63, s67
    s_cmp_ge_u32 s63, 64
    s_cselect_b32 s63, s64, 1
    s_cmp_eq_u32 s63, 0
    s_cbranch_scc1 L_tl_fast_94
    s_waitcnt vmcnt(0)
    s_barrier
    s_cmp_lg_u32 s14, 0
    s_cbranch_scc1 L_tl_np_109
    s_mov_b64 exec, 1
    v_mov_b32 v56, s57
    v_mov_b32 v57, s15
    s_mov_b32 s63, 0x5800000
    buffer_store_byte v56, v57, s[4:7], s63 offen sc1
    s_mov_b64 exec, -1
L_tl_np_109:
    s_cmp_lg_u32 s71, 0
    s_cbranch_scc1 L_tl_yd_111
    s_cmp_lg_u32 s14, 0
    s_cbranch_scc1 L_tl_rf_112
    s_lshl_b32 s63, s17, 7
    s_add_u32 s63, s63, 0x5810000
    v_mov_b32 v56, 8
    buffer_load_ubyte v58, v56, s[4:7], s63 offen sc1
    v_mov_b32 v56, 44
    s_cmp_lg_u32 s71, 0
    s_cbranch_scc1 L_tl_rf_112_s
    global_load_dword v59, v56, s[12:13] sc1
L_tl_rf_112_s:
    v_mov_b32 v56, 41472
    s_waitcnt vmcnt(0)
    ds_write_b64 v56, v[58:59]
    s_waitcnt lgkmcnt(0)
L_tl_rf_112:
    s_waitcnt vmcnt(0)
    s_barrier
    v_mov_b32 v56, 41472
    ds_read_b64 v[58:59], v56
    s_waitcnt lgkmcnt(0)
    v_readfirstlane_b32 s70, v58
    v_readfirstlane_b32 s63, v59
    s_cmp_ge_u32 s63, 128
    s_cselect_b32 s71, 1, s71
    s_barrier
    s_cmp_eq_u32 s71, 0
    s_cbranch_scc1 L_tl_nd_110
L_tl_yd_111:
    s_sub_u32 s73, s57, 1
L_tl_dr_113:
    s_cmp_ge_u32 s68, s73
    s_cbranch_scc1 L_tl_dro_114
    s_cmp_lg_u32 s71, 0
    s_cbranch_scc1 L_tl_drs_115
    s_cmp_lg_u32 s14, 0
    s_cbranch_scc1 L_tl_wo_117
    v_mov_b32 v56, 44
L_tl_w_116:
    global_load_dword v57, v56, s[12:13] sc1
    s_waitcnt vmcnt(0)
    v_cmp_gt_u32 vcc, 128, v57
    s_add_u32 s93, s93, 1
    s_cmp_lt_u32 s93, 0x80000
    s_cselect_b64 vcc, vcc, 0
    s_cbranch_vccz L_tl_wo_117
    s_sleep 12
    s_branch L_tl_w_116
L_tl_wo_117:
    s_waitcnt vmcnt(0)
    s_barrier
    s_mov_b32 s71, 1
L_tl_drs_115:
    s_add_u32 s68, s68, 1
    s_cmp_lg_u32 s14, 0
    s_cbranch_scc1 L_tl_wo_119
    s_lshl_b32 s63, s16, 5
    v_and_b32 v56, 31, v1
    v_add_u32 v56, s63, v56
    s_mov_b32 s63, 0x5800000
L_tl_w_118:
    buffer_load_ubyte v57, v56, s[4:7], s63 offen sc1
    s_waitcnt vmcnt(0)
    v_cmp_gt_u32 vcc, s68, v57
    s_add_u32 s93, s93, 1
    s_cmp_lt_u32 s93, 0x80000
    s_cselect_b64 vcc, vcc, 0
    s_cbranch_vccz L_tl_wo_119
    s_sleep 12
    s_branch L_tl_w_118
L_tl_wo_119:
    s_waitcnt vmcnt(0)
    s_barrier
    s_lshl_b32 s63, s17, 15
    s_lshl_b32 s64, s69, 20
    s_add_u32 s63, s63, s64
    s_lshl_b32 s64, s14, 13
    s_add_u32 s63, s63, s64
    s_add_u32 s63, s63, 0x6000000
    s_add_u32 s64, s63, 4096
    buffer_load_dwordx4 v[64:67], v13, s[4:7], s63 offen offset:0 sc1
    buffer_load_dwordx4 v[68:71], v13, s[4:7], s63 offen offset:1024 sc1
    buffer_load_dwordx4 v[72:75], v13, s[4:7], s63 offen offset:2048 sc1
    buffer_load_dwordx4 v[76:79], v13, s[4:7], s63 offen offset:3072 sc1
    buffer_load_dwordx4 v[80:83], v13, s[4:7], s64 offen offset:0 sc1
    buffer_load_dwordx4 v[84:87], v13, s[4:7], s64 offen offset:1024 sc1
    buffer_load_dwordx4 v[88:91], v13, s[4:7], s64 offen offset:2048 sc1
    buffer_load_dwordx4 v[92:95], v13, s[4:7], s64 offen offset:3072 sc1
    s_lshl_b32 s65, s69, 5
    s_add_u32 s65, s65, s17
    s_lshl_b32 s65, s65, 10
    buffer_load_dwordx4 v[40:43], v13, s[36:39], s65 offen
    buffer_load_dwordx4 v[44:47], v13, s[44:47], 0 offen
    buffer_load_dwordx2 v[48:49], v15, s[36:39], s65 offen
    s_lshr_b32 s66, s65, 7
    s_add_u32 s66, s66, 0x5000000
    v_lshlrev_b32 v56, 11, v15
    buffer_load_dwordx2 v[50:51], v56, s[4:7], s66 offen sc1
    buffer_load_dwordx2 v[52:53], v15, s[48:51], 0 offen
    s_waitcnt vmcnt(0)
    v_lshrrev_b32 v57, 1, v2
    v_cmp_eq_u32 vcc, 0, v57
    s_nop 1
    v_cndmask_b32 v16, 0, v14, vcc
    v_cmp_eq_u32 vcc, 1, v57
    s_nop 1
    v_cndmask_b32 v17, 0, v14, vcc
    v_cmp_eq_u32 vcc, 2, v57
    s_nop 1
    v_cndmask_b32 v18, 0, v14, vcc
    v_cmp_eq_u32 vcc, 3, v57
    s_nop 1
    v_cndmask_b32 v19, 0, v14, vcc
    s_nop 1
    v_mfma_f32_16x16x32_bf16 v[20:23], v[16:19], v[64:67], 0
    v_mfma_f32_16x16x32_bf16 v[20:23], v[16:19], v[68:71], v[20:23]
    v_mfma_f32_16x16x32_bf16 v[20:23], v[16:19], v[72:75], v[20:23]
    v_mfma_f32_16x16x32_bf16 v[20:23], v[16:19], v[76:79], v[20:23]
    v_mfma_f32_16x16x32_bf16 v[20:23], v[16:19], v[80:83], v[20:23]
    v_mfma_f32_16x16x32_bf16 v[20:23], v[16:19], v[84:87], v[20:23]
    v_mfma_f32_16x16x32_bf16 v[20:23], v[16:19], v[88:91], v[20:23]
    v_mfma_f32_16x16x32_bf16 v[20:23], v[16:19], v[92:95], v[20:23]
    v_lshlrev_b32 v24, 16, v40
    v_and_b32 v25, 0xffff0000, v40
    v_lshlrev_b32 v26, 16, v44
    v_and_b32 v27, 0xffff0000, v44
    v_mul_f32 v24, v24, v26
    v_mul_f32 v25, v25, v27
    v_cvt_pk_bf16_f32 v24, v24, v25
    v_lshlrev_b32 v25, 16, v24
    v_and_b32 v24, 0xffff0000, v24
    v_add_f32 v24, v24, v25
    v_mov_b32 v28, v24
    v_lshlrev_b32 v24, 16, v41
    v_and_b32 v25, 0xffff0000, v41
    v_lshlrev_b32 v26, 16, v45
    v_and_b32 v27, 0xffff0000, v45
    v_mul_f32 v24, v24, v26
    v_mul_f32 v25, v25, v27
    v_cvt_pk_bf16_f32 v24, v24, v25
    v_lshlrev_b32 v25, 16, v24
    v_and_b32 v24, 0xffff0000, v24
    v_add_f32 v24, v24, v25
    v_add_f32 v28, v28, v24
    v_lshlrev_b32 v24, 16, v42
    v_and_b32 v25, 0xffff0000, v42
    v_lshlrev_b32 v26, 16, v46
    v_and_b32 v27, 0xffff0000, v46
    v_mul_f32 v24, v24, v26
    v_mul_f32 v25, v25, v27
    v_cvt_pk_bf16_f32 v24, v24, v25
    v_lshlrev_b32 v25, 16, v24
    v_and_b32 v24, 0xffff0000, v24
    v_add_f32 v24, v24, v25
    v_add_f32 v28, v28, v24
    v_lshlrev_b32 v24, 16, v43
    v_and_b32 v25, 0xffff0000, v43
    v_lshlrev_b32 v26, 16, v47
    v_and_b32 v27, 0xffff0000, v47
    v_mul_f32 v24, v24, v26
    v_mul_f32 v25, v25, v27
    v_cvt_pk_bf16_f32 v24, v24, v25
    v_lshlrev_b32 v25, 16, v24
    v_and_b32 v24, 0xffff0000, v24
    v_add_f32 v24, v24, v25
    v_add_f32 v28, v28, v24
    s_nop 1
    v_add_f32_dpp v28, v28, v28 quad_perm:[1,0,3,2] row_mask:0xf bank_mask:0xf
    s_nop 1
    v_add_f32_dpp v28, v28, v28 quad_perm:[2,3,0,1] row_mask:0xf bank_mask:0xf
    s_nop 1
    v_add_f32_dpp v28, v28, v28 row_ror:4 row_mask:0xf bank_mask:0xf
    s_nop 1
    v_add_f32_dpp v28, v28, v28 row_ror:8 row_mask:0xf bank_mask:0xf
    v_mov_b32 v24, v28
    s_nop 1
    v_permlane32_swap_b32 v24, v28
    v_add_f32 v28, v28, v24
    v_mov_b32 v24, v28
    s_nop 1
    v_permlane16_swap_b32 v24, v28
    v_add_f32 v28, v28, v24
    v_cvt_pk_bf16_f32 v28, v28, v28
    v_lshlrev_b32 v28, 16, v28
    v_mul_f32 v28, 0xbfb8aa3b, v28
    v_exp_f32 v28, v28
    s_nop 0
    v_add_f32 v28, 1.0, v28
    v_rcp_f32 v28, v28
    s_nop 0
    v_cvt_pk_bf16_f32 v28, v28, v28
    v_lshlrev_b32 v28, 16, v28
    v_sub_f32 v29, 1.0, v28
    v_cvt_pk_bf16_f32 v29, v29, v29
    v_lshlrev_b32 v29, 16, v29
    v_cvt_pk_bf16_f32 v24, v20, v21
    v_lshlrev_b32 v25, 16, v24
    v_and_b32 v24, 0xffff0000, v24
    v_mul_f32 v25, v28, v25
    v_mul_f32 v24, v28, v24
    v_cvt_pk_bf16_f32 v20, v25, v24
    v_lshlrev_b32 v24, 16, v48
    v_and_b32 v25, 0xffff0000, v48
    v_lshlrev_b32 v26, 16, v52
    v_and_b32 v27, 0xffff0000, v52
    v_mul_f32 v24, v24, v26
    v_mul_f32 v25, v25, v27
    v_cvt_pk_bf16_f32 v24, v24, v25
    v_lshlrev_b32 v25, 16, v24
    v_and_b32 v24, 0xffff0000, v24
    v_lshlrev_b32 v26, 16, v50
    v_and_b32 v27, 0xffff0000, v50
    v_add_f32 v25, v25, v26
    v_add_f32 v24, v24, v27
    v_cvt_pk_bf16_f32 v24, v25, v24
    v_lshlrev_b32 v25, 16, v24
    v_and_b32 v24, 0xffff0000, v24
    v_mul_f32 v25, v29, v25
    v_mul_f32 v24, v29, v24
    v_cvt_pk_bf16_f32 v24, v25, v24
    v_lshlrev_b32 v25, 16, v24
    v_and_b32 v24, 0xffff0000, v24
    v_lshlrev_b32 v26, 16, v20
    v_and_b32 v27, 0xffff0000, v20
    v_add_f32 v25, v25, v26
    v_add_f32 v24, v24, v27
    v_cvt_pk_bf16_f32 v40, v25, v24
    v_cvt_pk_bf16_f32 v24, v22, v23
    v_lshlrev_b32 v25, 16, v24
    v_and_b32 v24, 0xffff0000, v24
    v_mul_f32 v25, v28, v25
    v_mul_f32 v24, v28, v24
    v_cvt_pk_bf16_f32 v22, v25, v24
    v_lshlrev_b32 v24, 16, v49
    v_and_b32 v25, 0xffff0000, v49
    v_lshlrev_b32 v26, 16, v53
    v_and_b32 v27, 0xffff0000, v53
    v_mul_f32 v24, v24, v26
    v_mul_f32 v25, v25, v27
    v_cvt_pk_bf16_f32 v24, v24, v25
    v_lshlrev_b32 v25, 16, v24
    v_and_b32 v24, 0xffff0000, v24
    v_lshlrev_b32 v26, 16, v51
    v_and_b32 v27, 0xffff0000, v51
    v_add_f32 v25, v25, v26
    v_add_f32 v24, v24, v27
    v_cvt_pk_bf16_f32 v24, v25, v24
    v_lshlrev_b32 v25, 16, v24
    v_and_b32 v24, 0xffff0000, v24
    v_mul_f32 v25, v29, v25
    v_mul_f32 v24, v29, v24
    v_cvt_pk_bf16_f32 v24, v25, v24
    v_lshlrev_b32 v25, 16, v24
    v_and_b32 v24, 0xffff0000, v24
    v_lshlrev_b32 v26, 16, v22
    v_and_b32 v27, 0xffff0000, v22
    v_add_f32 v25, v25, v26
    v_add_f32 v24, v24, v27
    v_cvt_pk_bf16_f32 v41, v25, v24
    s_mov_b32 exec_hi, 0
    buffer_store_dwordx2 v[40:41], v15, s[40:43], s65 offen
    s_mov_b32 exec_hi, -1
    s_add_u32 s74, s16, 28
    s_cmp_lt_u32 s69, 24
    s_cselect_b32 s75, 4, 7
    s_add_u32 s75, s69, s75
    s_sub_u32 s76, s69, 24
    s_cmp_lt_u32 s76, 4
    s_cselect_b32 s69, s74, s75
    s_branch L_tl_dr_113
L_tl_dro_114:
L_tl_nd_110:
    s_add_u32 s74, s16, 28
    s_cmp_lt_u32 s56, 24
    s_cselect_b32 s75, 4, 7
    s_add_u32 s75, s56, s75
    s_sub_u32 s76, s56, 24
    s_cmp_lt_u32 s76, 4
    s_cselect_b32 s56, s74, s75
    s_cmp_ge_u32 s56, 64
    s_cbranch_scc1 L_tl_fin_93
    s_add_u32 s72, s56, 1
    s_sub_u32 s63, s56, 1
    s_cmp_ge_u32 s56, 60
    s_cselect_b32 s72, s63, s72
    s_cmp_ge_u32 s70, s72
    s_cbranch_scc1 L_tl_go_120
    s_cmp_lg_u32 s14, 0
    s_cbranch_scc1 L_tl_rf_122
    s_lshl_b32 s63, s17, 7
    s_add_u32 s63, s63, 0x5810000
    v_mov_b32 v56, 8
    buffer_load_ubyte v58, v56, s[4:7], s63 offen sc1
    v_mov_b32 v56, 44
    s_cmp_lg_u32 s71, 0
    s_cbranch_scc1 L_tl_rf_122_s
    global_load_dword v59, v56, s[12:13] sc1
L_tl_rf_122_s:
    v_mov_b32 v56, 41472
    s_waitcnt vmcnt(0)
    ds_write_b64 v56, v[58:59]
    s_waitcnt lgkmcnt(0)
L_tl_rf_122:
    s_waitcnt vmcnt(0)
    s_barrier
    v_mov_b32 v56, 41472
    ds_read_b64 v[58:59], v56
    s_waitcnt lgkmcnt(0)
    v_readfirstlane_b32 s70, v58
    v_readfirstlane_b32 s63, v59
    s_cmp_ge_u32 s63, 128
    s_cselect_b32 s71, 1, s71
    s_barrier
    s_cmp_ge_u32 s70, s72
    s_cbranch_scc1 L_tl_go_120
L_tl_dr_123:
    s_cmp_ge_u32 s68, s57
    s_cbranch_scc1 L_tl_dro_124
    s_cmp_lg_u32 s71, 0
    s_cbranch_scc1 L_tl_drs_125
    s_cmp_lg_u32 s14, 0
    s_cbranch_scc1 L_tl_wo_127
    v_mov_b32 v56, 44
L_tl_w_126:
    global_load_dword v57, v56, s[12:13] sc1
    s_waitcnt vmcnt(0)
    v_cmp_gt_u32 vcc, 128, v57
    s_add_u32 s93, s93, 1
    s_cmp_lt_u32 s93, 0x80000
    s_cselect_b64 vcc, vcc, 0
    s_cbranch_vccz L_tl_wo_127
    s_sleep 12
    s_branch L_tl_w_126
L_tl_wo_127:
    s_waitcnt vmcnt(0)
    s_barrier
    s_mov_b32 s71, 1
L_tl_drs_125:
    s_add_u32 s68, s68, 1
    s_cmp_lg_u32 s14, 0
    s_cbranch_scc1 L_tl_wo_129
    s_lshl_b32 s63, s16, 5
    v_and_b32 v56, 31, v1
    v_add_u32 v56, s63, v56
    s_mov_b32 s63, 0x5800000
L_tl_w_128:
    buffer_load_ubyte v57, v56, s[4:7], s63 offen sc1
    s_waitcnt vmcnt(0)
    v_cmp_gt_u32 vcc, s68, v57
    s_add_u32 s93, s93, 1
    s_cmp_lt_u32 s93, 0x80000
    s_cselect_b64 vcc, vcc, 0
    s_cbranch_vccz L_tl_wo_129
    s_sleep 12
    s_branch L_tl_w_128
L_tl_wo_129:
    s_waitcnt vmcnt(0)
    s_barrier
    s_lshl_b32 s63, s17, 15
    s_lshl_b32 s64, s69, 20
    s_add_u32 s63, s63, s64
    s_lshl_b32 s64, s14, 13
    s_add_u32 s63, s63, s64
    s_add_u32 s63, s63, 0x6000000
    s_add_u32 s64, s63, 4096
    buffer_load_dwordx4 v[64:67], v13, s[4:7], s63 offen offset:0 sc1
    buffer_load_dwordx4 v[68:71], v13, s[4:7], s63 offen offset:1024 sc1
    buffer_load_dwordx4 v[72:75], v13, s[4:7], s63 offen offset:2048 sc1
    buffer_load_dwordx4 v[76:79], v13, s[4:7], s63 offen offset:3072 sc1
    buffer_load_dwordx4 v[80:83], v13, s[4:7], s64 offen offset:0 sc1
    buffer_load_dwordx4 v[84:87], v13, s[4:7], s64 offen offset:1024 sc1
    buffer_load_dwordx4 v[88:91], v13, s[4:7], s64 offen offset:2048 sc1
    buffer_load_dwordx4 v[92:95], v13, s[4:7], s64 offen offset:3072 sc1
    s_lshl_b32 s65, s69, 5
    s_add_u32 s65, s65, s17
    s_lshl_b32 s65, s65, 10
    buffer_load_dwordx4 v[40:43], v13, s[36:39], s65 offen
    buffer_load_dwordx4 v[44:47], v13, s[44:47], 0 offen
    buffer_load_dwordx2 v[48:49], v15, s[36:39], s65 offen
    s_lshr_b32 s66, s65, 7
    s_add_u32 s66, s66, 0x5000000
    v_lshlrev_b32 v56, 11, v15
    buffer_load_dwordx2 v[50:51], v56, s[4:7], s66 offen sc1
    buffer_load_dwordx2 v[52:53], v15, s[48:51], 0 offen
    s_waitcnt vmcnt(0)
    v_lshrrev_b32 v57, 1, v2
    v_cmp_eq_u32 vcc, 0, v57
    s_nop 1
    v_cndmask_b32 v16, 0, v14, vcc
    v_cmp_eq_u32 vcc, 1, v57
    s_nop 1
    v_cndmask_b32 v17, 0, v14, vcc
    v_cmp_eq_u32 vcc, 2, v57
    s_nop 1
    v_cndmask_b32 v18, 0, v14, vcc
    v_cmp_eq_u32 vcc, 3, v57
    s_nop 1
    v_cndmask_b32 v19, 0, v14, vcc
    s_nop 1
    v_mfma_f32_16x16x32_bf16 v[20:23], v[16:19], v[64:67], 0
    v_mfma_f32_16x16x32_bf16 v[20:23], v[16:19], v[68:71], v[20:23]
    v_mfma_f32_16x16x32_bf16 v[20:23], v[16:19], v[72:75], v[20:23]
    v_mfma_f32_16x16x32_bf16 v[20:23], v[16:19], v[76:79], v[20:23]
    v_mfma_f32_16x16x32_bf16 v[20:23], v[16:19], v[80:83], v[20:23]
    v_mfma_f32_16x16x32_bf16 v[20:23], v[16:19], v[84:87], v[20:23]
    v_mfma_f32_16x16x32_bf16 v[20:23], v[16:19], v[88:91], v[20:23]
    v_mfma_f32_16x16x32_bf16 v[20:23], v[16:19], v[92:95], v[20:23]
    v_lshlrev_b32 v24, 16, v40
    v_and_b32 v25, 0xffff0000, v40
    v_lshlrev_b32 v26, 16, v44
    v_and_b32 v27, 0xffff0000, v44
    v_mul_f32 v24, v24, v26
    v_mul_f32 v25, v25, v27
    v_cvt_pk_bf16_f32 v24, v24, v25
    v_lshlrev_b32 v25, 16, v24
    v_and_b32 v24, 0xffff0000, v24
    v_add_f32 v24, v24, v25
    v_mov_b32 v28, v24
    v_lshlrev_b32 v24, 16, v41
    v_and_b32 v25, 0xffff0000, v41
    v_lshlrev_b32 v26, 16, v45
    v_and_b32 v27, 0xffff0000, v45
    v_mul_f32 v24, v24, v26
    v_mul_f32 v25, v25, v27
    v_cvt_pk_bf16_f32 v24, v24, v25
    v_lshlrev_b32 v25, 16, v24
    v_and_b32 v24, 0xffff0000, v24
    v_add_f32 v24, v24, v25
    v_add_f32 v28, v28, v24
    v_lshlrev_b32 v24, 16, v42
    v_and_b32 v25, 0xffff0000, v42
    v_lshlrev_b32 v26, 16, v46
    v_and_b32 v27, 0xffff0000, v46
    v_mul_f32 v24, v24, v26
    v_mul_f32 v25, v25, v27
    v_cvt_pk_bf16_f32 v24, v24, v25
    v_lshlrev_b32 v25, 16, v24
    v_and_b32 v24, 0xffff0000, v24
    v_add_f32 v24, v24, v25
    v_add_f32 v28, v28, v24
    v_lshlrev_b32 v24, 16, v43
    v_and_b32 v25, 0xffff0000, v43
    v_lshlrev_b32 v26, 16, v47
    v_and_b32 v27, 0xffff0000, v47
    v_mul_f32 v24, v24, v26
    v_mul_f32 v25, v25, v27
    v_cvt_pk_bf16_f32 v24, v24, v25
    v_lshlrev_b32 v25, 16, v24
    v_and_b32 v24, 0xffff0000, v24
    v_add_f32 v24, v24, v25
    v_add_f32 v28, v28, v24
    s_nop 1
    v_add_f32_dpp v28, v28, v28 quad_perm:[1,0,3,2] row_mask:0xf bank_mask:0xf
    s_nop 1
    v_add_f32_dpp v28, v28, v28 quad_perm:[2,3,0,1] row_mask:0xf bank_mask:0xf
    s_nop 1
    v_add_f32_dpp v28, v28, v28 row_ror:4 row_mask:0xf bank_mask:0xf
    s_nop 1
    v_add_f32_dpp v28, v28, v28 row_ror:8 row_mask:0xf bank_mask:0xf
    v_mov_b32 v24, v28
    s_nop 1
    v_permlane32_swap_b32 v24, v28
    v_add_f32 v28, v28, v24
    v_mov_b32 v24, v28
    s_nop 1
    v_permlane16_swap_b32 v24, v28
    v_add_f32 v28, v28, v24
    v_cvt_pk_bf16_f32 v28, v28, v28
    v_lshlrev_b32 v28, 16, v28
    v_mul_f32 v28, 0xbfb8aa3b, v28
    v_exp_f32 v28, v28
    s_nop 0
    v_add_f32 v28, 1.0, v28
    v_rcp_f32 v28, v28
    s_nop 0
    v_cvt_pk_bf16_f32 v28, v28, v28
    v_lshlrev_b32 v28, 16, v28
    v_sub_f32 v29, 1.0, v28
    v_cvt_pk_bf16_f32 v29, v29, v29
    v_lshlrev_b32 v29, 16, v29
    v_cvt_pk_bf16_f32 v24, v20, v21
    v_lshlrev_b32 v25, 16, v24
    v_and_b32 v24, 0xffff0000, v24
    v_mul_f32 v25, v28, v25
    v_mul_f32 v24, v28, v24
    v_cvt_pk_bf16_f32 v20, v25, v24
    v_lshlrev_b32 v24, 16, v48
    v_and_b32 v25, 0xffff0000, v48
    v_lshlrev_b32 v26, 16, v52
    v_and_b32 v27, 0xffff0000, v52
    v_mul_f32 v24, v24, v26
    v_mul_f32 v25, v25, v27
    v_cvt_pk_bf16_f32 v24, v24, v25
    v_lshlrev_b32 v25, 16, v24
    v_and_b32 v24, 0xffff0000, v24
    v_lshlrev_b32 v26, 16, v50
    v_and_b32 v27, 0xffff0000, v50
    v_add_f32 v25, v25, v26
    v_add_f32 v24, v24, v27
    v_cvt_pk_bf16_f32 v24, v25, v24
    v_lshlrev_b32 v25, 16, v24
    v_and_b32 v24, 0xffff0000, v24
    v_mul_f32 v25, v29, v25
    v_mul_f32 v24, v29, v24
    v_cvt_pk_bf16_f32 v24, v25, v24
    v_lshlrev_b32 v25, 16, v24
    v_and_b32 v24, 0xffff0000, v24
    v_lshlrev_b32 v26, 16, v20
    v_and_b32 v27, 0xffff0000, v20
    v_add_f32 v25, v25, v26
    v_add_f32 v24, v24, v27
    v_cvt_pk_bf16_f32 v40, v25, v24
    v_cvt_pk_bf16_f32 v24, v22, v23
    v_lshlrev_b32 v25, 16, v24
    v_and_b32 v24, 0xffff0000, v24
    v_mul_f32 v25, v28, v25
    v_mul_f32 v24, v28, v24
    v_cvt_pk_bf16_f32 v22, v25, v24
    v_lshlrev_b32 v24, 16, v49
    v_and_b32 v25, 0xffff0000, v49
    v_lshlrev_b32 v26, 16, v53
    v_and_b32 v27, 0xffff0000, v53
    v_mul_f32 v24, v24, v26
    v_mul_f32 v25, v25, v27
    v_cvt_pk_bf16_f32 v24, v24, v25
    v_lshlrev_b32 v25, 16, v24
    v_and_b32 v24, 0xffff0000, v24
    v_lshlrev_b32 v26, 16, v51
    v_and_b32 v27, 0xffff0000, v51
    v_add_f32 v25, v25, v26
    v_add_f32 v24, v24, v27
    v_cvt_pk_bf16_f32 v24, v25, v24
    v_lshlrev_b32 v25, 16, v24
    v_and_b32 v24, 0xffff0000, v24
    v_mul_f32 v25, v29, v25
    v_mul_f32 v24, v29, v24
    v_cvt_pk_bf16_f32 v24, v25, v24
    v_lshlrev_b32 v25, 16, v24
    v_and_b32 v24, 0xffff0000, v24
    v_lshlrev_b32 v26, 16, v22
    v_and_b32 v27, 0xffff0000, v22
    v_add_f32 v25, v25, v26
    v_add_f32 v24, v24, v27
    v_cvt_pk_bf16_f32 v41, v25, v24
    s_mov_b32 exec_hi, 0
    buffer_store_dwordx2 v[40:41], v15, s[40:43], s65 offen
    s_mov_b32 exec_hi, -1
    s_add_u32 s74, s16, 28
    s_cmp_lt_u32 s69, 24
    s_cselect_b32 s75, 4, 7
    s_add_u32 s75, s69, s75
    s_sub_u32 s76, s69, 24
    s_cmp_lt_u32 s76, 4
    s_cselect_b32 s69, s74, s75
    s_branch L_tl_dr_123
L_tl_dro_124:
L_tl_sp_121:
    s_cmp_lg_u32 s14, 0
    s_cbranch_scc1 L_tl_rf_130
    s_lshl_b32 s63, s17, 7
    s_add_u32 s63, s63, 0x5810000
    v_mov_b32 v56, 8
    buffer_load_ubyte v58, v56, s[4:7], s63 offen sc1
    v_mov_b32 v56, 44
    s_cmp_lg_u32 s71, 0
    s_cbranch_scc1 L_tl_rf_130_s
    global_load_dword v59, v56, s[12:13] sc1
L_tl_rf_130_s:
    v_mov_b32 v56, 41472
    s_waitcnt vmcnt(0)
    ds_write_b64 v56, v[58:59]
    s_waitcnt lgkmcnt(0)
L_tl_rf_130:
    s_waitcnt vmcnt(0)
    s_barrier
    v_mov_b32 v56, 41472
    ds_read_b64 v[58:59], v56
    s_waitcnt lgkmcnt(0)
    v_readfirstlane_b32 s70, v58
    v_readfirstlane_b32 s63, v59
    s_cmp_ge_u32 s63, 128
    s_cselect_b32 s71, 1, s71
    s_barrier
    s_cmp_ge_u32 s70, s72
    s_cbranch_scc1 L_tl_go_120
    s_add_u32 s93, s93, 1
    s_cmp_ge_u32 s93, 0x80000
    s_cbranch_scc1 L_tl_go_120
    s_sleep 12
    s_branch L_tl_sp_121
L_tl_go_120:
    s_lshl_b32 s61, s56, 16
    s_lshl_b32 s60, s56, 18
    buffer_load_dwordx4 v[40:43], v6, s[4:7], s60 offen offset:0
    buffer_load_dwordx4 v[44:47], v6, s[4:7], s60 offen offset:64
    buffer_load_dwordx4 v[48:51], v6, s[4:7], s60 offen offset:2048
    buffer_load_dwordx4 v[52:55], v6, s[4:7], s60 offen offset:2112
L_tl_kl_131:
    buffer_load_dwordx4 v[16:19], v7, s[4:7], s61 offen offset:0 sc1
    buffer_load_dwordx4 v[20:23], v7, s[4:7], s61 offen offset:64 sc1
    buffer_load_dwordx4 v[24:27], v7, s[4:7], s61 offen offset:128 sc1
    buffer_load_dwordx4 v[28:31], v7, s[4:7], s61 offen offset:192 sc1
    buffer_load_dwordx2 v[32:33], v8, s[4:7], s61 offen offset:0 sc1
    buffer_load_dwordx2 v[34:35], v8, s[4:7], s61 offen offset:16 sc1
    buffer_load_dwordx2 v[36:37], v8, s[4:7], s61 offen offset:512 sc1
    buffer_load_dwordx2 v[38:39], v8, s[4:7], s61 offen offset:528 sc1
    s_cmp_lt_u32 s56, 60
    s_cbranch_scc1 L_tl_ko_132
    s_waitcnt vmcnt(0)
    v_max3_u32 v56, v16, v20, v24
    v_max3_u32 v56, v56, v28, v32
    v_max3_u32 v56, v56, v34, v36
    v_max_u32 v56, v56, v38
    v_cmp_eq_u32 vcc, -1, v56
    s_add_u32 s93, s93, 1
    s_cmp_lt_u32 s93, 0x80000
    s_cselect_b64 vcc, vcc, 0
    s_cbranch_vccz L_tl_ko_132
    s_sleep 2
    s_branch L_tl_kl_131
L_tl_ko_132:
    s_waitcnt vmcnt(12)
    s_barrier
    v_add_u32 v56, s55, v5
    ds_read_b128 v[80:83], v56 offset:24576
    ds_read_b128 v[96:99], v5 offset:16384
    ds_read_b128 v[112:115], v5 offset:20480
    v_xor_b32 v57, 64, v5
    v_xor_b32 v58, 64, v56
    ds_read_b128 v[84:87], v58 offset:24576
    ds_read_b128 v[100:103], v57 offset:16384
    ds_read_b128 v[116:119], v57 offset:20480
    v_xor_b32 v57, 128, v5
    v_xor_b32 v58, 128, v56
    ds_read_b128 v[88:91], v58 offset:24576
    ds_read_b128 v[104:107], v57 offset:16384
    ds_read_b128 v[120:123], v57 offset:20480
    v_xor_b32 v57, 192, v5
    v_xor_b32 v58, 192, v56
    ds_read_b128 v[92:95], v58 offset:24576
    ds_read_b128 v[108:111], v57 offset:16384
    ds_read_b128 v[124:127], v57 offset:20480
    s_waitcnt lgkmcnt(9)
    v_mfma_f32_16x16x32_bf16 v[68:71], v[96:99], v[80:83], 0
    v_mfma_f32_16x16x32_bf16 v[72:75], v[112:115], v[80:83], 0
    s_waitcnt lgkmcnt(6)
    v_mfma_f32_16x16x32_bf16 v[68:71], v[100:103], v[84:87], v[68:71]
    v_mfma_f32_16x16x32_bf16 v[72:75], v[116:119], v[84:87], v[72:75]
    s_waitcnt lgkmcnt(3)
    v_mfma_f32_16x16x32_bf16 v[68:71], v[104:107], v[88:91], v[68:71]
    v_mfma_f32_16x16x32_bf16 v[72:75], v[120:123], v[88:91], v[72:75]
    s_waitcnt lgkmcnt(0)
    v_mfma_f32_16x16x32_bf16 v[68:71], v[108:111], v[92:95], v[68:71]
    v_mfma_f32_16x16x32_bf16 v[72:75], v[124:127], v[92:95], v[72:75]
    s_waitcnt vmcnt(4)
    v_mfma_f32_16x16x32_bf16 v[64:67], v[16:19], v[80:83], 0
    v_mfma_f32_16x16x32_bf16 v[64:67], v[20:23], v[84:87], v[64:67]
    v_mfma_f32_16x16x32_bf16 v[64:67], v[24:27], v[88:91], v[64:67]
    v_mfma_f32_16x16x32_bf16 v[64:67], v[28:31], v[92:95], v[64:67]
    v_mov_b32 v57, s53
    v_cmp_le_i32 vcc, 0, v12
    s_nop 1
    v_cndmask_b32 v68, v57, v68, vcc
    v_cmp_le_i32 vcc, 1, v12
    s_nop 1
    v_cndmask_b32 v69, v57, v69, vcc
    v_cmp_le_i32 vcc, 2, v12
    s_nop 1
    v_cndmask_b32 v70, v57, v70, vcc
    v_cmp_le_i32 vcc, 3, v12
    s_nop 1
    v_cndmask_b32 v71, v57, v71, vcc
    v_cmp_le_i32 vcc, 16, v12
    s_nop 1
    v_cndmask_b32 v72, v57, v72, vcc
    v_cmp_le_i32 vcc, 17, v12
    s_nop 1
    v_cndmask_b32 v73, v57, v73, vcc
    v_cmp_le_i32 vcc, 18, v12
    s_nop 1
    v_cndmask_b32 v74, v57, v74, vcc
    v_cmp_le_i32 vcc, 19, v12
    s_nop 1
    v_cndmask_b32 v75, v57, v75, vcc
    v_cmp_gt_u32 vcc, 2, v3
    s_nop 1
    v_cndmask_b32 v64, v57, v64, vcc
    v_cndmask_b32 v65, v57, v65, vcc
    v_cndmask_b32 v66, v57, v66, vcc
    v_cndmask_b32 v67, v57, v67, vcc
    v_max3_f32 v76, v64, v65, v66
    v_max3_f32 v77, v67, v68, v69
    v_max3_f32 v76, v76, v70, v71
    v_max3_f32 v77, v77, v72, v73
    v_max3_f32 v76, v76, v74, v75
    v_max_f32 v76, v76, v77
    v_mov_b32 v77, v76
    s_nop 1
    v_permlane32_swap_b32 v77, v76
    v_max_f32 v76, v76, v77
    v_mov_b32 v77, v76
    s_nop 1
    v_permlane16_swap_b32 v77, v76
    v_max_f32 v76, v76, v77
    v_mul_f32 v76, s52, v76
    v_fma_f32 v64, v64, s52, -v76
    v_fma_f32 v65, v65, s52, -v76
    v_fma_f32 v66, v66, s52, -v76
    v_fma_f32 v67, v67, s52, -v76
    v_fma_f32 v68, v68, s52, -v76
    v_fma_f32 v69, v69, s52, -v76
    v_fma_f32 v70, v70, s52, -v76
    v_fma_f32 v71, v71, s52, -v76
    v_fma_f32 v72, v72, s52, -v76
    v_fma_f32 v73, v73, s52, -v76
    v_fma_f32 v74, v74, s52, -v76
    v_fma_f32 v75, v75, s52, -v76
    v_exp_f32 v64, v64
    v_exp_f32 v65, v65
    v_exp_f32 v66, v66
    v_exp_f32 v67, v67
    v_exp_f32 v68, v68
    v_exp_f32 v69, v69
    v_exp_f32 v70, v70
    v_exp_f32 v71, v71
    v_exp_f32 v72, v72
    v_exp_f32 v73, v73
    v_exp_f32 v74, v74
    v_exp_f32 v75, v75
    s_nop 0
    v_add_f32 v78, v64, v65
    v_add_f32 v77, v66, v67
    v_add_f32 v79, v68, v69
    v_add_f32 v76, v70, v71
    v_add_f32 v78, v78, v77
    v_add_f32 v77, v72, v73
    v_add_f32 v79, v79, v76
    v_add_f32 v76, v74, v75
    v_add_f32 v78, v78, v77
    v_add_f32 v79, v79, v76
    v_add_f32 v78, v78, v79
    v_mov_b32 v77, v78
    s_nop 1
    v_permlane32_swap_b32 v77, v78
    v_add_f32 v78, v78, v77
    v_mov_b32 v77, v78
    s_nop 1
    v_permlane16_swap_b32 v77, v78
    v_add_f32 v78, v78, v77
    v_rcp_f32 v78, v78
    s_nop 0
    v_mul_f32 v64, v64, v78
    v_mul_f32 v65, v65, v78
    v_mul_f32 v66, v66, v78
    v_mul_f32 v67, v67, v78
    v_mul_f32 v68, v68, v78
    v_mul_f32 v69, v69, v78
    v_mul_f32 v70, v70, v78
    v_mul_f32 v71, v71, v78
    v_mul_f32 v72, v72, v78
    v_mul_f32 v73, v73, v78
    v_mul_f32 v74, v74, v78
    v_mul_f32 v75, v75, v78
    v_cvt_pk_bf16_f32 v80, v68, v69
    v_cvt_pk_bf16_f32 v81, v70, v71
    v_cvt_pk_bf16_f32 v82, v72, v73
    v_cvt_pk_bf16_f32 v83, v74, v75
    v_cvt_pk_bf16_f32 v84, v64, v65
    v_cvt_pk_bf16_f32 v85, v66, v67
    s_waitcnt vmcnt(0)
    v_mfma_f32_16x16x32_bf16 v[96:99], v[40:43], v[80:83], 0
    v_mfma_f32_16x16x32_bf16 v[100:103], v[44:47], v[80:83], 0
    v_mfma_f32_16x16x32_bf16 v[104:107], v[48:51], v[80:83], 0
    v_mfma_f32_16x16x32_bf16 v[108:111], v[52:55], v[80:83], 0
    v_mfma_f32_16x16x16_bf16 v[96:99], v[32:33], v[84:85], v[96:99]
    v_mfma_f32_16x16x16_bf16 v[100:103], v[34:35], v[84:85], v[100:103]
    v_mfma_f32_16x16x16_bf16 v[104:107], v[36:37], v[84:85], v[104:107]
    v_mfma_f32_16x16x16_bf16 v[108:111], v[38:39], v[84:85], v[108:111]
    s_add_u32 s74, s16, 28
    s_cmp_lt_u32 s56, 24
    s_cselect_b32 s75, 4, 7
    s_add_u32 s75, s56, s75
    s_sub_u32 s76, s56, 24
    s_cmp_lt_u32 s76, 4
    s_cselect_b32 s67, s74, s75
    s_cmp_ge_u32 s67, 64
    s_cbranch_scc1 L_tl_nx_133
    s_lshl_b32 s58, s67, 13
    s_add_u32 s59, s58, 0x1000000
    s_add_u32 m0, s54, 0
    s_lshl_b32 s60, s67, 18
    buffer_load_dwordx4 v4, s[4:7], s59 offen lds
    buffer_load_dwordx4 v4, s[4:7], s59 offen offset:1024 lds
    s_add_u32 m0, s54, 8192
    s_nop 0
    buffer_load_dwordx4 v4, s[4:7], s58 offen lds
    buffer_load_dwordx4 v4, s[4:7], s58 offen offset:1024 lds
L_tl_nx_133:
    s_nop 4
    v_cvt_pk_bf16_f32 v64, v96, v100
    v_cvt_pk_bf16_f32 v65, v97, v101
    v_cvt_pk_bf16_f32 v66, v98, v102
    v_cvt_pk_bf16_f32 v67, v99, v103
    ds_write_b128 v9, v[64:67] offset:0
    v_cvt_pk_bf16_f32 v68, v104, v108
    v_cvt_pk_bf16_f32 v69, v105, v109
    v_cvt_pk_bf16_f32 v70, v106, v110
    v_cvt_pk_bf16_f32 v71, v107, v111
    ds_write_b128 v9, v[68:71] offset:64
    s_waitcnt lgkmcnt(0)
    s_barrier
    ds_read_b128 v[16:19], v10 offset:0
    ds_read_b128 v[20:23], v10 offset:64
    ds_read_b128 v[24:27], v10 offset:128
    ds_read_b128 v[28:31], v10 offset:192
    ds_read_b128 v[32:35], v10 offset:4352
    ds_read_b128 v[36:39], v10 offset:4416
    ds_read_b128 v[40:43], v10 offset:4480
    ds_read_b128 v[44:47], v10 offset:4544
    s_lshl_b32 s62, s56, 20
    s_waitcnt lgkmcnt(7)
    v_mfma_f32_16x16x32_bf16 v[64:67], v[16:19], a[0:3], 0
    v_mfma_f32_16x16x32_bf16 v[68:71], v[16:19], a[16:19], 0
    v_mfma_f32_16x16x32_bf16 v[72:75], v[16:19], a[32:35], 0
    v_mfma_f32_16x16x32_bf16 v[76:79], v[16:19], a[48:51], 0
    v_mfma_f32_16x16x32_bf16 v[80:83], v[16:19], a[64:67], 0
    v_mfma_f32_16x16x32_bf16 v[84:87], v[16:19], a[80:83], 0
    v_mfma_f32_16x16x32_bf16 v[88:91], v[16:19], a[96:99], 0
    v_mfma_f32_16x16x32_bf16 v[92:95], v[16:19], a[112:115], 0
    s_waitcnt lgkmcnt(6)
    v_mfma_f32_16x16x32_bf16 v[64:67], v[20:23], a[4:7], v[64:67]
    v_mfma_f32_16x16x32_bf16 v[68:71], v[20:23], a[20:23], v[68:71]
    v_mfma_f32_16x16x32_bf16 v[72:75], v[20:23], a[36:39], v[72:75]
    v_mfma_f32_16x16x32_bf16 v[76:79], v[20:23], a[52:55], v[76:79]
    v_mfma_f32_16x16x32_bf16 v[80:83], v[20:23], a[68:71], v[80:83]
    v_mfma_f32_16x16x32_bf16 v[84:87], v[20:23], a[84:87], v[84:87]
    v_mfma_f32_16x16x32_bf16 v[88:91], v[20:23], a[100:103], v[88:91]
    v_mfma_f32_16x16x32_bf16 v[92:95], v[20:23], a[116:119], v[92:95]
    s_waitcnt lgkmcnt(5)
    v_mfma_f32_16x16x32_bf16 v[64:67], v[24:27], a[8:11], v[64:67]
    v_mfma_f32_16x16x32_bf16 v[68:71], v[24:27], a[24:27], v[68:71]
    v_mfma_f32_16x16x32_bf16 v[72:75], v[24:27], a[40:43], v[72:75]
    v_mfma_f32_16x16x32_bf16 v[76:79], v[24:27], a[56:59], v[76:79]
    v_mfma_f32_16x16x32_bf16 v[80:83], v[24:27], a[72:75], v[80:83]
    v_mfma_f32_16x16x32_bf16 v[84:87], v[24:27], a[88:91], v[84:87]
    v_mfma_f32_16x16x32_bf16 v[88:91], v[24:27], a[104:107], v[88:91]
    v_mfma_f32_16x16x32_bf16 v[92:95], v[24:27], a[120:123], v[92:95]
    s_waitcnt lgkmcnt(4)
    v_mfma_f32_16x16x32_bf16 v[64:67], v[28:31], a[12:15], v[64:67]
    v_mfma_f32_16x16x32_bf16 v[68:71], v[28:31], a[28:31], v[68:71]
    v_mfma_f32_16x16x32_bf16 v[72:75], v[28:31], a[44:47], v[72:75]
    v_mfma_f32_16x16x32_bf16 v[76:79], v[28:31], a[60:63], v[76:79]
    v_mfma_f32_16x16x32_bf16 v[80:83], v[28:31], a[76:79], v[80:83]
    v_mfma_f32_16x16x32_bf16 v[84:87], v[28:31], a[92:95], v[84:87]
    v_mfma_f32_16x16x32_bf16 v[88:91], v[28:31], a[108:111], v[88:91]
    v_mfma_f32_16x16x32_bf16 v[92:95], v[28:31], a[124:127], v[92:95]
    s_waitcnt lgkmcnt(3)
    v_mfma_f32_16x16x32_bf16 v[96:99], v[32:35], a[0:3], 0
    v_mfma_f32_16x16x32_bf16 v[100:103], v[32:35], a[16:19], 0
    v_mfma_f32_16x16x32_bf16 v[104:107], v[32:35], a[32:35], 0
    v_mfma_f32_16x16x32_bf16 v[108:111], v[32:35], a[48:51], 0
    v_mfma_f32_16x16x32_bf16 v[112:115], v[32:35], a[64:67], 0
    v_mfma_f32_16x16x32_bf16 v[116:119], v[32:35], a[80:83], 0
    v_mfma_f32_16x16x32_bf16 v[120:123], v[32:35], a[96:99], 0
    v_mfma_f32_16x16x32_bf16 v[124:127], v[32:35], a[112:115], 0
    s_waitcnt lgkmcnt(2)
    v_mfma_f32_16x16x32_bf16 v[96:99], v[36:39], a[4:7], v[96:99]
    v_mfma_f32_16x16x32_bf16 v[100:103], v[36:39], a[20:23], v[100:103]
    v_mfma_f32_16x16x32_bf16 v[104:107], v[36:39], a[36:39], v[104:107]
    v_mfma_f32_16x16x32_bf16 v[108:111], v[36:39], a[52:55], v[108:111]
    v_mfma_f32_16x16x32_bf16 v[112:115], v[36:39], a[68:71], v[112:115]
    v_mfma_f32_16x16x32_bf16 v[116:119], v[36:39], a[84:87], v[116:119]
    v_mfma_f32_16x16x32_bf16 v[120:123], v[36:39], a[100:103], v[120:123]
    v_mfma_f32_16x16x32_bf16 v[124:127], v[36:39], a[116:119], v[124:127]
    s_waitcnt lgkmcnt(1)
    v_mfma_f32_16x16x32_bf16 v[96:99], v[40:43], a[8:11], v[96:99]
    v_mfma_f32_16x16x32_bf16 v[100:103], v[40:43], a[24:27], v[100:103]
    v_mfma_f32_16x16x32_bf16 v[104:107], v[40:43], a[40:43], v[104:107]
    v_mfma_f32_16x16x32_bf16 v[108:111], v[40:43], a[56:59], v[108:111]
    v_mfma_f32_16x16x32_bf16 v[112:115], v[40:43], a[72:75], v[112:115]
    v_mfma_f32_16x16x32_bf16 v[116:119], v[40:43], a[88:91], v[116:119]
    v_mfma_f32_16x16x32_bf16 v[120:123], v[40:43], a[104:107], v[120:123]
    v_mfma_f32_16x16x32_bf16 v[124:127], v[40:43], a[120:123], v[124:127]
    s_waitcnt lgkmcnt(0)
    v_mfma_f32_16x16x32_bf16 v[96:99], v[44:47], a[12:15], v[96:99]
    v_mfma_f32_16x16x32_bf16 v[100:103], v[44:47], a[28:31], v[100:103]
    v_mfma_f32_16x16x32_bf16 v[104:107], v[44:47], a[44:47], v[104:107]
    v_mfma_f32_16x16x32_bf16 v[108:111], v[44:47], a[60:63], v[108:111]
    v_mfma_f32_16x16x32_bf16 v[112:115], v[44:47], a[76:79], v[112:115]
    v_mfma_f32_16x16x32_bf16 v[116:119], v[44:47], a[92:95], v[116:119]
    v_mfma_f32_16x16x32_bf16 v[120:123], v[44:47], a[108:111], v[120:123]
    v_mfma_f32_16x16x32_bf16 v[124:127], v[44:47], a[124:127], v[124:127]
    s_nop 7
    v_cvt_pk_bf16_f32 v16, v64, v68
    v_cvt_pk_bf16_f32 v17, v72, v76
    v_cvt_pk_bf16_f32 v18, v80, v84
    v_cvt_pk_bf16_f32 v19, v88, v92
    s_add_u32 s63, s62, 0
    v_min_u32 v16, -2, v16
    buffer_store_dwordx4 v[16:19], v11, s[4:7], s63 offen sc1
    v_cvt_pk_bf16_f32 v20, v65, v69
    v_cvt_pk_bf16_f32 v21, v73, v77
    v_cvt_pk_bf16_f32 v22, v81, v85
    v_cvt_pk_bf16_f32 v23, v89, v93
    s_add_u32 s63, s62, 32768
    v_min_u32 v20, -2, v20
    buffer_store_dwordx4 v[20:23], v11, s[4:7], s63 offen sc1
    v_cvt_pk_bf16_f32 v24, v66, v70
    v_cvt_pk_bf16_f32 v25, v74, v78
    v_cvt_pk_bf16_f32 v26, v82, v86
    v_cvt_pk_bf16_f32 v27, v90, v94
    s_add_u32 s63, s62, 65536
    v_min_u32 v24, -2, v24
    buffer_store_dwordx4 v[24:27], v11, s[4:7], s63 offen sc1
    v_cvt_pk_bf16_f32 v28, v67, v71
    v_cvt_pk_bf16_f32 v29, v75, v79
    v_cvt_pk_bf16_f32 v30, v83, v87
    v_cvt_pk_bf16_f32 v31, v91, v95
    s_add_u32 s63, s62, 98304
    v_min_u32 v28, -2, v28
    buffer_store_dwordx4 v[28:31], v11, s[4:7], s63 offen sc1
    v_cvt_pk_bf16_f32 v16, v96, v100
    v_cvt_pk_bf16_f32 v17, v104, v108
    v_cvt_pk_bf16_f32 v18, v112, v116
    v_cvt_pk_bf16_f32 v19, v120, v124
    s_add_u32 s63, s62, 524288
    v_min_u32 v16, -2, v16
    buffer_store_dwordx4 v[16:19], v11, s[4:7], s63 offen sc1
    v_cvt_pk_bf16_f32 v20, v97, v101
    v_cvt_pk_bf16_f32 v21, v105, v109
    v_cvt_pk_bf16_f32 v22, v113, v117
    v_cvt_pk_bf16_f32 v23, v121, v125
    s_add_u32 s63, s62, 557056
    v_min_u32 v20, -2, v20
    buffer_store_dwordx4 v[20:23], v11, s[4:7], s63 offen sc1
    v_cvt_pk_bf16_f32 v24, v98, v102
    v_cvt_pk_bf16_f32 v25, v106, v110
    v_cvt_pk_bf16_f32 v26, v114, v118
    v_cvt_pk_bf16_f32 v27, v122, v126
    s_add_u32 s63, s62, 589824
    v_min_u32 v24, -2, v24
    buffer_store_dwordx4 v[24:27], v11, s[4:7], s63 offen sc1
    v_cvt_pk_bf16_f32 v28, v99, v103
    v_cvt_pk_bf16_f32 v29, v107, v111
    v_cvt_pk_bf16_f32 v30, v115, v119
    v_cvt_pk_bf16_f32 v31, v123, v127
    s_add_u32 s63, s62, 622592
    v_min_u32 v28, -2, v28
    buffer_store_dwordx4 v[28:31], v11, s[4:7], s63 offen sc1
    s_sub_u32 s64, s57, s68
    s_add_u32 s57, s57, 1
    s_mov_b32 s63, s67
    s_cmp_ge_u32 s63, 64
    s_cselect_b32 s63, s64, 1
    s_cmp_eq_u32 s63, 0
    s_cbranch_scc1 L_tl_fast_94
    s_waitcnt vmcnt(0)
    s_barrier
    s_cmp_lg_u32 s14, 0
    s_cbranch_scc1 L_tl_np_134
    s_mov_b64 exec, 1
    v_mov_b32 v56, s57
    v_mov_b32 v57, s15
    s_mov_b32 s63, 0x5800000
    buffer_store_byte v56, v57, s[4:7], s63 offen sc1
    s_mov_b64 exec, -1
L_tl_np_134:
    s_cmp_lg_u32 s71, 0
    s_cbranch_scc1 L_tl_yd_136
    s_cmp_lg_u32 s14, 0
    s_cbranch_scc1 L_tl_rf_137
    s_lshl_b32 s63, s17, 7
    s_add_u32 s63, s63, 0x5810000
    v_mov_b32 v56, 8
    buffer_load_ubyte v58, v56, s[4:7], s63 offen sc1
    v_mov_b32 v56, 44
    s_cmp_lg_u32 s71, 0
    s_cbranch_scc1 L_tl_rf_137_s
    global_load_dword v59, v56, s[12:13] sc1
L_tl_rf_137_s:
    v_mov_b32 v56, 41472
    s_waitcnt vmcnt(0)
    ds_write_b64 v56, v[58:59]
    s_waitcnt lgkmcnt(0)
L_tl_rf_137:
    s_waitcnt vmcnt(0)
    s_barrier
    v_mov_b32 v56, 41472
    ds_read_b64 v[58:59], v56
    s_waitcnt lgkmcnt(0)
    v_readfirstlane_b32 s70, v58
    v_readfirstlane_b32 s63, v59
    s_cmp_ge_u32 s63, 128
    s_cselect_b32 s71, 1, s71
    s_barrier
    s_cmp_eq_u32 s71, 0
    s_cbranch_scc1 L_tl_nd_135
L_tl_yd_136:
    s_sub_u32 s73, s57, 1
L_tl_dr_138:
    s_cmp_ge_u32 s68, s73
    s_cbranch_scc1 L_tl_dro_139
    s_cmp_lg_u32 s71, 0
    s_cbranch_scc1 L_tl_drs_140
    s_cmp_lg_u32 s14, 0
    s_cbranch_scc1 L_tl_wo_142
    v_mov_b32 v56, 44
L_tl_w_141:
    global_load_dword v57, v56, s[12:13] sc1
    s_waitcnt vmcnt(0)
    v_cmp_gt_u32 vcc, 128, v57
    s_add_u32 s93, s93, 1
    s_cmp_lt_u32 s93, 0x80000
    s_cselect_b64 vcc, vcc, 0
    s_cbranch_vccz L_tl_wo_142
    s_sleep 12
    s_branch L_tl_w_141
L_tl_wo_142:
    s_waitcnt vmcnt(0)
    s_barrier
    s_mov_b32 s71, 1
L_tl_drs_140:
    s_add_u32 s68, s68, 1
    s_cmp_lg_u32 s14, 0
    s_cbranch_scc1 L_tl_wo_144
    s_lshl_b32 s63, s16, 5
    v_and_b32 v56, 31, v1
    v_add_u32 v56, s63, v56
    s_mov_b32 s63, 0x5800000
L_tl_w_143:
    buffer_load_ubyte v57, v56, s[4:7], s63 offen sc1
    s_waitcnt vmcnt(0)
    v_cmp_gt_u32 vcc, s68, v57
    s_add_u32 s93, s93, 1
    s_cmp_lt_u32 s93, 0x80000
    s_cselect_b64 vcc, vcc, 0
    s_cbranch_vccz L_tl_wo_144
    s_sleep 12
    s_branch L_tl_w_143
L_tl_wo_144:
    s_waitcnt vmcnt(0)
    s_barrier
    s_lshl_b32 s63, s17, 15
    s_lshl_b32 s64, s69, 20
    s_add_u32 s63, s63, s64
    s_lshl_b32 s64, s14, 13
    s_add_u32 s63, s63, s64
    s_add_u32 s63, s63, 0x6000000
    s_add_u32 s64, s63, 4096
    buffer_load_dwordx4 v[64:67], v13, s[4:7], s63 offen offset:0 sc1
    buffer_load_dwordx4 v[68:71], v13, s[4:7], s63 offen offset:1024 sc1
    buffer_load_dwordx4 v[72:75], v13, s[4:7], s63 offen offset:2048 sc1
    buffer_load_dwordx4 v[76:79], v13, s[4:7], s63 offen offset:3072 sc1
    buffer_load_dwordx4 v[80:83], v13, s[4:7], s64 offen offset:0 sc1
    buffer_load_dwordx4 v[84:87], v13, s[4:7], s64 offen offset:1024 sc1
    buffer_load_dwordx4 v[88:91], v13, s[4:7], s64 offen offset:2048 sc1
    buffer_load_dwordx4 v[92:95], v13, s[4:7], s64 offen offset:3072 sc1
    s_lshl_b32 s65, s69, 5
    s_add_u32 s65, s65, s17
    s_lshl_b32 s65, s65, 10
    buffer_load_dwordx4 v[40:43], v13, s[36:39], s65 offen
    buffer_load_dwordx4 v[44:47], v13, s[44:47], 0 offen
    buffer_load_dwordx2 v[48:49], v15, s[36:39], s65 offen
    s_lshr_b32 s66, s65, 7
    s_add_u32 s66, s66, 0x5000000
    v_lshlrev_b32 v56, 11, v15
    buffer_load_dwordx2 v[50:51], v56, s[4:7], s66 offen sc1
    buffer_load_dwordx2 v[52:53], v15, s[48:51], 0 offen
    s_waitcnt vmcnt(0)
    v_lshrrev_b32 v57, 1, v2
    v_cmp_eq_u32 vcc, 0, v57
    s_nop 1
    v_cndmask_b32 v16, 0, v14, vcc
    v_cmp_eq_u32 vcc, 1, v57
    s_nop 1
    v_cndmask_b32 v17, 0, v14, vcc
    v_cmp_eq_u32 vcc, 2, v57
    s_nop 1
    v_cndmask_b32 v18, 0, v14, vcc
    v_cmp_eq_u32 vcc, 3, v57
    s_nop 1
    v_cndmask_b32 v19, 0, v14, vcc
    s_nop 1
    v_mfma_f32_16x16x32_bf16 v[20:23], v[16:19], v[64:67], 0
    v_mfma_f32_16x16x32_bf16 v[20:23], v[16:19], v[68:71], v[20:23]
    v_mfma_f32_16x16x32_bf16 v[20:23], v[16:19], v[72:75], v[20:23]
    v_mfma_f32_16x16x32_bf16 v[20:23], v[16:19], v[76:79], v[20:23]
    v_mfma_f32_16x16x32_bf16 v[20:23], v[16:19], v[80:83], v[20:23]
    v_mfma_f32_16x16x32_bf16 v[20:23], v[16:19], v[84:87], v[20:23]
    v_mfma_f32_16x16x32_bf16 v[20:23], v[16:19], v[88:91], v[20:23]
    v_mfma_f32_16x16x32_bf16 v[20:23], v[16:19], v[92:95], v[20:23]
    v_lshlrev_b32 v24, 16, v40
    v_and_b32 v25, 0xffff0000, v40
    v_lshlrev_b32 v26, 16, v44
    v_and_b32 v27, 0xffff0000, v44
    v_mul_f32 v24, v24, v26
    v_mul_f32 v25, v25, v27
    v_cvt_pk_bf16_f32 v24, v24, v25
    v_lshlrev_b32 v25, 16, v24
    v_and_b32 v24, 0xffff0000, v24
    v_add_f32 v24, v24, v25
    v_mov_b32 v28, v24
    v_lshlrev_b32 v24, 16, v41
    v_and_b32 v25, 0xffff0000, v41
    v_lshlrev_b32 v26, 16, v45
    v_and_b32 v27, 0xffff0000, v45
    v_mul_f32 v24, v24, v26
    v_mul_f32 v25, v25, v27
    v_cvt_pk_bf16_f32 v24, v24, v25
    v_lshlrev_b32 v25, 16, v24
    v_and_b32 v24, 0xffff0000, v24
    v_add_f32 v24, v24, v25
    v_add_f32 v28, v28, v24
    v_lshlrev_b32 v24, 16, v42
    v_and_b32 v25, 0xffff0000, v42
    v_lshlrev_b32 v26, 16, v46
    v_and_b32 v27, 0xffff0000, v46
    v_mul_f32 v24, v24, v26
    v_mul_f32 v25, v25, v27
    v_cvt_pk_bf16_f32 v24, v24, v25
    v_lshlrev_b32 v25, 16, v24
    v_and_b32 v24, 0xffff0000, v24
    v_add_f32 v24, v24, v25
    v_add_f32 v28, v28, v24
    v_lshlrev_b32 v24, 16, v43
    v_and_b32 v25, 0xffff0000, v43
    v_lshlrev_b32 v26, 16, v47
    v_and_b32 v27, 0xffff0000, v47
    v_mul_f32 v24, v24, v26
    v_mul_f32 v25, v25, v27
    v_cvt_pk_bf16_f32 v24, v24, v25
    v_lshlrev_b32 v25, 16, v24
    v_and_b32 v24, 0xffff0000, v24
    v_add_f32 v24, v24, v25
    v_add_f32 v28, v28, v24
    s_nop 1
    v_add_f32_dpp v28, v28, v28 quad_perm:[1,0,3,2] row_mask:0xf bank_mask:0xf
    s_nop 1
    v_add_f32_dpp v28, v28, v28 quad_perm:[2,3,0,1] row_mask:0xf bank_mask:0xf
    s_nop 1
    v_add_f32_dpp v28, v28, v28 row_ror:4 row_mask:0xf bank_mask:0xf
    s_nop 1
    v_add_f32_dpp v28, v28, v28 row_ror:8 row_mask:0xf bank_mask:0xf
    v_mov_b32 v24, v28
    s_nop 1
    v_permlane32_swap_b32 v24, v28
    v_add_f32 v28, v28, v24
    v_mov_b32 v24, v28
    s_nop 1
    v_permlane16_swap_b32 v24, v28
    v_add_f32 v28, v28, v24
    v_cvt_pk_bf16_f32 v28, v28, v28
    v_lshlrev_b32 v28, 16, v28
    v_mul_f32 v28, 0xbfb8aa3b, v28
    v_exp_f32 v28, v28
    s_nop 0
    v_add_f32 v28, 1.0, v28
    v_rcp_f32 v28, v28
    s_nop 0
    v_cvt_pk_bf16_f32 v28, v28, v28
    v_lshlrev_b32 v28, 16, v28
    v_sub_f32 v29, 1.0, v28
    v_cvt_pk_bf16_f32 v29, v29, v29
    v_lshlrev_b32 v29, 16, v29
    v_cvt_pk_bf16_f32 v24, v20, v21
    v_lshlrev_b32 v25, 16, v24
    v_and_b32 v24, 0xffff0000, v24
    v_mul_f32 v25, v28, v25
    v_mul_f32 v24, v28, v24
    v_cvt_pk_bf16_f32 v20, v25, v24
    v_lshlrev_b32 v24, 16, v48
    v_and_b32 v25, 0xffff0000, v48
    v_lshlrev_b32 v26, 16, v52
    v_and_b32 v27, 0xffff0000, v52
    v_mul_f32 v24, v24, v26
    v_mul_f32 v25, v25, v27
    v_cvt_pk_bf16_f32 v24, v24, v25
    v_lshlrev_b32 v25, 16, v24
    v_and_b32 v24, 0xffff0000, v24
    v_lshlrev_b32 v26, 16, v50
    v_and_b32 v27, 0xffff0000, v50
    v_add_f32 v25, v25, v26
    v_add_f32 v24, v24, v27
    v_cvt_pk_bf16_f32 v24, v25, v24
    v_lshlrev_b32 v25, 16, v24
    v_and_b32 v24, 0xffff0000, v24
    v_mul_f32 v25, v29, v25
    v_mul_f32 v24, v29, v24
    v_cvt_pk_bf16_f32 v24, v25, v24
    v_lshlrev_b32 v25, 16, v24
    v_and_b32 v24, 0xffff0000, v24
    v_lshlrev_b32 v26, 16, v20
    v_and_b32 v27, 0xffff0000, v20
    v_add_f32 v25, v25, v26
    v_add_f32 v24, v24, v27
    v_cvt_pk_bf16_f32 v40, v25, v24
    v_cvt_pk_bf16_f32 v24, v22, v23
    v_lshlrev_b32 v25, 16, v24
    v_and_b32 v24, 0xffff0000, v24
    v_mul_f32 v25, v28, v25
    v_mul_f32 v24, v28, v24
    v_cvt_pk_bf16_f32 v22, v25, v24
    v_lshlrev_b32 v24, 16, v49
    v_and_b32 v25, 0xffff0000, v49
    v_lshlrev_b32 v26, 16, v53
    v_and_b32 v27, 0xffff0000, v53
    v_mul_f32 v24, v24, v26
    v_mul_f32 v25, v25, v27
    v_cvt_pk_bf16_f32 v24, v24, v25
    v_lshlrev_b32 v25, 16, v24
    v_and_b32 v24, 0xffff0000, v24
    v_lshlrev_b32 v26, 16, v51
    v_and_b32 v27, 0xffff0000, v51
    v_add_f32 v25, v25, v26
    v_add_f32 v24, v24, v27
    v_cvt_pk_bf16_f32 v24, v25, v24
    v_lshlrev_b32 v25, 16, v24
    v_and_b32 v24, 0xffff0000, v24
    v_mul_f32 v25, v29, v25
    v_mul_f32 v24, v29, v24
    v_cvt_pk_bf16_f32 v24, v25, v24
    v_lshlrev_b32 v25, 16, v24
    v_and_b32 v24, 0xffff0000, v24
    v_lshlrev_b32 v26, 16, v22
    v_and_b32 v27, 0xffff0000, v22
    v_add_f32 v25, v25, v26
    v_add_f32 v24, v24, v27
    v_cvt_pk_bf16_f32 v41, v25, v24
    s_mov_b32 exec_hi, 0
    buffer_store_dwordx2 v[40:41], v15, s[40:43], s65 offen
    s_mov_b32 exec_hi, -1
    s_add_u32 s74, s16, 28
    s_cmp_lt_u32 s69, 24
    s_cselect_b32 s75, 4, 7
    s_add_u32 s75, s69, s75
    s_sub_u32 s76, s69, 24
    s_cmp_lt_u32 s76, 4
    s_cselect_b32 s69, s74, s75
    s_branch L_tl_dr_138
L_tl_dro_139:
L_tl_nd_135:
    s_add_u32 s74, s16, 28
    s_cmp_lt_u32 s56, 24
    s_cselect_b32 s75, 4, 7
    s_add_u32 s75, s56, s75
    s_sub_u32 s76, s56, 24
    s_cmp_lt_u32 s76, 4
    s_cselect_b32 s56, s74, s75
    s_cmp_ge_u32 s56, 64
    s_cbranch_scc1 L_tl_fin_93
    s_branch L_tl_loop_92
L_tl_fin_93:
    s_sub_u32 s73, s57, 1
L_tl_dr_145:
    s_cmp_ge_u32 s68, s73
    s_cbranch_scc1 L_tl_dro_146
    s_cmp_lg_u32 s71, 0
    s_cbranch_scc1 L_tl_drs_147
    s_cmp_lg_u32 s14, 0
    s_cbranch_scc1 L_tl_wo_149
    v_mov_b32 v56, 44
L_tl_w_148:
    global_load_dword v57, v56, s[12:13] sc1
    s_waitcnt vmcnt(0)
    v_cmp_gt_u32 vcc, 128, v57
    s_add_u32 s93, s93, 1
    s_cmp_lt_u32 s93, 0x80000
    s_cselect_b64 vcc, vcc, 0
    s_cbranch_vccz L_tl_wo_149
    s_sleep 12
    s_branch L_tl_w_148
L_tl_wo_149:
    s_waitcnt vmcnt(0)
    s_barrier
    s_mov_b32 s71, 1
L_tl_drs_147:
    s_add_u32 s68, s68, 1
    s_cmp_lg_u32 s14, 0
    s_cbranch_scc1 L_tl_wo_151
    s_lshl_b32 s63, s16, 5
    v_and_b32 v56, 31, v1
    v_add_u32 v56, s63, v56
    s_mov_b32 s63, 0x5800000
L_tl_w_150:
    buffer_load_ubyte v57, v56, s[4:7], s63 offen sc1
    s_waitcnt vmcnt(0)
    v_cmp_gt_u32 vcc, s68, v57
    s_add_u32 s93, s93, 1
    s_cmp_lt_u32 s93, 0x80000
    s_cselect_b64 vcc, vcc, 0
    s_cbranch_vccz L_tl_wo_151
    s_sleep 12
    s_branch L_tl_w_150
L_tl_wo_151:
    s_waitcnt vmcnt(0)
    s_barrier
    s_lshl_b32 s63, s17, 15
    s_lshl_b32 s64, s69, 20
    s_add_u32 s63, s63, s64
    s_lshl_b32 s64, s14, 13
    s_add_u32 s63, s63, s64
    s_add_u32 s63, s63, 0x6000000
    s_add_u32 s64, s63, 4096
    buffer_load_dwordx4 v[64:67], v13, s[4:7], s63 offen offset:0 sc1
    buffer_load_dwordx4 v[68:71], v13, s[4:7], s63 offen offset:1024 sc1
    buffer_load_dwordx4 v[72:75], v13, s[4:7], s63 offen offset:2048 sc1
    buffer_load_dwordx4 v[76:79], v13, s[4:7], s63 offen offset:3072 sc1
    buffer_load_dwordx4 v[80:83], v13, s[4:7], s64 offen offset:0 sc1
    buffer_load_dwordx4 v[84:87], v13, s[4:7], s64 offen offset:1024 sc1
    buffer_load_dwordx4 v[88:91], v13, s[4:7], s64 offen offset:2048 sc1
    buffer_load_dwordx4 v[92:95], v13, s[4:7], s64 offen offset:3072 sc1
    s_lshl_b32 s65, s69, 5
    s_add_u32 s65, s65, s17
    s_lshl_b32 s65, s65, 10
    buffer_load_dwordx4 v[40:43], v13, s[36:39], s65 offen
    buffer_load_dwordx4 v[44:47], v13, s[44:47], 0 offen
    buffer_load_dwordx2 v[48:49], v15, s[36:39], s65 offen
    s_lshr_b32 s66, s65, 7
    s_add_u32 s66, s66, 0x5000000
    v_lshlrev_b32 v56, 11, v15
    buffer_load_dwordx2 v[50:51], v56, s[4:7], s66 offen sc1
    buffer_load_dwordx2 v[52:53], v15, s[48:51], 0 offen
    s_waitcnt vmcnt(0)
    v_lshrrev_b32 v57, 1, v2
    v_cmp_eq_u32 vcc, 0, v57
    s_nop 1
    v_cndmask_b32 v16, 0, v14, vcc
    v_cmp_eq_u32 vcc, 1, v57
    s_nop 1
    v_cndmask_b32 v17, 0, v14, vcc
    v_cmp_eq_u32 vcc, 2, v57
    s_nop 1
    v_cndmask_b32 v18, 0, v14, vcc
    v_cmp_eq_u32 vcc, 3, v57
    s_nop 1
    v_cndmask_b32 v19, 0, v14, vcc
    s_nop 1
    v_mfma_f32_16x16x32_bf16 v[20:23], v[16:19], v[64:67], 0
    v_mfma_f32_16x16x32_bf16 v[20:23], v[16:19], v[68:71], v[20:23]
    v_mfma_f32_16x16x32_bf16 v[20:23], v[16:19], v[72:75], v[20:23]
    v_mfma_f32_16x16x32_bf16 v[20:23], v[16:19], v[76:79], v[20:23]
    v_mfma_f32_16x16x32_bf16 v[20:23], v[16:19], v[80:83], v[20:23]
    v_mfma_f32_16x16x32_bf16 v[20:23], v[16:19], v[84:87], v[20:23]
    v_mfma_f32_16x16x32_bf16 v[20:23], v[16:19], v[88:91], v[20:23]
    v_mfma_f32_16x16x32_bf16 v[20:23], v[16:19], v[92:95], v[20:23]
    v_lshlrev_b32 v24, 16, v40
    v_and_b32 v25, 0xffff0000, v40
    v_lshlrev_b32 v26, 16, v44
    v_and_b32 v27, 0xffff0000, v44
    v_mul_f32 v24, v24, v26
    v_mul_f32 v25, v25, v27
    v_cvt_pk_bf16_f32 v24, v24, v25
    v_lshlrev_b32 v25, 16, v24
    v_and_b32 v24, 0xffff0000, v24
    v_add_f32 v24, v24, v25
    v_mov_b32 v28, v24
    v_lshlrev_b32 v24, 16, v41
    v_and_b32 v25, 0xffff0000, v41
    v_lshlrev_b32 v26, 16, v45
    v_and_b32 v27, 0xffff0000, v45
    v_mul_f32 v24, v24, v26
    v_mul_f32 v25, v25, v27
    v_cvt_pk_bf16_f32 v24, v24, v25
    v_lshlrev_b32 v25, 16, v24
    v_and_b32 v24, 0xffff0000, v24
    v_add_f32 v24, v24, v25
    v_add_f32 v28, v28, v24
    v_lshlrev_b32 v24, 16, v42
    v_and_b32 v25, 0xffff0000, v42
    v_lshlrev_b32 v26, 16, v46
    v_and_b32 v27, 0xffff0000, v46
    v_mul_f32 v24, v24, v26
    v_mul_f32 v25, v25, v27
    v_cvt_pk_bf16_f32 v24, v24, v25
    v_lshlrev_b32 v25, 16, v24
    v_and_b32 v24, 0xffff0000, v24
    v_add_f32 v24, v24, v25
    v_add_f32 v28, v28, v24
    v_lshlrev_b32 v24, 16, v43
    v_and_b32 v25, 0xffff0000, v43
    v_lshlrev_b32 v26, 16, v47
    v_and_b32 v27, 0xffff0000, v47
    v_mul_f32 v24, v24, v26
    v_mul_f32 v25, v25, v27
    v_cvt_pk_bf16_f32 v24, v24, v25
    v_lshlrev_b32 v25, 16, v24
    v_and_b32 v24, 0xffff0000, v24
    v_add_f32 v24, v24, v25
    v_add_f32 v28, v28, v24
    s_nop 1
    v_add_f32_dpp v28, v28, v28 quad_perm:[1,0,3,2] row_mask:0xf bank_mask:0xf
    s_nop 1
    v_add_f32_dpp v28, v28, v28 quad_perm:[2,3,0,1] row_mask:0xf bank_mask:0xf
    s_nop 1
    v_add_f32_dpp v28, v28, v28 row_ror:4 row_mask:0xf bank_mask:0xf
    s_nop 1
    v_add_f32_dpp v28, v28, v28 row_ror:8 row_mask:0xf bank_mask:0xf
    v_mov_b32 v24, v28
    s_nop 1
    v_permlane32_swap_b32 v24, v28
    v_add_f32 v28, v28, v24
    v_mov_b32 v24, v28
    s_nop 1
    v_permlane16_swap_b32 v24, v28
    v_add_f32 v28, v28, v24
    v_cvt_pk_bf16_f32 v28, v28, v28
    v_lshlrev_b32 v28, 16, v28
    v_mul_f32 v28, 0xbfb8aa3b, v28
    v_exp_f32 v28, v28
    s_nop 0
    v_add_f32 v28, 1.0, v28
    v_rcp_f32 v28, v28
    s_nop 0
    v_cvt_pk_bf16_f32 v28, v28, v28
    v_lshlrev_b32 v28, 16, v28
    v_sub_f32 v29, 1.0, v28
    v_cvt_pk_bf16_f32 v29, v29, v29
    v_lshlrev_b32 v29, 16, v29
    v_cvt_pk_bf16_f32 v24, v20, v21
    v_lshlrev_b32 v25, 16, v24
    v_and_b32 v24, 0xffff0000, v24
    v_mul_f32 v25, v28, v25
    v_mul_f32 v24, v28, v24
    v_cvt_pk_bf16_f32 v20, v25, v24
    v_lshlrev_b32 v24, 16, v48
    v_and_b32 v25, 0xffff0000, v48
    v_lshlrev_b32 v26, 16, v52
    v_and_b32 v27, 0xffff0000, v52
    v_mul_f32 v24, v24, v26
    v_mul_f32 v25, v25, v27
    v_cvt_pk_bf16_f32 v24, v24, v25
    v_lshlrev_b32 v25, 16, v24
    v_and_b32 v24, 0xffff0000, v24
    v_lshlrev_b32 v26, 16, v50
    v_and_b32 v27, 0xffff0000, v50
    v_add_f32 v25, v25, v26
    v_add_f32 v24, v24, v27
    v_cvt_pk_bf16_f32 v24, v25, v24
    v_lshlrev_b32 v25, 16, v24
    v_and_b32 v24, 0xffff0000, v24
    v_mul_f32 v25, v29, v25
    v_mul_f32 v24, v29, v24
    v_cvt_pk_bf16_f32 v24, v25, v24
    v_lshlrev_b32 v25, 16, v24
    v_and_b32 v24, 0xffff0000, v24
    v_lshlrev_b32 v26, 16, v20
    v_and_b32 v27, 0xffff0000, v20
    v_add_f32 v25, v25, v26
    v_add_f32 v24, v24, v27
    v_cvt_pk_bf16_f32 v40, v25, v24
    v_cvt_pk_bf16_f32 v24, v22, v23
    v_lshlrev_b32 v25, 16, v24
    v_and_b32 v24, 0xffff0000, v24
    v_mul_f32 v25, v28, v25
    v_mul_f32 v24, v28, v24
    v_cvt_pk_bf16_f32 v22, v25, v24
    v_lshlrev_b32 v24, 16, v49
    v_and_b32 v25, 0xffff0000, v49
    v_lshlrev_b32 v26, 16, v53
    v_and_b32 v27, 0xffff0000, v53
    v_mul_f32 v24, v24, v26
    v_mul_f32 v25, v25, v27
    v_cvt_pk_bf16_f32 v24, v24, v25
    v_lshlrev_b32 v25, 16, v24
    v_and_b32 v24, 0xffff0000, v24
    v_lshlrev_b32 v26, 16, v51
    v_and_b32 v27, 0xffff0000, v51
    v_add_f32 v25, v25, v26
    v_add_f32 v24, v24, v27
    v_cvt_pk_bf16_f32 v24, v25, v24
    v_lshlrev_b32 v25, 16, v24
    v_and_b32 v24, 0xffff0000, v24
    v_mul_f32 v25, v29, v25
    v_mul_f32 v24, v29, v24
    v_cvt_pk_bf16_f32 v24, v25, v24
    v_lshlrev_b32 v25, 16, v24
    v_and_b32 v24, 0xffff0000, v24
    v_lshlrev_b32 v26, 16, v22
    v_and_b32 v27, 0xffff0000, v22
    v_add_f32 v25, v25, v26
    v_add_f32 v24, v24, v27
    v_cvt_pk_bf16_f32 v41, v25, v24
    s_mov_b32 exec_hi, 0
    buffer_store_dwordx2 v[40:41], v15, s[40:43], s65 offen
    s_mov_b32 exec_hi, -1
    s_add_u32 s74, s16, 28
    s_cmp_lt_u32 s69, 24
    s_cselect_b32 s75, 4, 7
    s_add_u32 s75, s69, s75
    s_sub_u32 s76, s69, 24
    s_cmp_lt_u32 s76, 4
    s_cselect_b32 s69, s74, s75
    s_branch L_tl_dr_145
L_tl_dro_146:
    s_sub_u32 s67, s56, 7
    s_lshl_b32 s63, s17, 15
    s_lshl_b32 s64, s67, 20
    s_add_u32 s63, s63, s64
    s_lshl_b32 s64, s14, 13
    s_add_u32 s63, s63, s64
    s_add_u32 s63, s63, 0x6000000
    s_add_u32 s64, s63, 4096
    buffer_load_dwordx4 v[64:67], v13, s[4:7], s63 offen offset:0 sc1
    buffer_load_dwordx4 v[68:71], v13, s[4:7], s63 offen offset:1024 sc1
    buffer_load_dwordx4 v[72:75], v13, s[4:7], s63 offen offset:2048 sc1
    buffer_load_dwordx4 v[76:79], v13, s[4:7], s63 offen offset:3072 sc1
    buffer_load_dwordx4 v[80:83], v13, s[4:7], s64 offen offset:0 sc1
    buffer_load_dwordx4 v[84:87], v13, s[4:7], s64 offen offset:1024 sc1
    buffer_load_dwordx4 v[88:91], v13, s[4:7], s64 offen offset:2048 sc1
    buffer_load_dwordx4 v[92:95], v13, s[4:7], s64 offen offset:3072 sc1
    s_lshl_b32 s65, s67, 5
    s_add_u32 s65, s65, s17
    s_lshl_b32 s65, s65, 10
    buffer_load_dwordx4 v[40:43], v13, s[36:39], s65 offen
    buffer_load_dwordx4 v[44:47], v13, s[44:47], 0 offen
    buffer_load_dwordx2 v[48:49], v15, s[36:39], s65 offen
    s_lshr_b32 s66, s65, 7
    s_add_u32 s66, s66, 0x5000000
    v_lshlrev_b32 v56, 11, v15
    buffer_load_dwordx2 v[50:51], v56, s[4:7], s66 offen sc1
    buffer_load_dwordx2 v[52:53], v15, s[48:51], 0 offen
    s_branch L_tl_pl_152
L_tl_fast_94:
    s_nop 1
    s_lshl_b32 s63, s17, 15
    s_lshl_b32 s64, s56, 20
    s_add_u32 s63, s63, s64
    s_lshl_b32 s64, s14, 13
    s_add_u32 s63, s63, s64
    s_add_u32 s63, s63, 0x6000000
    s_add_u32 s64, s63, 4096
    buffer_load_dwordx4 v[64:67], v13, s[4:7], s63 offen offset:0 sc1
    buffer_load_dwordx4 v[68:71], v13, s[4:7], s63 offen offset:1024 sc1
    buffer_load_dwordx4 v[72:75], v13, s[4:7], s63 offen offset:2048 sc1
    buffer_load_dwordx4 v[76:79], v13, s[4:7], s63 offen offset:3072 sc1
    buffer_load_dwordx4 v[80:83], v13, s[4:7], s64 offen offset:0 sc1
    buffer_load_dwordx4 v[84:87], v13, s[4:7], s64 offen offset:1024 sc1
    buffer_load_dwordx4 v[88:91], v13, s[4:7], s64 offen offset:2048 sc1
    buffer_load_dwordx4 v[92:95], v13, s[4:7], s64 offen offset:3072 sc1
    s_lshl_b32 s65, s56, 5
    s_add_u32 s65, s65, s17
    s_lshl_b32 s65, s65, 10
    buffer_load_dwordx4 v[40:43], v13, s[36:39], s65 offen
    buffer_load_dwordx4 v[44:47], v13, s[44:47], 0 offen
    buffer_load_dwordx2 v[48:49], v15, s[36:39], s65 offen
    s_lshr_b32 s66, s65, 7
    s_add_u32 s66, s66, 0x5000000
    v_lshlrev_b32 v56, 11, v15
    buffer_load_dwordx2 v[50:51], v56, s[4:7], s66 offen sc1
    buffer_load_dwordx2 v[52:53], v15, s[48:51], 0 offen
L_tl_pl_152:
    s_waitcnt vmcnt(0)
    v_max3_u32 v56, v64, v68, v72
    v_max3_u32 v56, v56, v76, v80
    v_max3_u32 v56, v56, v84, v88
    v_max_u32 v56, v56, v92
    v_cmp_eq_u32 vcc, -1, v56
    s_add_u32 s93, s93, 1
    s_cmp_lt_u32 s93, 0x80000
    s_cselect_b64 vcc, vcc, 0
    s_cbranch_vccz L_tl_po_153
    s_sleep 2
    buffer_load_dwordx4 v[64:67], v13, s[4:7], s63 offen offset:0 sc1
    buffer_load_dwordx4 v[68:71], v13, s[4:7], s63 offen offset:1024 sc1
    buffer_load_dwordx4 v[72:75], v13, s[4:7], s63 offen offset:2048 sc1
    buffer_load_dwordx4 v[76:79], v13, s[4:7], s63 offen offset:3072 sc1
    buffer_load_dwordx4 v[80:83], v13, s[4:7], s64 offen offset:0 sc1
    buffer_load_dwordx4 v[84:87], v13, s[4:7], s64 offen offset:1024 sc1
    buffer_load_dwordx4 v[88:91], v13, s[4:7], s64 offen offset:2048 sc1
    buffer_load_dwordx4 v[92:95], v13, s[4:7], s64 offen offset:3072 sc1
    s_branch L_tl_pl_152
L_tl_po_153:
    v_lshrrev_b32 v57, 1, v2
    v_cmp_eq_u32 vcc, 0, v57
    s_nop 1
    v_cndmask_b32 v16, 0, v14, vcc
    v_cmp_eq_u32 vcc, 1, v57
    s_nop 1
    v_cndmask_b32 v17, 0, v14, vcc
    v_cmp_eq_u32 vcc, 2, v57
    s_nop 1
    v_cndmask_b32 v18, 0, v14, vcc
    v_cmp_eq_u32 vcc, 3, v57
    s_nop 1
    v_cndmask_b32 v19, 0, v14, vcc
    s_nop 1
    v_mfma_f32_16x16x32_bf16 v[20:23], v[16:19], v[64:67], 0
    v_mfma_f32_16x16x32_bf16 v[20:23], v[16:19], v[68:71], v[20:23]
    v_mfma_f32_16x16x32_bf16 v[20:23], v[16:19], v[72:75], v[20:23]
    v_mfma_f32_16x16x32_bf16 v[20:23], v[16:19], v[76:79], v[20:23]
    v_mfma_f32_16x16x32_bf16 v[20:23], v[16:19], v[80:83], v[20:23]
    v_mfma_f32_16x16x32_bf16 v[20:23], v[16:19], v[84:87], v[20:23]
    v_mfma_f32_16x16x32_bf16 v[20:23], v[16:19], v[88:91], v[20:23]
    v_mfma_f32_16x16x32_bf16 v[20:23], v[16:19], v[92:95], v[20:23]
    v_lshlrev_b32 v24, 16, v40
    v_and_b32 v25, 0xffff0000, v40
    v_lshlrev_b32 v26, 16, v44
    v_and_b32 v27, 0xffff0000, v44
    v_mul_f32 v24, v24, v26
    v_mul_f32 v25, v25, v27
    v_cvt_pk_bf16_f32 v24, v24, v25
    v_lshlrev_b32 v25, 16, v24
    v_and_b32 v24, 0xffff0000, v24
    v_add_f32 v24, v24, v25
    v_mov_b32 v28, v24
    v_lshlrev_b32 v24, 16, v41
    v_and_b32 v25, 0xffff0000, v41
    v_lshlrev_b32 v26, 16, v45
    v_and_b32 v27, 0xffff0000, v45
    v_mul_f32 v24, v24, v26
    v_mul_f32 v25, v25, v27
    v_cvt_pk_bf16_f32 v24, v24, v25
    v_lshlrev_b32 v25, 16, v24
    v_and_b32 v24, 0xffff0000, v24
    v_add_f32 v24, v24, v25
    v_add_f32 v28, v28, v24
    v_lshlrev_b32 v24, 16, v42
    v_and_b32 v25, 0xffff0000, v42
    v_lshlrev_b32 v26, 16, v46
    v_and_b32 v27, 0xffff0000, v46
    v_mul_f32 v24, v24, v26
    v_mul_f32 v25, v25, v27
    v_cvt_pk_bf16_f32 v24, v24, v25
    v_lshlrev_b32 v25, 16, v24
    v_and_b32 v24, 0xffff0000, v24
    v_add_f32 v24, v24, v25
    v_add_f32 v28, v28, v24
    v_lshlrev_b32 v24, 16, v43
    v_and_b32 v25, 0xffff0000, v43
    v_lshlrev_b32 v26, 16, v47
    v_and_b32 v27, 0xffff0000, v47
    v_mul_f32 v24, v24, v26
    v_mul_f32 v25, v25, v27
    v_cvt_pk_bf16_f32 v24, v24, v25
    v_lshlrev_b32 v25, 16, v24
    v_and_b32 v24, 0xffff0000, v24
    v_add_f32 v24, v24, v25
    v_add_f32 v28, v28, v24
    s_nop 1
    v_add_f32_dpp v28, v28, v28 quad_perm:[1,0,3,2] row_mask:0xf bank_mask:0xf
    s_nop 1
    v_add_f32_dpp v28, v28, v28 quad_perm:[2,3,0,1] row_mask:0xf bank_mask:0xf
    s_nop 1
    v_add_f32_dpp v28, v28, v28 row_ror:4 row_mask:0xf bank_mask:0xf
    s_nop 1
    v_add_f32_dpp v28, v28, v28 row_ror:8 row_mask:0xf bank_mask:0xf
    v_mov_b32 v24, v28
    s_nop 1
    v_permlane32_swap_b32 v24, v28
    v_add_f32 v28, v28, v24
    v_mov_b32 v24, v28
    s_nop 1
    v_permlane16_swap_b32 v24, v28
    v_add_f32 v28, v28, v24
    v_cvt_pk_bf16_f32 v28, v28, v28
    v_lshlrev_b32 v28, 16, v28
    v_mul_f32 v28, 0xbfb8aa3b, v28
    v_exp_f32 v28, v28
    s_nop 0
    v_add_f32 v28, 1.0, v28
    v_rcp_f32 v28, v28
    s_nop 0
    v_cvt_pk_bf16_f32 v28, v28, v28
    v_lshlrev_b32 v28, 16, v28
    v_sub_f32 v29, 1.0, v28
    v_cvt_pk_bf16_f32 v29, v29, v29
    v_lshlrev_b32 v29, 16, v29
    v_cvt_pk_bf16_f32 v24, v20, v21
    v_lshlrev_b32 v25, 16, v24
    v_and_b32 v24, 0xffff0000, v24
    v_mul_f32 v25, v28, v25
    v_mul_f32 v24, v28, v24
    v_cvt_pk_bf16_f32 v20, v25, v24
    v_lshlrev_b32 v24, 16, v48
    v_and_b32 v25, 0xffff0000, v48
    v_lshlrev_b32 v26, 16, v52
    v_and_b32 v27, 0xffff0000, v52
    v_mul_f32 v24, v24, v26
    v_mul_f32 v25, v25, v27
    v_cvt_pk_bf16_f32 v24, v24, v25
    v_lshlrev_b32 v25, 16, v24
    v_and_b32 v24, 0xffff0000, v24
    v_lshlrev_b32 v26, 16, v50
    v_and_b32 v27, 0xffff0000, v50
    v_add_f32 v25, v25, v26
    v_add_f32 v24, v24, v27
    v_cvt_pk_bf16_f32 v24, v25, v24
    v_lshlrev_b32 v25, 16, v24
    v_and_b32 v24, 0xffff0000, v24
    v_mul_f32 v25, v29, v25
    v_mul_f32 v24, v29, v24
    v_cvt_pk_bf16_f32 v24, v25, v24
    v_lshlrev_b32 v25, 16, v24
    v_and_b32 v24, 0xffff0000, v24
    v_lshlrev_b32 v26, 16, v20
    v_and_b32 v27, 0xffff0000, v20
    v_add_f32 v25, v25, v26
    v_add_f32 v24, v24, v27
    v_cvt_pk_bf16_f32 v40, v25, v24
    v_cvt_pk_bf16_f32 v24, v22, v23
    v_lshlrev_b32 v25, 16, v24
    v_and_b32 v24, 0xffff0000, v24
    v_mul_f32 v25, v28, v25
    v_mul_f32 v24, v28, v24
    v_cvt_pk_bf16_f32 v22, v25, v24
    v_lshlrev_b32 v24, 16, v49
    v_and_b32 v25, 0xffff0000, v49
    v_lshlrev_b32 v26, 16, v53
    v_and_b32 v27, 0xffff0000, v53
    v_mul_f32 v24, v24, v26
    v_mul_f32 v25, v25, v27
    v_cvt_pk_bf16_f32 v24, v24, v25
    v_lshlrev_b32 v25, 16, v24
    v_and_b32 v24, 0xffff0000, v24
    v_lshlrev_b32 v26, 16, v51
    v_and_b32 v27, 0xffff0000, v51
    v_add_f32 v25, v25, v26
    v_add_f32 v24, v24, v27
    v_cvt_pk_bf16_f32 v24, v25, v24
    v_lshlrev_b32 v25, 16, v24
    v_and_b32 v24, 0xffff0000, v24
    v_mul_f32 v25, v29, v25
    v_mul_f32 v24, v29, v24
    v_cvt_pk_bf16_f32 v24, v25, v24
    v_lshlrev_b32 v25, 16, v24
    v_and_b32 v24, 0xffff0000, v24
    v_lshlrev_b32 v26, 16, v22
    v_and_b32 v27, 0xffff0000, v22
    v_add_f32 v25, v25, v26
    v_add_f32 v24, v24, v27
    v_cvt_pk_bf16_f32 v41, v25, v24
    s_mov_b32 exec_hi, 0
    buffer_store_dwordx2 v[40:41], v15, s[40:43], s65 offen
    s_mov_b32 exec_hi, -1
    s_waitcnt vmcnt(0)
L_mg_end_1:
    s_endpgm
.section .rodata,"a"
.p2align 6
.amdhsa_kernel mega_kernel
  .amdhsa_next_free_vgpr 256
  .amdhsa_next_free_sgpr 100
  .amdhsa_accum_offset 128
  .amdhsa_group_segment_fixed_size 0
  .amdhsa_kernarg_size 160
  .amdhsa_user_sgpr_count 2
  .amdhsa_user_sgpr_kernarg_segment_ptr 1
  .amdhsa_system_sgpr_workgroup_id_x 1
  .amdhsa_float_denorm_mode_32 3
.end_amdhsa_kernel
```
